```python
import torch

def _softmax(x, axis=-1):
    return torch.softmax(x, dim=axis)
def _gelu(x):
    return torch.nn.functional.gelu(x, approximate="tanh")
def _silu(x):
    return torch.nn.functional.silu(x)
def _sigmoid(x):
    return torch.sigmoid(x)
def _layernorm(x, axis=-1, eps=1e-5):
    m = x.mean(dim=axis, keepdim=True)
    v = x.var(dim=axis, keepdim=True, unbiased=False)
    return (x - m) / torch.sqrt(v + eps)
def _scatter_add(tgt, idx, src, axis=0):
    return tgt.clone().index_add_(axis, idx, src)
def _segment_sum(src, seg, n):
    out = torch.zeros((n,) + src.shape[1:], dtype=src.dtype)
    return out.index_add_(0, seg, src)
def _pad(x, pw):
    flat = tuple(v for pair in reversed(pw) for v in pair)
    return torch.nn.functional.pad(x, flat)

kernel_name = 'gated_mix__sliding_local_dilated__mixer_s_mlp__prompt'

def setup_inputs():

    _w = (lambda a: (lambda t: t.to(torch.bfloat16) if t.is_floating_point() else t)(torch.as_tensor(a)))
    def _A_setup():
        B, S, D = 1, 2048, 640
        return {
            "x": _w((lambda *s: torch.randn(*s, dtype=torch.bfloat16) * 0.05)(B, S, D)),
            "wqkv": _w((lambda *s: torch.randn(*s, dtype=torch.bfloat16) * 3.2)(D, 3 * D)),
            "wo": _w((lambda *s: torch.randn(*s, dtype=torch.bfloat16) * 0.1)(D, D)),
        }
    _A_in = _A_setup()

    def _B_setup():
        B, S, D, F = 1, 2048, 640, 1728
        return {
            "x":  _w((lambda *s: torch.randn(*s, dtype=torch.bfloat16) * 0.05)(B, S, D)),
            "w1": _w((lambda *s: torch.randn(*s, dtype=torch.bfloat16) * 3.2)(D, D) * (D ** -0.5)),
            "w2": _w((lambda *s: torch.randn(*s, dtype=torch.bfloat16) * 3.2)(D, D) * (D ** -0.5)),
            "w3": _w((lambda *s: torch.randn(*s, dtype=torch.bfloat16) * 3.2)(D, F) * (D ** -0.5)),
            "w4": _w((lambda *s: torch.randn(*s, dtype=torch.bfloat16) * 3.2)(F, D) * (F ** -0.5)),
        }
    _B_in = _B_setup()

    return {
        "A_x": _A_in["x"],
        "A_wqkv": _A_in["wqkv"],
        "A_wo": _A_in["wo"],
        "B_x": _B_in["x"],
        "B_w1": _B_in["w1"],
        "B_w2": _B_in["w2"],
        "B_w3": _B_in["w3"],
        "B_w4": _B_in["w4"],
        "gate_w": _w((lambda *s: torch.randn(*s, dtype=torch.bfloat16) * 0.05)(640) * 16.0),
    }

def reference(A_x, A_wqkv, A_wo, B_x, B_w1, B_w2, B_w3, B_w4, gate_w):
    def _A_ref(x, wqkv, wo):
        B, S, D = x.shape
        H = 32; Dh = D // H
        W, dil = 8, 2
        qkv = (lambda x, *d: x.permute(*d))((x @ wqkv).reshape(B, S, 3, H, Dh), 2, 0, 3, 1, 4)
        q, k, v = qkv[0], qkv[1], qkv[2]
        scale = Dh ** -0.5
        pos = torch.arange(S)
        off = torch.arange(W) * dil
        idx = pos[:, None] - off[None, :]
        mask = idx >= 0
        idx_c = torch.where(mask, idx, 0).reshape(-1)
        kg = k[:, :, idx_c, :].reshape(B, H, S, W, Dh)
        vg = v[:, :, idx_c, :].reshape(B, H, S, W, Dh)
        logits = torch.einsum("bhsd,bhswd->bhsw", q, kg) * scale
        logits = torch.where(mask[None, None, :, :], logits, -1e9)
        attn = _softmax(logits, axis=-1)
        o = torch.einsum("bhsw,bhswd->bhsd", attn, vg)
        return (lambda x, *d: x.permute(*d))(o, 0, 2, 1, 3).reshape(B, S, D) @ wo

    def _B_ref(x, w1, w2, w3, w4):
        B, S, D = x.shape
        h = _gelu(_layernorm(x, axis=-1) @ w1)
        c = D // 4
        g0 = _pad(h[:, :, 0*c:1*c], ((0, 0), (1, 0), (0, 0)))[:, :S, :]
        g1 = _pad(h[:, :, 1*c:2*c], ((0, 0), (0, 1), (0, 0)))[:, 1:, :]
        g2 = _pad(h[:, :, 2*c:3*c], ((0, 0), (2, 0), (0, 0)))[:, :S, :]
        g3 = _pad(h[:, :, 3*c:   ], ((0, 0), (0, 2), (0, 0)))[:, 2:, :]
        hs = torch.concatenate([g0, g1, g2, g3], axis=-1) @ w2
        x1 = x + hs
        h2 = _gelu(_layernorm(x1, axis=-1) @ w3) @ w4
        return x1 + h2

    x = A_x
    g = _sigmoid((x * gate_w).sum(-1, keepdims=True))
    a = _A_ref(x, A_wqkv, A_wo)
    b = _B_ref(x, B_w1, B_w2, B_w3, B_w4)
    return g * a + (1 - g) * b
```

```asm
; @launch grid=(256,1,1) block=(512,1,1) lds=163840
.amdgcn_target "amdgcn-amd-amdhsa--gfx950"
.text
.globl gated_mix__sliding_local_dilated__mixer_s_mlp__prompt_kernel
.p2align 8
.type gated_mix__sliding_local_dilated__mixer_s_mlp__prompt_kernel,@function
gated_mix__sliding_local_dilated__mixer_s_mlp__prompt_kernel:
  s_cmp_ge_u32 s2, 256
  s_cbranch_scc1 .Lexit
  s_load_dwordx16 s[40:55], s[0:1], 0
  s_load_dwordx8 s[56:63], s[0:1], 64
  v_lshrrev_b32 v2, 6, v0
  v_and_b32 v1, 63, v0
  v_readfirstlane_b32 s20, v2
  s_and_b32 s30, s2, 7
  s_lshr_b32 s31, s2, 3
  s_and_b32 s22, s31, 1
  s_lshl_b32 s30, s30, 1
  s_add_u32 s22, s22, s30
  s_lshr_b32 s23, s31, 1
  s_lshl_b32 s24, s22, 4
  s_add_u32 s24, s24, s23
  s_cmp_ge_u32 s23, 12
  s_cselect_b32 s64, 1, 0
  s_lshr_b32 s30, s23, 3
  s_lshl_b32 s30, s30, 2
  s_and_b32 s66, s23, 3
  s_add_u32 s66, s66, s30
  s_lshr_b32 s65, s23, 2
  s_and_b32 s65, s65, 1
  s_lshl_b32 s67, s22, 7
  s_lshl_b32 s30, s65, 6
  s_add_u32 s67, s67, s30
  s_mov_b32 s28, 0xc0135761
  s_mov_b32 s29, 0xbdd2d3e8
  s_and_b32 s21, s20, 3
  s_waitcnt lgkmcnt(0)
  s_mov_b32 s4, s62
  s_mov_b32 s5, s63
  s_mov_b32 s6, 0x2600000
  s_mov_b32 s7, 0x20000
  s_cmp_lg_u32 s20, 3
  s_cbranch_scc1 .ipf_1
  s_getpc_b64 s[30:31]
  s_and_b32 s30, s30, 0xffffff00
  s_lshr_b32 s32, s2, 3
  s_lshl_b32 s32, s32, 11
  v_and_b32 v2, 15, v1
  v_lshlrev_b32 v2, 7, v2
  v_add_u32 v2, s32, v2
  v_min_u32 v2, 53168, v2
  global_load_dword v3, v2, s[30:31]
.ipf_1:
  s_cmp_ge_u32 s20, 4
  s_cbranch_scc1 .Lloader
  s_or_b32 s30, s2, s20
  s_cmp_lg_u32 s30, 0
  s_cbranch_scc1 .np_2
  s_memrealtime s[32:33]
  s_mov_b32 s12, s60
  s_mov_b32 s13, s61
  s_mov_b32 s14, 0x100
  s_mov_b32 s15, 0x20000
  v_mov_b32 v188, 0
  s_waitcnt lgkmcnt(0)
  s_or_b32 s32, s32, 1
  s_or_b32 s33, s33, 0x40000000
  v_mov_b32 v190, s32
  v_mov_b32 v191, s33
  buffer_store_dwordx2 v[190:191], v188, s[12:15], 0 offen sc1
.np_2:
  s_mov_b32 s8, s40
  s_mov_b32 s9, s41
  s_mov_b32 s10, 0x280000
  s_mov_b32 s11, 0x20000
  s_lshl_b32 s30, s24, 3
  s_lshl_b32 s31, s21, 1
  s_add_u32 s30, s30, s31
  v_lshrrev_b32 v192, 5, v1
  v_add_u32 v192, s30, v192
  v_and_b32 v193, 31, v1
  v_mul_u32_u24 v193, 40, v193
  v_mul_u32_u24 v194, 1280, v192
  v_add_u32 v194, v194, v193
  buffer_load_dwordx4 v[4:7], v194, s[8:11], 0 offen
  buffer_load_dwordx4 v[8:11], v194, s[8:11], 0 offen offset:16
  buffer_load_dwordx2 v[12:13], v194, s[8:11], 0 offen offset:32
  s_lshl_b32 s30, s24, 2
  s_add_u32 s30, s30, s21
  s_mov_b32 s16, s50
  s_mov_b32 s17, s51
  s_mov_b32 s18, 0xc8000
  s_mov_b32 s19, 0x20000
  s_mul_i32 s31, s30, 6554
  s_lshr_b32 s31, s31, 16
  s_mul_i32 s32, s31, 10
  s_sub_u32 s32, s30, s32
  s_mul_i32 s33, s31, 6554
  s_lshr_b32 s33, s33, 16
  s_mul_i32 s34, s33, 10
  s_sub_u32 s34, s31, s34
  s_mul_i32 s35, s33, 10
  s_add_u32 s35, s35, s34
  s_mul_i32 s35, s35, 10
  s_add_u32 s35, s35, s32
  s_lshl_b32 s35, s35, 10
  s_add_u32 s35, s35, 0x1c00000
  s_mul_i32 s34, s34, 81920
  s_mul_i32 s33, s33, 160
  s_add_u32 s34, s34, s33
  s_cmp_lt_u32 s30, 800
  s_cselect_b32 s35, s35, 0x80000000
  s_cselect_b32 s34, s34, 0x40000000
  s_lshl_b32 s32, s32, 6
  v_lshl_add_u32 v172, v1, 4, s35
  v_add_u32 v188, s32, v1
  v_mul_u32_u24 v189, 6554, v188
  v_lshrrev_b32 v189, 16, v189
  v_mul_u32_u24 v190, 10, v189
  v_sub_u32 v190, v188, v190
  v_and_b32 v191, 0x73, v189
  v_and_b32 v188, 4, v189
  v_lshl_or_b32 v191, v188, 1, v191
  v_and_b32 v188, 8, v189
  v_lshrrev_b32 v188, 1, v188
  v_or_b32 v191, v191, v188
  v_mul_u32_u24 v191, 1280, v191
  v_lshl_add_u32 v191, v190, 4, v191
  buffer_load_dwordx4 v[140:143], v191, s[16:19], s34 offen
  s_lshl_b32 s30, s24, 2
  s_add_u32 s30, s30, s21
  s_mov_b32 s16, s52
  s_mov_b32 s17, s53
  s_mov_b32 s18, 0x21c000
  s_mov_b32 s19, 0x20000
  s_mul_i32 s31, s30, 4682
  s_lshr_b32 s31, s31, 16
  s_mul_i32 s32, s31, 14
  s_sub_u32 s32, s30, s32
  s_mul_i32 s33, s31, 6554
  s_lshr_b32 s33, s33, 16
  s_mul_i32 s34, s33, 10
  s_sub_u32 s34, s31, s34
  s_mul_i32 s35, s33, 10
  s_add_u32 s35, s35, s34
  s_mul_i32 s35, s35, 14
  s_add_u32 s35, s35, s32
  s_lshl_b32 s35, s35, 10
  s_add_u32 s35, s35, 0x2300000
  s_mul_i32 s34, s34, 221184
  s_mul_i32 s33, s33, 224
  s_add_u32 s34, s34, s33
  s_lshl_b32 s32, s32, 6
  v_lshl_add_u32 v173, v1, 4, s35
  v_add_u32 v188, s32, v1
  v_mul_u32_u24 v189, 4682, v188
  v_lshrrev_b32 v189, 16, v189
  v_mul_u32_u24 v190, 14, v189
  v_sub_u32 v190, v188, v190
  v_and_b32 v191, 0x73, v189
  v_and_b32 v188, 4, v189
  v_lshl_or_b32 v191, v188, 1, v191
  v_and_b32 v188, 8, v189
  v_lshrrev_b32 v188, 1, v188
  v_or_b32 v191, v191, v188
  v_mul_u32_u24 v191, 3456, v191
  v_lshl_add_u32 v191, v190, 4, v191
  buffer_load_dwordx4 v[144:147], v191, s[16:19], s34 offen
  s_lshl_b32 s30, s24, 2
  s_add_u32 s30, s30, s21
  s_add_u32 s30, s30, 1024
  s_mov_b32 s16, s52
  s_mov_b32 s17, s53
  s_mov_b32 s18, 0x21c000
  s_mov_b32 s19, 0x20000
  s_mul_i32 s31, s30, 4682
  s_lshr_b32 s31, s31, 16
  s_mul_i32 s32, s31, 14
  s_sub_u32 s32, s30, s32
  s_mul_i32 s33, s31, 6554
  s_lshr_b32 s33, s33, 16
  s_mul_i32 s34, s33, 10
  s_sub_u32 s34, s31, s34
  s_mul_i32 s35, s33, 10
  s_add_u32 s35, s35, s34
  s_mul_i32 s35, s35, 14
  s_add_u32 s35, s35, s32
  s_lshl_b32 s35, s35, 10
  s_add_u32 s35, s35, 0x2300000
  s_mul_i32 s34, s34, 221184
  s_mul_i32 s33, s33, 224
  s_add_u32 s34, s34, s33
  s_lshl_b32 s32, s32, 6
  v_lshl_add_u32 v174, v1, 4, s35
  v_add_u32 v188, s32, v1
  v_mul_u32_u24 v189, 4682, v188
  v_lshrrev_b32 v189, 16, v189
  v_mul_u32_u24 v190, 14, v189
  v_sub_u32 v190, v188, v190
  v_and_b32 v191, 0x73, v189
  v_and_b32 v188, 4, v189
  v_lshl_or_b32 v191, v188, 1, v191
  v_and_b32 v188, 8, v189
  v_lshrrev_b32 v188, 1, v188
  v_or_b32 v191, v191, v188
  v_mul_u32_u24 v191, 3456, v191
  v_lshl_add_u32 v191, v190, 4, v191
  buffer_load_dwordx4 v[148:151], v191, s[16:19], s34 offen
  s_lshl_b32 s30, s24, 2
  s_add_u32 s30, s30, s21
  s_add_u32 s30, s30, 2048
  s_mov_b32 s16, s52
  s_mov_b32 s17, s53
  s_mov_b32 s18, 0x21c000
  s_mov_b32 s19, 0x20000
  s_mul_i32 s31, s30, 4682
  s_lshr_b32 s31, s31, 16
  s_mul_i32 s32, s31, 14
  s_sub_u32 s32, s30, s32
  s_mul_i32 s33, s31, 6554
  s_lshr_b32 s33, s33, 16
  s_mul_i32 s34, s33, 10
  s_sub_u32 s34, s31, s34
  s_mul_i32 s35, s33, 10
  s_add_u32 s35, s35, s34
  s_mul_i32 s35, s35, 14
  s_add_u32 s35, s35, s32
  s_lshl_b32 s35, s35, 10
  s_add_u32 s35, s35, 0x2300000
  s_mul_i32 s34, s34, 221184
  s_mul_i32 s33, s33, 224
  s_add_u32 s34, s34, s33
  s_cmp_lt_u32 s30, 2240
  s_cselect_b32 s35, s35, 0x80000000
  s_cselect_b32 s34, s34, 0x40000000
  s_lshl_b32 s32, s32, 6
  v_lshl_add_u32 v175, v1, 4, s35
  v_add_u32 v188, s32, v1
  v_mul_u32_u24 v189, 4682, v188
  v_lshrrev_b32 v189, 16, v189
  v_mul_u32_u24 v190, 14, v189
  v_sub_u32 v190, v188, v190
  v_and_b32 v191, 0x73, v189
  v_and_b32 v188, 4, v189
  v_lshl_or_b32 v191, v188, 1, v191
  v_and_b32 v188, 8, v189
  v_lshrrev_b32 v188, 1, v188
  v_or_b32 v191, v191, v188
  v_mul_u32_u24 v191, 3456, v191
  v_lshl_add_u32 v191, v190, 4, v191
  buffer_load_dwordx4 v[152:155], v191, s[16:19], s34 offen
  v_mov_b32 v224, 0
  v_mov_b32 v225, 0
  v_mov_b32 v226, 0
  v_mov_b32 v227, 0
  v_mov_b32 v228, 0
  v_mov_b32 v229, 0
  v_mov_b32 v230, 0
  v_mov_b32 v231, 0
  v_mov_b32 v232, 0
  v_mov_b32 v233, 0
  v_mov_b32 v234, 0
  v_mov_b32 v235, 0
  v_mov_b32 v236, 0
  v_mov_b32 v237, 0
  v_mov_b32 v238, 0
  v_mov_b32 v239, 0
  v_mov_b32 v240, 0
  v_mov_b32 v241, 0
  v_mov_b32 v242, 0
  v_mov_b32 v243, 0
  v_mov_b32 v244, 0
  v_mov_b32 v245, 0
  v_mov_b32 v246, 0
  v_mov_b32 v247, 0
  v_mov_b32 v248, 0
  v_mov_b32 v249, 0
  v_mov_b32 v250, 0
  v_mov_b32 v251, 0
  v_mov_b32 v252, 0
  v_mov_b32 v253, 0
  v_mov_b32 v254, 0
  v_mov_b32 v255, 0
  v_and_b32 v188, 31, v1
  v_lshlrev_b32 v188, 2, v188
  v_add_u32 v188, 162880, v188
  ds_write_b32 v188, v224
  v_mov_b32 v212, 0x3f803f80
  v_mov_b32 v213, 0x3f803f80
  v_mov_b32 v214, 0x3f803f80
  v_mov_b32 v215, 0x3f803f80
  v_lshrrev_b32 v196, 4, v1
  v_and_b32 v197, 15, v1
  v_lshlrev_b32 v197, 7, v197
  v_and_b32 v198, 7, v1
  v_xor_b32 v198, v198, v196
  v_lshl_add_u32 v211, v198, 4, v197
  s_lshl_b32 s30, s21, 12
  s_add_u32 s30, s30, 20480
  v_add_u32 v180, s30, v211
  v_xor_b32 v182, 64, v180
  v_add_u32 v181, 73728, v180
  v_add_u32 v183, 73728, v182
  v_lshrrev_b32 v198, 1, v196
  v_lshlrev_b32 v198, 4, v198
  v_and_b32 v199, 1, v196
  v_lshl_add_u32 v198, v199, 2, v198
  v_bfe_u32 v200, v1, 2, 2
  v_add_u32 v208, v198, v200
  v_and_b32 v200, 3, v1
  v_lshlrev_b32 v209, 3, v200
  v_mul_u32_u24 v198, 320, v208
  v_add_u32 v198, v198, v209
  v_lshlrev_b32 v199, 5, v199
  v_add_u32 v184, v198, v199
  v_sub_u32 v186, v198, v199
  v_add_u32 v185, 73728, v184
  v_add_u32 v187, 73728, v186
  s_waitcnt vmcnt(4)
  v_lshlrev_b32 v28, 16, v4
  v_and_b32 v29, 0xffff0000, v4
  v_lshlrev_b32 v30, 16, v5
  v_and_b32 v31, 0xffff0000, v5
  v_lshlrev_b32 v32, 16, v6
  v_and_b32 v33, 0xffff0000, v6
  v_lshlrev_b32 v34, 16, v7
  v_and_b32 v35, 0xffff0000, v7
  v_lshlrev_b32 v36, 16, v8
  v_and_b32 v37, 0xffff0000, v8
  v_lshlrev_b32 v38, 16, v9
  v_and_b32 v39, 0xffff0000, v9
  v_lshlrev_b32 v40, 16, v10
  v_and_b32 v41, 0xffff0000, v10
  v_lshlrev_b32 v42, 16, v11
  v_and_b32 v43, 0xffff0000, v11
  v_lshlrev_b32 v44, 16, v12
  v_and_b32 v45, 0xffff0000, v12
  v_lshlrev_b32 v46, 16, v13
  v_and_b32 v47, 0xffff0000, v13
  v_pk_add_f32 v[200:201], v[28:29], v[30:31]
  v_pk_add_f32 v[202:203], v[32:33], v[34:35]
  v_pk_add_f32 v[200:201], v[200:201], v[36:37]
  v_pk_add_f32 v[202:203], v[202:203], v[38:39]
  v_pk_add_f32 v[200:201], v[200:201], v[40:41]
  v_pk_add_f32 v[202:203], v[202:203], v[42:43]
  v_pk_add_f32 v[200:201], v[200:201], v[44:45]
  v_pk_add_f32 v[202:203], v[202:203], v[46:47]
  v_pk_add_f32 v[200:201], v[200:201], v[202:203]
  v_add_f32 v196, v200, v201
  s_nop 1
  v_add_f32_dpp v196, v196, v196 quad_perm:[1,0,3,2] row_mask:0xf bank_mask:0xf
  s_nop 1
  v_add_f32_dpp v196, v196, v196 quad_perm:[2,3,0,1] row_mask:0xf bank_mask:0xf
  s_nop 1
  v_add_f32_dpp v196, v196, v196 row_half_mirror row_mask:0xf bank_mask:0xf
  s_nop 1
  v_add_f32_dpp v196, v196, v196 row_mirror row_mask:0xf bank_mask:0xf
  v_mov_b32 v200, v196
  s_nop 1
  v_permlane16_swap_b32 v196, v200
  v_add_f32 v196, v196, v200
  v_mul_f32 v196, 0xbacccccd, v196
  v_pk_add_f32 v[28:29], v[28:29], v[196:197] op_sel_hi:[1,0]
  v_pk_add_f32 v[30:31], v[30:31], v[196:197] op_sel_hi:[1,0]
  v_pk_add_f32 v[32:33], v[32:33], v[196:197] op_sel_hi:[1,0]
  v_pk_add_f32 v[34:35], v[34:35], v[196:197] op_sel_hi:[1,0]
  v_pk_add_f32 v[36:37], v[36:37], v[196:197] op_sel_hi:[1,0]
  v_pk_add_f32 v[38:39], v[38:39], v[196:197] op_sel_hi:[1,0]
  v_pk_add_f32 v[40:41], v[40:41], v[196:197] op_sel_hi:[1,0]
  v_pk_add_f32 v[42:43], v[42:43], v[196:197] op_sel_hi:[1,0]
  v_pk_add_f32 v[44:45], v[44:45], v[196:197] op_sel_hi:[1,0]
  v_pk_add_f32 v[46:47], v[46:47], v[196:197] op_sel_hi:[1,0]
  v_pk_mul_f32 v[200:201], v[28:29], v[28:29]
  v_pk_mul_f32 v[202:203], v[30:31], v[30:31]
  v_pk_fma_f32 v[200:201], v[32:33], v[32:33], v[200:201]
  v_pk_fma_f32 v[202:203], v[34:35], v[34:35], v[202:203]
  v_pk_fma_f32 v[200:201], v[36:37], v[36:37], v[200:201]
  v_pk_fma_f32 v[202:203], v[38:39], v[38:39], v[202:203]
  v_pk_fma_f32 v[200:201], v[40:41], v[40:41], v[200:201]
  v_pk_fma_f32 v[202:203], v[42:43], v[42:43], v[202:203]
  v_pk_fma_f32 v[200:201], v[44:45], v[44:45], v[200:201]
  v_pk_fma_f32 v[202:203], v[46:47], v[46:47], v[202:203]
  v_pk_add_f32 v[200:201], v[200:201], v[202:203]
  v_add_f32 v197, v200, v201
  s_nop 1
  v_add_f32_dpp v197, v197, v197 quad_perm:[1,0,3,2] row_mask:0xf bank_mask:0xf
  s_nop 1
  v_add_f32_dpp v197, v197, v197 quad_perm:[2,3,0,1] row_mask:0xf bank_mask:0xf
  s_nop 1
  v_add_f32_dpp v197, v197, v197 row_half_mirror row_mask:0xf bank_mask:0xf
  s_nop 1
  v_add_f32_dpp v197, v197, v197 row_mirror row_mask:0xf bank_mask:0xf
  v_mov_b32 v200, v197
  s_nop 1
  v_permlane16_swap_b32 v197, v200
  v_add_f32 v197, v197, v200
  v_mul_f32 v197, 0x3acccccd, v197
  v_xor_b32 v196, 0x80000000, v196
  v_cvt_pk_bf16_f32 v200, v196, v197
  v_lshlrev_b32 v196, 16, v200
  v_and_b32 v197, 0xffff0000, v200
  v_add_f32 v197, 0x3727c5ac, v197
  v_cvt_pk_bf16_f32 v200, v197, v197
  v_lshlrev_b32 v197, 16, v200
  v_sqrt_f32 v197, v197
  s_nop 0
  v_cvt_pk_bf16_f32 v200, v197, v197
  v_lshlrev_b32 v197, 16, v200
  v_rcp_f32 v197, v197
  v_xor_b32 v196, 0x80000000, v196
  v_lshlrev_b32 v200, 4, v192
  v_add_u32 v200, 0x1b00000, v200
  s_waitcnt vmcnt(0)
  buffer_store_dwordx2 v[196:197], v200, s[4:7], 0 offen sc1
  buffer_store_dwordx4 v[140:143], v172, s[4:7], 0 offen sc1
  buffer_store_dwordx4 v[144:147], v173, s[4:7], 0 offen sc1
  buffer_store_dwordx4 v[148:151], v174, s[4:7], 0 offen sc1
  buffer_store_dwordx4 v[152:155], v175, s[4:7], 0 offen sc1
  s_getreg_b32 s30, hwreg(HW_REG_XCC_ID)
  s_lshl_b32 s31, s24, 2
  s_add_u32 s31, s31, 0x1b0c000
  v_mov_b32 v188, s31
  v_mov_b32 v189, s30
  buffer_store_dword v189, v188, s[4:7], 0 offen sc1
  s_lshl_b32 s30, s21, 5
  v_and_b32 v204, 15, v1
  v_add_u32 v204, s30, v204
  v_lshlrev_b32 v205, 4, v204
  v_add_u32 v205, 159744, v205
  v_lshrrev_b32 v188, 4, v1
  v_lshlrev_b32 v206, 4, v188
  v_add_u32 v206, 161792, v206
  s_lshl_b32 s30, s21, 8
  v_add_u32 v207, s30, v206
  s_waitcnt lgkmcnt(0)
  s_barrier
  ds_read_b64_tr_b16 v[100:101], v184 offset:0
  ds_read_b64_tr_b16 v[102:103], v184 offset:2560
  ds_read_b128 v[84:87], v180 offset:0
  ds_read_b128 v[88:91], v180 offset:2048
  ds_read_b64_tr_b16 v[104:105], v186 offset:32
  ds_read_b64_tr_b16 v[106:107], v186 offset:2592
  ds_read_b64_tr_b16 v[108:109], v184 offset:64
  ds_read_b64_tr_b16 v[110:111], v184 offset:2624
  ds_read_b64_tr_b16 v[112:113], v186 offset:96
  ds_read_b64_tr_b16 v[114:115], v186 offset:2656
  ds_read_b64_tr_b16 v[116:117], v184 offset:128
  ds_read_b64_tr_b16 v[118:119], v184 offset:2688
  ds_read_b64_tr_b16 v[120:121], v186 offset:160
  ds_read_b64_tr_b16 v[122:123], v186 offset:2720
  ds_read_b64_tr_b16 v[124:125], v184 offset:192
  ds_read_b64_tr_b16 v[126:127], v184 offset:2752
  ds_read_b64_tr_b16 v[128:129], v186 offset:224
  ds_read_b64_tr_b16 v[130:131], v186 offset:2784
  ds_read_b64_tr_b16 v[132:133], v184 offset:256
  ds_read_b64_tr_b16 v[134:135], v184 offset:2816
  ds_read_b64_tr_b16 v[136:137], v186 offset:288
  ds_read_b64_tr_b16 v[138:139], v186 offset:2848
  s_waitcnt lgkmcnt(0)
  v_mfma_f32_16x16x32_bf16 v[4:7], v[100:103], v[84:87], 0
  ds_read_b64_tr_b16 v[140:141], v184 offset:10240
  ds_read_b64_tr_b16 v[142:143], v184 offset:12800
  v_mfma_f32_16x16x32_bf16 v[44:47], v[100:103], v[88:91], 0
  ds_read_b128 v[92:95], v182 offset:0
  v_mfma_f32_16x16x32_bf16 v[8:11], v[104:107], v[84:87], 0
  ds_read_b128 v[96:99], v182 offset:2048
  ds_read_b64_tr_b16 v[144:145], v186 offset:10272
  v_mfma_f32_16x16x32_bf16 v[48:51], v[104:107], v[88:91], 0
  ds_read_b64_tr_b16 v[146:147], v186 offset:12832
  v_mfma_f32_16x16x32_bf16 v[12:15], v[108:111], v[84:87], 0
  ds_read_b64_tr_b16 v[148:149], v184 offset:10304
  v_mfma_f32_16x16x32_bf16 v[52:55], v[108:111], v[88:91], 0
  ds_read_b64_tr_b16 v[150:151], v184 offset:12864
  ds_read_b64_tr_b16 v[152:153], v186 offset:10336
  v_mfma_f32_16x16x32_bf16 v[16:19], v[112:115], v[84:87], 0
  ds_read_b64_tr_b16 v[154:155], v186 offset:12896
  v_mfma_f32_16x16x32_bf16 v[56:59], v[112:115], v[88:91], 0
  ds_read_b64_tr_b16 v[156:157], v184 offset:10368
  v_mfma_f32_16x16x32_bf16 v[20:23], v[116:119], v[84:87], 0
  ds_read_b64_tr_b16 v[158:159], v184 offset:12928
  ds_read_b64_tr_b16 v[160:161], v186 offset:10400
  v_mfma_f32_16x16x32_bf16 v[60:63], v[116:119], v[88:91], 0
  ds_read_b64_tr_b16 v[162:163], v186 offset:12960
  v_mfma_f32_16x16x32_bf16 v[24:27], v[120:123], v[84:87], 0
  ds_read_b64_tr_b16 v[164:165], v184 offset:10432
  ds_read_b64_tr_b16 v[166:167], v184 offset:12992
  v_mfma_f32_16x16x32_bf16 v[64:67], v[120:123], v[88:91], 0
  ds_read_b64_tr_b16 v[168:169], v186 offset:10464
  v_mfma_f32_16x16x32_bf16 v[28:31], v[124:127], v[84:87], 0
  ds_read_b64_tr_b16 v[170:171], v186 offset:13024
  v_mfma_f32_16x16x32_bf16 v[68:71], v[124:127], v[88:91], 0
  ds_read_b64_tr_b16 v[172:173], v184 offset:10496
  ds_read_b64_tr_b16 v[174:175], v184 offset:13056
  v_mfma_f32_16x16x32_bf16 v[32:35], v[128:131], v[84:87], 0
  ds_read_b64_tr_b16 v[176:177], v186 offset:10528
  v_mfma_f32_16x16x32_bf16 v[72:75], v[128:131], v[88:91], 0
  ds_read_b64_tr_b16 v[178:179], v186 offset:13088
  v_mfma_f32_16x16x32_bf16 v[36:39], v[132:135], v[84:87], 0
  v_mfma_f32_16x16x32_bf16 v[76:79], v[132:135], v[88:91], 0
  v_mfma_f32_16x16x32_bf16 v[40:43], v[136:139], v[84:87], 0
  v_mfma_f32_16x16x32_bf16 v[80:83], v[136:139], v[88:91], 0
  s_cmp_lg_u32 s21, 0
  s_cbranch_scc1 .cm_3
  v_mfma_f32_16x16x32_bf16 v[232:235], v[132:135], v[212:215], v[232:235]
  v_mfma_f32_16x16x32_bf16 v[236:239], v[136:139], v[212:215], v[236:239]
  s_cmp_eq_u32 s64, 0
  s_cbranch_scc1 .cm_3
  v_mfma_f32_16x16x32_bf16 v[224:227], v[124:127], v[212:215], v[224:227]
  v_mfma_f32_16x16x32_bf16 v[228:231], v[128:131], v[212:215], v[228:231]
.cm_3:
  s_waitcnt lgkmcnt(0)
  s_barrier
  v_mfma_f32_16x16x32_bf16 v[4:7], v[140:143], v[92:95], v[4:7]
  ds_read_b64_tr_b16 v[100:101], v184 offset:36864
  ds_read_b64_tr_b16 v[102:103], v184 offset:39424
  v_mfma_f32_16x16x32_bf16 v[44:47], v[140:143], v[96:99], v[44:47]
  ds_read_b128 v[84:87], v180 offset:36864
  v_mfma_f32_16x16x32_bf16 v[8:11], v[144:147], v[92:95], v[8:11]
  ds_read_b128 v[88:91], v180 offset:38912
  ds_read_b64_tr_b16 v[104:105], v186 offset:36896
  v_mfma_f32_16x16x32_bf16 v[48:51], v[144:147], v[96:99], v[48:51]
  ds_read_b64_tr_b16 v[106:107], v186 offset:39456
  v_mfma_f32_16x16x32_bf16 v[12:15], v[148:151], v[92:95], v[12:15]
  ds_read_b64_tr_b16 v[108:109], v184 offset:36928
  v_mfma_f32_16x16x32_bf16 v[52:55], v[148:151], v[96:99], v[52:55]
  ds_read_b64_tr_b16 v[110:111], v184 offset:39488
  ds_read_b64_tr_b16 v[112:113], v186 offset:36960
  v_mfma_f32_16x16x32_bf16 v[16:19], v[152:155], v[92:95], v[16:19]
  ds_read_b64_tr_b16 v[114:115], v186 offset:39520
  v_mfma_f32_16x16x32_bf16 v[56:59], v[152:155], v[96:99], v[56:59]
  ds_read_b64_tr_b16 v[116:117], v184 offset:36992
  v_mfma_f32_16x16x32_bf16 v[20:23], v[156:159], v[92:95], v[20:23]
  ds_read_b64_tr_b16 v[118:119], v184 offset:39552
  ds_read_b64_tr_b16 v[120:121], v186 offset:37024
  v_mfma_f32_16x16x32_bf16 v[60:63], v[156:159], v[96:99], v[60:63]
  ds_read_b64_tr_b16 v[122:123], v186 offset:39584
  v_mfma_f32_16x16x32_bf16 v[24:27], v[160:163], v[92:95], v[24:27]
  ds_read_b64_tr_b16 v[124:125], v184 offset:37056
  ds_read_b64_tr_b16 v[126:127], v184 offset:39616
  v_mfma_f32_16x16x32_bf16 v[64:67], v[160:163], v[96:99], v[64:67]
  ds_read_b64_tr_b16 v[128:129], v186 offset:37088
  v_mfma_f32_16x16x32_bf16 v[28:31], v[164:167], v[92:95], v[28:31]
  ds_read_b64_tr_b16 v[130:131], v186 offset:39648
  v_mfma_f32_16x16x32_bf16 v[68:71], v[164:167], v[96:99], v[68:71]
  ds_read_b64_tr_b16 v[132:133], v184 offset:37120
  ds_read_b64_tr_b16 v[134:135], v184 offset:39680
  v_mfma_f32_16x16x32_bf16 v[32:35], v[168:171], v[92:95], v[32:35]
  ds_read_b64_tr_b16 v[136:137], v186 offset:37152
  v_mfma_f32_16x16x32_bf16 v[72:75], v[168:171], v[96:99], v[72:75]
  ds_read_b64_tr_b16 v[138:139], v186 offset:39712
  v_mfma_f32_16x16x32_bf16 v[36:39], v[172:175], v[92:95], v[36:39]
  v_mfma_f32_16x16x32_bf16 v[76:79], v[172:175], v[96:99], v[76:79]
  v_mfma_f32_16x16x32_bf16 v[40:43], v[176:179], v[92:95], v[40:43]
  v_mfma_f32_16x16x32_bf16 v[80:83], v[176:179], v[96:99], v[80:83]
  s_cmp_lg_u32 s21, 1
  s_cbranch_scc1 .cm_4
  v_mfma_f32_16x16x32_bf16 v[232:235], v[172:175], v[212:215], v[232:235]
  v_mfma_f32_16x16x32_bf16 v[236:239], v[176:179], v[212:215], v[236:239]
  s_cmp_eq_u32 s64, 0
  s_cbranch_scc1 .cm_4
  v_mfma_f32_16x16x32_bf16 v[224:227], v[164:167], v[212:215], v[224:227]
  v_mfma_f32_16x16x32_bf16 v[228:231], v[168:171], v[212:215], v[228:231]
.cm_4:
  s_waitcnt lgkmcnt(0)
  v_mfma_f32_16x16x32_bf16 v[4:7], v[100:103], v[84:87], v[4:7]
  ds_read_b64_tr_b16 v[140:141], v184 offset:47104
  ds_read_b64_tr_b16 v[142:143], v184 offset:49664
  v_mfma_f32_16x16x32_bf16 v[44:47], v[100:103], v[88:91], v[44:47]
  ds_read_b128 v[92:95], v182 offset:36864
  v_mfma_f32_16x16x32_bf16 v[8:11], v[104:107], v[84:87], v[8:11]
  ds_read_b128 v[96:99], v182 offset:38912
  ds_read_b64_tr_b16 v[144:145], v186 offset:47136
  v_mfma_f32_16x16x32_bf16 v[48:51], v[104:107], v[88:91], v[48:51]
  ds_read_b64_tr_b16 v[146:147], v186 offset:49696
  v_mfma_f32_16x16x32_bf16 v[12:15], v[108:111], v[84:87], v[12:15]
  ds_read_b64_tr_b16 v[148:149], v184 offset:47168
  v_mfma_f32_16x16x32_bf16 v[52:55], v[108:111], v[88:91], v[52:55]
  ds_read_b64_tr_b16 v[150:151], v184 offset:49728
  ds_read_b64_tr_b16 v[152:153], v186 offset:47200
  v_mfma_f32_16x16x32_bf16 v[16:19], v[112:115], v[84:87], v[16:19]
  ds_read_b64_tr_b16 v[154:155], v186 offset:49760
  v_mfma_f32_16x16x32_bf16 v[56:59], v[112:115], v[88:91], v[56:59]
  ds_read_b64_tr_b16 v[156:157], v184 offset:47232
  v_mfma_f32_16x16x32_bf16 v[20:23], v[116:119], v[84:87], v[20:23]
  ds_read_b64_tr_b16 v[158:159], v184 offset:49792
  ds_read_b64_tr_b16 v[160:161], v186 offset:47264
  v_mfma_f32_16x16x32_bf16 v[60:63], v[116:119], v[88:91], v[60:63]
  ds_read_b64_tr_b16 v[162:163], v186 offset:49824
  v_mfma_f32_16x16x32_bf16 v[24:27], v[120:123], v[84:87], v[24:27]
  ds_read_b64_tr_b16 v[164:165], v184 offset:47296
  ds_read_b64_tr_b16 v[166:167], v184 offset:49856
  v_mfma_f32_16x16x32_bf16 v[64:67], v[120:123], v[88:91], v[64:67]
  ds_read_b64_tr_b16 v[168:169], v186 offset:47328
  v_mfma_f32_16x16x32_bf16 v[28:31], v[124:127], v[84:87], v[28:31]
  ds_read_b64_tr_b16 v[170:171], v186 offset:49888
  v_mfma_f32_16x16x32_bf16 v[68:71], v[124:127], v[88:91], v[68:71]
  ds_read_b64_tr_b16 v[172:173], v184 offset:47360
  ds_read_b64_tr_b16 v[174:175], v184 offset:49920
  v_mfma_f32_16x16x32_bf16 v[32:35], v[128:131], v[84:87], v[32:35]
  ds_read_b64_tr_b16 v[176:177], v186 offset:47392
  v_mfma_f32_16x16x32_bf16 v[72:75], v[128:131], v[88:91], v[72:75]
  ds_read_b64_tr_b16 v[178:179], v186 offset:49952
  v_mfma_f32_16x16x32_bf16 v[36:39], v[132:135], v[84:87], v[36:39]
  v_mfma_f32_16x16x32_bf16 v[76:79], v[132:135], v[88:91], v[76:79]
  v_mfma_f32_16x16x32_bf16 v[40:43], v[136:139], v[84:87], v[40:43]
  v_mfma_f32_16x16x32_bf16 v[80:83], v[136:139], v[88:91], v[80:83]
  s_cmp_lg_u32 s21, 2
  s_cbranch_scc1 .cm_5
  v_mfma_f32_16x16x32_bf16 v[232:235], v[132:135], v[212:215], v[232:235]
  v_mfma_f32_16x16x32_bf16 v[236:239], v[136:139], v[212:215], v[236:239]
  s_cmp_eq_u32 s64, 0
  s_cbranch_scc1 .cm_5
  v_mfma_f32_16x16x32_bf16 v[224:227], v[124:127], v[212:215], v[224:227]
  v_mfma_f32_16x16x32_bf16 v[228:231], v[128:131], v[212:215], v[228:231]
.cm_5:
  s_waitcnt lgkmcnt(0)
  s_barrier
  v_mfma_f32_16x16x32_bf16 v[4:7], v[140:143], v[92:95], v[4:7]
  ds_read_b64_tr_b16 v[100:101], v185 offset:0
  ds_read_b64_tr_b16 v[102:103], v185 offset:2560
  v_mfma_f32_16x16x32_bf16 v[44:47], v[140:143], v[96:99], v[44:47]
  ds_read_b128 v[84:87], v181 offset:0
  v_mfma_f32_16x16x32_bf16 v[8:11], v[144:147], v[92:95], v[8:11]
  ds_read_b128 v[88:91], v181 offset:2048
  ds_read_b64_tr_b16 v[104:105], v187 offset:32
  v_mfma_f32_16x16x32_bf16 v[48:51], v[144:147], v[96:99], v[48:51]
  ds_read_b64_tr_b16 v[106:107], v187 offset:2592
  v_mfma_f32_16x16x32_bf16 v[12:15], v[148:151], v[92:95], v[12:15]
  ds_read_b64_tr_b16 v[108:109], v185 offset:64
  v_mfma_f32_16x16x32_bf16 v[52:55], v[148:151], v[96:99], v[52:55]
  ds_read_b64_tr_b16 v[110:111], v185 offset:2624
  ds_read_b64_tr_b16 v[112:113], v187 offset:96
  v_mfma_f32_16x16x32_bf16 v[16:19], v[152:155], v[92:95], v[16:19]
  ds_read_b64_tr_b16 v[114:115], v187 offset:2656
  v_mfma_f32_16x16x32_bf16 v[56:59], v[152:155], v[96:99], v[56:59]
  ds_read_b64_tr_b16 v[116:117], v185 offset:128
  v_mfma_f32_16x16x32_bf16 v[20:23], v[156:159], v[92:95], v[20:23]
  ds_read_b64_tr_b16 v[118:119], v185 offset:2688
  ds_read_b64_tr_b16 v[120:121], v187 offset:160
  v_mfma_f32_16x16x32_bf16 v[60:63], v[156:159], v[96:99], v[60:63]
  ds_read_b64_tr_b16 v[122:123], v187 offset:2720
  v_mfma_f32_16x16x32_bf16 v[24:27], v[160:163], v[92:95], v[24:27]
  ds_read_b64_tr_b16 v[124:125], v185 offset:192
  ds_read_b64_tr_b16 v[126:127], v185 offset:2752
  v_mfma_f32_16x16x32_bf16 v[64:67], v[160:163], v[96:99], v[64:67]
  ds_read_b64_tr_b16 v[128:129], v187 offset:224
  v_mfma_f32_16x16x32_bf16 v[28:31], v[164:167], v[92:95], v[28:31]
  ds_read_b64_tr_b16 v[130:131], v187 offset:2784
  v_mfma_f32_16x16x32_bf16 v[68:71], v[164:167], v[96:99], v[68:71]
  ds_read_b64_tr_b16 v[132:133], v185 offset:256
  ds_read_b64_tr_b16 v[134:135], v185 offset:2816
  v_mfma_f32_16x16x32_bf16 v[32:35], v[168:171], v[92:95], v[32:35]
  ds_read_b64_tr_b16 v[136:137], v187 offset:288
  v_mfma_f32_16x16x32_bf16 v[72:75], v[168:171], v[96:99], v[72:75]
  ds_read_b64_tr_b16 v[138:139], v187 offset:2848
  v_mfma_f32_16x16x32_bf16 v[36:39], v[172:175], v[92:95], v[36:39]
  v_mfma_f32_16x16x32_bf16 v[76:79], v[172:175], v[96:99], v[76:79]
  v_mfma_f32_16x16x32_bf16 v[40:43], v[176:179], v[92:95], v[40:43]
  v_mfma_f32_16x16x32_bf16 v[80:83], v[176:179], v[96:99], v[80:83]
  s_cmp_lg_u32 s21, 3
  s_cbranch_scc1 .cm_6
  v_mfma_f32_16x16x32_bf16 v[232:235], v[172:175], v[212:215], v[232:235]
  v_mfma_f32_16x16x32_bf16 v[236:239], v[176:179], v[212:215], v[236:239]
  s_cmp_eq_u32 s64, 0
  s_cbranch_scc1 .cm_6
  v_mfma_f32_16x16x32_bf16 v[224:227], v[164:167], v[212:215], v[224:227]
  v_mfma_f32_16x16x32_bf16 v[228:231], v[168:171], v[212:215], v[228:231]
.cm_6:
  s_waitcnt lgkmcnt(0)
  v_mfma_f32_16x16x32_bf16 v[4:7], v[100:103], v[84:87], v[4:7]
  ds_read_b64_tr_b16 v[140:141], v185 offset:10240
  ds_read_b64_tr_b16 v[142:143], v185 offset:12800
  v_mfma_f32_16x16x32_bf16 v[44:47], v[100:103], v[88:91], v[44:47]
  ds_read_b128 v[92:95], v183 offset:0
  v_mfma_f32_16x16x32_bf16 v[8:11], v[104:107], v[84:87], v[8:11]
  ds_read_b128 v[96:99], v183 offset:2048
  ds_read_b64_tr_b16 v[144:145], v187 offset:10272
  v_mfma_f32_16x16x32_bf16 v[48:51], v[104:107], v[88:91], v[48:51]
  ds_read_b64_tr_b16 v[146:147], v187 offset:12832
  v_mfma_f32_16x16x32_bf16 v[12:15], v[108:111], v[84:87], v[12:15]
  ds_read_b64_tr_b16 v[148:149], v185 offset:10304
  v_mfma_f32_16x16x32_bf16 v[52:55], v[108:111], v[88:91], v[52:55]
  ds_read_b64_tr_b16 v[150:151], v185 offset:12864
  ds_read_b64_tr_b16 v[152:153], v187 offset:10336
  v_mfma_f32_16x16x32_bf16 v[16:19], v[112:115], v[84:87], v[16:19]
  ds_read_b64_tr_b16 v[154:155], v187 offset:12896
  v_mfma_f32_16x16x32_bf16 v[56:59], v[112:115], v[88:91], v[56:59]
  ds_read_b64_tr_b16 v[156:157], v185 offset:10368
  v_mfma_f32_16x16x32_bf16 v[20:23], v[116:119], v[84:87], v[20:23]
  ds_read_b64_tr_b16 v[158:159], v185 offset:12928
  ds_read_b64_tr_b16 v[160:161], v187 offset:10400
  v_mfma_f32_16x16x32_bf16 v[60:63], v[116:119], v[88:91], v[60:63]
  ds_read_b64_tr_b16 v[162:163], v187 offset:12960
  v_mfma_f32_16x16x32_bf16 v[24:27], v[120:123], v[84:87], v[24:27]
  ds_read_b64_tr_b16 v[164:165], v185 offset:10432
  ds_read_b64_tr_b16 v[166:167], v185 offset:12992
  v_mfma_f32_16x16x32_bf16 v[64:67], v[120:123], v[88:91], v[64:67]
  ds_read_b64_tr_b16 v[168:169], v187 offset:10464
  v_mfma_f32_16x16x32_bf16 v[28:31], v[124:127], v[84:87], v[28:31]
  ds_read_b64_tr_b16 v[170:171], v187 offset:13024
  v_mfma_f32_16x16x32_bf16 v[68:71], v[124:127], v[88:91], v[68:71]
  ds_read_b64_tr_b16 v[172:173], v185 offset:10496
  ds_read_b64_tr_b16 v[174:175], v185 offset:13056
  v_mfma_f32_16x16x32_bf16 v[32:35], v[128:131], v[84:87], v[32:35]
  ds_read_b64_tr_b16 v[176:177], v187 offset:10528
  v_mfma_f32_16x16x32_bf16 v[72:75], v[128:131], v[88:91], v[72:75]
  ds_read_b64_tr_b16 v[178:179], v187 offset:13088
  v_mfma_f32_16x16x32_bf16 v[36:39], v[132:135], v[84:87], v[36:39]
  v_mfma_f32_16x16x32_bf16 v[76:79], v[132:135], v[88:91], v[76:79]
  v_mfma_f32_16x16x32_bf16 v[40:43], v[136:139], v[84:87], v[40:43]
  v_mfma_f32_16x16x32_bf16 v[80:83], v[136:139], v[88:91], v[80:83]
  s_cmp_lg_u32 s21, 0
  s_cbranch_scc1 .cm_7
  v_mfma_f32_16x16x32_bf16 v[232:235], v[132:135], v[212:215], v[232:235]
  v_mfma_f32_16x16x32_bf16 v[236:239], v[136:139], v[212:215], v[236:239]
  s_cmp_eq_u32 s64, 0
  s_cbranch_scc1 .cm_7
  v_mfma_f32_16x16x32_bf16 v[224:227], v[124:127], v[212:215], v[224:227]
  v_mfma_f32_16x16x32_bf16 v[228:231], v[128:131], v[212:215], v[228:231]
.cm_7:
  s_waitcnt lgkmcnt(0)
  s_barrier
  v_mfma_f32_16x16x32_bf16 v[4:7], v[140:143], v[92:95], v[4:7]
  ds_read_b64_tr_b16 v[100:101], v185 offset:36864
  ds_read_b64_tr_b16 v[102:103], v185 offset:39424
  v_mfma_f32_16x16x32_bf16 v[44:47], v[140:143], v[96:99], v[44:47]
  ds_read_b128 v[84:87], v181 offset:36864
  v_mfma_f32_16x16x32_bf16 v[8:11], v[144:147], v[92:95], v[8:11]
  ds_read_b128 v[88:91], v181 offset:38912
  ds_read_b64_tr_b16 v[104:105], v187 offset:36896
  v_mfma_f32_16x16x32_bf16 v[48:51], v[144:147], v[96:99], v[48:51]
  ds_read_b64_tr_b16 v[106:107], v187 offset:39456
  v_mfma_f32_16x16x32_bf16 v[12:15], v[148:151], v[92:95], v[12:15]
  ds_read_b64_tr_b16 v[108:109], v185 offset:36928
  v_mfma_f32_16x16x32_bf16 v[52:55], v[148:151], v[96:99], v[52:55]
  ds_read_b64_tr_b16 v[110:111], v185 offset:39488
  ds_read_b64_tr_b16 v[112:113], v187 offset:36960
  v_mfma_f32_16x16x32_bf16 v[16:19], v[152:155], v[92:95], v[16:19]
  ds_read_b64_tr_b16 v[114:115], v187 offset:39520
  v_mfma_f32_16x16x32_bf16 v[56:59], v[152:155], v[96:99], v[56:59]
  ds_read_b64_tr_b16 v[116:117], v185 offset:36992
  v_mfma_f32_16x16x32_bf16 v[20:23], v[156:159], v[92:95], v[20:23]
  ds_read_b64_tr_b16 v[118:119], v185 offset:39552
  ds_read_b64_tr_b16 v[120:121], v187 offset:37024
  v_mfma_f32_16x16x32_bf16 v[60:63], v[156:159], v[96:99], v[60:63]
  ds_read_b64_tr_b16 v[122:123], v187 offset:39584
  v_mfma_f32_16x16x32_bf16 v[24:27], v[160:163], v[92:95], v[24:27]
  ds_read_b64_tr_b16 v[124:125], v185 offset:37056
  ds_read_b64_tr_b16 v[126:127], v185 offset:39616
  v_mfma_f32_16x16x32_bf16 v[64:67], v[160:163], v[96:99], v[64:67]
  ds_read_b64_tr_b16 v[128:129], v187 offset:37088
  v_mfma_f32_16x16x32_bf16 v[28:31], v[164:167], v[92:95], v[28:31]
  ds_read_b64_tr_b16 v[130:131], v187 offset:39648
  v_mfma_f32_16x16x32_bf16 v[68:71], v[164:167], v[96:99], v[68:71]
  ds_read_b64_tr_b16 v[132:133], v185 offset:37120
  ds_read_b64_tr_b16 v[134:135], v185 offset:39680
  v_mfma_f32_16x16x32_bf16 v[32:35], v[168:171], v[92:95], v[32:35]
  ds_read_b64_tr_b16 v[136:137], v187 offset:37152
  v_mfma_f32_16x16x32_bf16 v[72:75], v[168:171], v[96:99], v[72:75]
  ds_read_b64_tr_b16 v[138:139], v187 offset:39712
  v_mfma_f32_16x16x32_bf16 v[36:39], v[172:175], v[92:95], v[36:39]
  v_mfma_f32_16x16x32_bf16 v[76:79], v[172:175], v[96:99], v[76:79]
  v_mfma_f32_16x16x32_bf16 v[40:43], v[176:179], v[92:95], v[40:43]
  v_mfma_f32_16x16x32_bf16 v[80:83], v[176:179], v[96:99], v[80:83]
  s_cmp_lg_u32 s21, 1
  s_cbranch_scc1 .cm_8
  v_mfma_f32_16x16x32_bf16 v[232:235], v[172:175], v[212:215], v[232:235]
  v_mfma_f32_16x16x32_bf16 v[236:239], v[176:179], v[212:215], v[236:239]
  s_cmp_eq_u32 s64, 0
  s_cbranch_scc1 .cm_8
  v_mfma_f32_16x16x32_bf16 v[224:227], v[164:167], v[212:215], v[224:227]
  v_mfma_f32_16x16x32_bf16 v[228:231], v[168:171], v[212:215], v[228:231]
.cm_8:
  s_waitcnt lgkmcnt(0)
  v_mfma_f32_16x16x32_bf16 v[4:7], v[100:103], v[84:87], v[4:7]
  ds_read_b64_tr_b16 v[140:141], v185 offset:47104
  ds_read_b64_tr_b16 v[142:143], v185 offset:49664
  v_mfma_f32_16x16x32_bf16 v[44:47], v[100:103], v[88:91], v[44:47]
  ds_read_b128 v[92:95], v183 offset:36864
  v_mfma_f32_16x16x32_bf16 v[8:11], v[104:107], v[84:87], v[8:11]
  ds_read_b128 v[96:99], v183 offset:38912
  ds_read_b64_tr_b16 v[144:145], v187 offset:47136
  v_mfma_f32_16x16x32_bf16 v[48:51], v[104:107], v[88:91], v[48:51]
  ds_read_b64_tr_b16 v[146:147], v187 offset:49696
  v_mfma_f32_16x16x32_bf16 v[12:15], v[108:111], v[84:87], v[12:15]
  ds_read_b64_tr_b16 v[148:149], v185 offset:47168
  v_mfma_f32_16x16x32_bf16 v[52:55], v[108:111], v[88:91], v[52:55]
  ds_read_b64_tr_b16 v[150:151], v185 offset:49728
  ds_read_b64_tr_b16 v[152:153], v187 offset:47200
  v_mfma_f32_16x16x32_bf16 v[16:19], v[112:115], v[84:87], v[16:19]
  ds_read_b64_tr_b16 v[154:155], v187 offset:49760
  v_mfma_f32_16x16x32_bf16 v[56:59], v[112:115], v[88:91], v[56:59]
  ds_read_b64_tr_b16 v[156:157], v185 offset:47232
  v_mfma_f32_16x16x32_bf16 v[20:23], v[116:119], v[84:87], v[20:23]
  ds_read_b64_tr_b16 v[158:159], v185 offset:49792
  ds_read_b64_tr_b16 v[160:161], v187 offset:47264
  v_mfma_f32_16x16x32_bf16 v[60:63], v[116:119], v[88:91], v[60:63]
  ds_read_b64_tr_b16 v[162:163], v187 offset:49824
  v_mfma_f32_16x16x32_bf16 v[24:27], v[120:123], v[84:87], v[24:27]
  ds_read_b64_tr_b16 v[164:165], v185 offset:47296
  ds_read_b64_tr_b16 v[166:167], v185 offset:49856
  v_mfma_f32_16x16x32_bf16 v[64:67], v[120:123], v[88:91], v[64:67]
  ds_read_b64_tr_b16 v[168:169], v187 offset:47328
  v_mfma_f32_16x16x32_bf16 v[28:31], v[124:127], v[84:87], v[28:31]
  ds_read_b64_tr_b16 v[170:171], v187 offset:49888
  v_mfma_f32_16x16x32_bf16 v[68:71], v[124:127], v[88:91], v[68:71]
  ds_read_b64_tr_b16 v[172:173], v185 offset:47360
  ds_read_b64_tr_b16 v[174:175], v185 offset:49920
  v_mfma_f32_16x16x32_bf16 v[32:35], v[128:131], v[84:87], v[32:35]
  ds_read_b64_tr_b16 v[176:177], v187 offset:47392
  v_mfma_f32_16x16x32_bf16 v[72:75], v[128:131], v[88:91], v[72:75]
  ds_read_b64_tr_b16 v[178:179], v187 offset:49952
  v_mfma_f32_16x16x32_bf16 v[36:39], v[132:135], v[84:87], v[36:39]
  v_mfma_f32_16x16x32_bf16 v[76:79], v[132:135], v[88:91], v[76:79]
  v_mfma_f32_16x16x32_bf16 v[40:43], v[136:139], v[84:87], v[40:43]
  v_mfma_f32_16x16x32_bf16 v[80:83], v[136:139], v[88:91], v[80:83]
  s_cmp_lg_u32 s21, 2
  s_cbranch_scc1 .cm_9
  v_mfma_f32_16x16x32_bf16 v[232:235], v[132:135], v[212:215], v[232:235]
  v_mfma_f32_16x16x32_bf16 v[236:239], v[136:139], v[212:215], v[236:239]
  s_cmp_eq_u32 s64, 0
  s_cbranch_scc1 .cm_9
  v_mfma_f32_16x16x32_bf16 v[224:227], v[124:127], v[212:215], v[224:227]
  v_mfma_f32_16x16x32_bf16 v[228:231], v[128:131], v[212:215], v[228:231]
.cm_9:
  s_waitcnt vmcnt(0) lgkmcnt(0)
  s_barrier
  v_mfma_f32_16x16x32_bf16 v[4:7], v[140:143], v[92:95], v[4:7]
  ds_read_b64_tr_b16 v[100:101], v184 offset:0
  ds_read_b64_tr_b16 v[102:103], v184 offset:2560
  v_mfma_f32_16x16x32_bf16 v[44:47], v[140:143], v[96:99], v[44:47]
  ds_read_b128 v[84:87], v180 offset:0
  v_mfma_f32_16x16x32_bf16 v[8:11], v[144:147], v[92:95], v[8:11]
  ds_read_b128 v[88:91], v180 offset:2048
  ds_read_b64_tr_b16 v[104:105], v186 offset:32
  v_mfma_f32_16x16x32_bf16 v[48:51], v[144:147], v[96:99], v[48:51]
  ds_read_b64_tr_b16 v[106:107], v186 offset:2592
  v_mfma_f32_16x16x32_bf16 v[12:15], v[148:151], v[92:95], v[12:15]
  ds_read_b64_tr_b16 v[108:109], v184 offset:64
  v_mfma_f32_16x16x32_bf16 v[52:55], v[148:151], v[96:99], v[52:55]
  ds_read_b64_tr_b16 v[110:111], v184 offset:2624
  ds_read_b64_tr_b16 v[112:113], v186 offset:96
  v_mfma_f32_16x16x32_bf16 v[16:19], v[152:155], v[92:95], v[16:19]
  ds_read_b64_tr_b16 v[114:115], v186 offset:2656
  v_mfma_f32_16x16x32_bf16 v[56:59], v[152:155], v[96:99], v[56:59]
  ds_read_b64_tr_b16 v[116:117], v184 offset:128
  v_mfma_f32_16x16x32_bf16 v[20:23], v[156:159], v[92:95], v[20:23]
  ds_read_b64_tr_b16 v[118:119], v184 offset:2688
  ds_read_b64_tr_b16 v[120:121], v186 offset:160
  v_mfma_f32_16x16x32_bf16 v[60:63], v[156:159], v[96:99], v[60:63]
  ds_read_b64_tr_b16 v[122:123], v186 offset:2720
  v_mfma_f32_16x16x32_bf16 v[24:27], v[160:163], v[92:95], v[24:27]
  ds_read_b64_tr_b16 v[124:125], v184 offset:192
  ds_read_b64_tr_b16 v[126:127], v184 offset:2752
  v_mfma_f32_16x16x32_bf16 v[64:67], v[160:163], v[96:99], v[64:67]
  ds_read_b64_tr_b16 v[128:129], v186 offset:224
  v_mfma_f32_16x16x32_bf16 v[28:31], v[164:167], v[92:95], v[28:31]
  ds_read_b64_tr_b16 v[130:131], v186 offset:2784
  v_mfma_f32_16x16x32_bf16 v[68:71], v[164:167], v[96:99], v[68:71]
  ds_read_b64_tr_b16 v[132:133], v184 offset:256
  ds_read_b64_tr_b16 v[134:135], v184 offset:2816
  v_mfma_f32_16x16x32_bf16 v[32:35], v[168:171], v[92:95], v[32:35]
  ds_read_b64_tr_b16 v[136:137], v186 offset:288
  v_mfma_f32_16x16x32_bf16 v[72:75], v[168:171], v[96:99], v[72:75]
  ds_read_b64_tr_b16 v[138:139], v186 offset:2848
  v_mfma_f32_16x16x32_bf16 v[36:39], v[172:175], v[92:95], v[36:39]
  v_mfma_f32_16x16x32_bf16 v[76:79], v[172:175], v[96:99], v[76:79]
  v_mfma_f32_16x16x32_bf16 v[40:43], v[176:179], v[92:95], v[40:43]
  v_mfma_f32_16x16x32_bf16 v[80:83], v[176:179], v[96:99], v[80:83]
  s_cmp_lg_u32 s21, 3
  s_cbranch_scc1 .cm_10
  v_mfma_f32_16x16x32_bf16 v[232:235], v[172:175], v[212:215], v[232:235]
  v_mfma_f32_16x16x32_bf16 v[236:239], v[176:179], v[212:215], v[236:239]
  s_cmp_eq_u32 s64, 0
  s_cbranch_scc1 .cm_10
  v_mfma_f32_16x16x32_bf16 v[224:227], v[164:167], v[212:215], v[224:227]
  v_mfma_f32_16x16x32_bf16 v[228:231], v[168:171], v[212:215], v[228:231]
.cm_10:
  s_waitcnt lgkmcnt(0)
  v_mfma_f32_16x16x32_bf16 v[4:7], v[100:103], v[84:87], v[4:7]
  ds_read_b64_tr_b16 v[140:141], v184 offset:10240
  ds_read_b64_tr_b16 v[142:143], v184 offset:12800
  v_mfma_f32_16x16x32_bf16 v[44:47], v[100:103], v[88:91], v[44:47]
  ds_read_b128 v[92:95], v182 offset:0
  v_mfma_f32_16x16x32_bf16 v[8:11], v[104:107], v[84:87], v[8:11]
  ds_read_b128 v[96:99], v182 offset:2048
  ds_read_b64_tr_b16 v[144:145], v186 offset:10272
  v_mfma_f32_16x16x32_bf16 v[48:51], v[104:107], v[88:91], v[48:51]
  ds_read_b64_tr_b16 v[146:147], v186 offset:12832
  v_mfma_f32_16x16x32_bf16 v[12:15], v[108:111], v[84:87], v[12:15]
  ds_read_b64_tr_b16 v[148:149], v184 offset:10304
  v_mfma_f32_16x16x32_bf16 v[52:55], v[108:111], v[88:91], v[52:55]
  ds_read_b64_tr_b16 v[150:151], v184 offset:12864
  ds_read_b64_tr_b16 v[152:153], v186 offset:10336
  v_mfma_f32_16x16x32_bf16 v[16:19], v[112:115], v[84:87], v[16:19]
  ds_read_b64_tr_b16 v[154:155], v186 offset:12896
  v_mfma_f32_16x16x32_bf16 v[56:59], v[112:115], v[88:91], v[56:59]
  ds_read_b64_tr_b16 v[156:157], v184 offset:10368
  v_mfma_f32_16x16x32_bf16 v[20:23], v[116:119], v[84:87], v[20:23]
  ds_read_b64_tr_b16 v[158:159], v184 offset:12928
  ds_read_b64_tr_b16 v[160:161], v186 offset:10400
  v_mfma_f32_16x16x32_bf16 v[60:63], v[116:119], v[88:91], v[60:63]
  ds_read_b64_tr_b16 v[162:163], v186 offset:12960
  v_mfma_f32_16x16x32_bf16 v[24:27], v[120:123], v[84:87], v[24:27]
  ds_read_b64_tr_b16 v[164:165], v184 offset:10432
  ds_read_b64_tr_b16 v[166:167], v184 offset:12992
  v_mfma_f32_16x16x32_bf16 v[64:67], v[120:123], v[88:91], v[64:67]
  ds_read_b64_tr_b16 v[168:169], v186 offset:10464
  v_mfma_f32_16x16x32_bf16 v[28:31], v[124:127], v[84:87], v[28:31]
  ds_read_b64_tr_b16 v[170:171], v186 offset:13024
  v_mfma_f32_16x16x32_bf16 v[68:71], v[124:127], v[88:91], v[68:71]
  ds_read_b64_tr_b16 v[172:173], v184 offset:10496
  ds_read_b64_tr_b16 v[174:175], v184 offset:13056
  v_mfma_f32_16x16x32_bf16 v[32:35], v[128:131], v[84:87], v[32:35]
  ds_read_b64_tr_b16 v[176:177], v186 offset:10528
  v_mfma_f32_16x16x32_bf16 v[72:75], v[128:131], v[88:91], v[72:75]
  ds_read_b64_tr_b16 v[178:179], v186 offset:13088
  v_mfma_f32_16x16x32_bf16 v[36:39], v[132:135], v[84:87], v[36:39]
  v_mfma_f32_16x16x32_bf16 v[76:79], v[132:135], v[88:91], v[76:79]
  v_mfma_f32_16x16x32_bf16 v[40:43], v[136:139], v[84:87], v[40:43]
  v_mfma_f32_16x16x32_bf16 v[80:83], v[136:139], v[88:91], v[80:83]
  s_cmp_lg_u32 s21, 0
  s_cbranch_scc1 .cm_11
  v_mfma_f32_16x16x32_bf16 v[232:235], v[132:135], v[212:215], v[232:235]
  v_mfma_f32_16x16x32_bf16 v[236:239], v[136:139], v[212:215], v[236:239]
  s_cmp_eq_u32 s64, 0
  s_cbranch_scc1 .cm_11
  v_mfma_f32_16x16x32_bf16 v[224:227], v[124:127], v[212:215], v[224:227]
  v_mfma_f32_16x16x32_bf16 v[228:231], v[128:131], v[212:215], v[228:231]
.cm_11:
  s_waitcnt lgkmcnt(0)
  s_barrier
  v_mfma_f32_16x16x32_bf16 v[4:7], v[140:143], v[92:95], v[4:7]
  ds_read_b64_tr_b16 v[100:101], v184 offset:36864
  ds_read_b64_tr_b16 v[102:103], v184 offset:39424
  v_mfma_f32_16x16x32_bf16 v[44:47], v[140:143], v[96:99], v[44:47]
  ds_read_b128 v[84:87], v180 offset:36864
  v_mfma_f32_16x16x32_bf16 v[8:11], v[144:147], v[92:95], v[8:11]
  ds_read_b128 v[88:91], v180 offset:38912
  ds_read_b64_tr_b16 v[104:105], v186 offset:36896
  v_mfma_f32_16x16x32_bf16 v[48:51], v[144:147], v[96:99], v[48:51]
  ds_read_b64_tr_b16 v[106:107], v186 offset:39456
  v_mfma_f32_16x16x32_bf16 v[12:15], v[148:151], v[92:95], v[12:15]
  ds_read_b64_tr_b16 v[108:109], v184 offset:36928
  v_mfma_f32_16x16x32_bf16 v[52:55], v[148:151], v[96:99], v[52:55]
  ds_read_b64_tr_b16 v[110:111], v184 offset:39488
  ds_read_b64_tr_b16 v[112:113], v186 offset:36960
  v_mfma_f32_16x16x32_bf16 v[16:19], v[152:155], v[92:95], v[16:19]
  ds_read_b64_tr_b16 v[114:115], v186 offset:39520
  v_mfma_f32_16x16x32_bf16 v[56:59], v[152:155], v[96:99], v[56:59]
  ds_read_b64_tr_b16 v[116:117], v184 offset:36992
  v_mfma_f32_16x16x32_bf16 v[20:23], v[156:159], v[92:95], v[20:23]
  ds_read_b64_tr_b16 v[118:119], v184 offset:39552
  ds_read_b64_tr_b16 v[120:121], v186 offset:37024
  v_mfma_f32_16x16x32_bf16 v[60:63], v[156:159], v[96:99], v[60:63]
  ds_read_b64_tr_b16 v[122:123], v186 offset:39584
  v_mfma_f32_16x16x32_bf16 v[24:27], v[160:163], v[92:95], v[24:27]
  ds_read_b64_tr_b16 v[124:125], v184 offset:37056
  ds_read_b64_tr_b16 v[126:127], v184 offset:39616
  v_mfma_f32_16x16x32_bf16 v[64:67], v[160:163], v[96:99], v[64:67]
  ds_read_b64_tr_b16 v[128:129], v186 offset:37088
  v_mfma_f32_16x16x32_bf16 v[28:31], v[164:167], v[92:95], v[28:31]
  ds_read_b64_tr_b16 v[130:131], v186 offset:39648
  v_mfma_f32_16x16x32_bf16 v[68:71], v[164:167], v[96:99], v[68:71]
  ds_read_b64_tr_b16 v[132:133], v184 offset:37120
  ds_read_b64_tr_b16 v[134:135], v184 offset:39680
  v_mfma_f32_16x16x32_bf16 v[32:35], v[168:171], v[92:95], v[32:35]
  ds_read_b64_tr_b16 v[136:137], v186 offset:37152
  v_mfma_f32_16x16x32_bf16 v[72:75], v[168:171], v[96:99], v[72:75]
  ds_read_b64_tr_b16 v[138:139], v186 offset:39712
  v_mfma_f32_16x16x32_bf16 v[36:39], v[172:175], v[92:95], v[36:39]
  v_mfma_f32_16x16x32_bf16 v[76:79], v[172:175], v[96:99], v[76:79]
  v_mfma_f32_16x16x32_bf16 v[40:43], v[176:179], v[92:95], v[40:43]
  v_mfma_f32_16x16x32_bf16 v[80:83], v[176:179], v[96:99], v[80:83]
  s_cmp_lg_u32 s21, 1
  s_cbranch_scc1 .cm_12
  v_mfma_f32_16x16x32_bf16 v[232:235], v[172:175], v[212:215], v[232:235]
  v_mfma_f32_16x16x32_bf16 v[236:239], v[176:179], v[212:215], v[236:239]
  s_cmp_eq_u32 s64, 0
  s_cbranch_scc1 .cm_12
  v_mfma_f32_16x16x32_bf16 v[224:227], v[164:167], v[212:215], v[224:227]
  v_mfma_f32_16x16x32_bf16 v[228:231], v[168:171], v[212:215], v[228:231]
.cm_12:
  s_waitcnt lgkmcnt(0)
  v_mfma_f32_16x16x32_bf16 v[4:7], v[100:103], v[84:87], v[4:7]
  ds_read_b64_tr_b16 v[140:141], v184 offset:47104
  ds_read_b64_tr_b16 v[142:143], v184 offset:49664
  v_mfma_f32_16x16x32_bf16 v[44:47], v[100:103], v[88:91], v[44:47]
  ds_read_b128 v[92:95], v182 offset:36864
  v_mfma_f32_16x16x32_bf16 v[8:11], v[104:107], v[84:87], v[8:11]
  ds_read_b128 v[96:99], v182 offset:38912
  ds_read_b64_tr_b16 v[144:145], v186 offset:47136
  v_mfma_f32_16x16x32_bf16 v[48:51], v[104:107], v[88:91], v[48:51]
  ds_read_b64_tr_b16 v[146:147], v186 offset:49696
  v_mfma_f32_16x16x32_bf16 v[12:15], v[108:111], v[84:87], v[12:15]
  ds_read_b64_tr_b16 v[148:149], v184 offset:47168
  v_mfma_f32_16x16x32_bf16 v[52:55], v[108:111], v[88:91], v[52:55]
  ds_read_b64_tr_b16 v[150:151], v184 offset:49728
  ds_read_b64_tr_b16 v[152:153], v186 offset:47200
  v_mfma_f32_16x16x32_bf16 v[16:19], v[112:115], v[84:87], v[16:19]
  ds_read_b64_tr_b16 v[154:155], v186 offset:49760
  v_mfma_f32_16x16x32_bf16 v[56:59], v[112:115], v[88:91], v[56:59]
  ds_read_b64_tr_b16 v[156:157], v184 offset:47232
  v_mfma_f32_16x16x32_bf16 v[20:23], v[116:119], v[84:87], v[20:23]
  ds_read_b64_tr_b16 v[158:159], v184 offset:49792
  ds_read_b64_tr_b16 v[160:161], v186 offset:47264
  v_mfma_f32_16x16x32_bf16 v[60:63], v[116:119], v[88:91], v[60:63]
  ds_read_b64_tr_b16 v[162:163], v186 offset:49824
  v_mfma_f32_16x16x32_bf16 v[24:27], v[120:123], v[84:87], v[24:27]
  ds_read_b64_tr_b16 v[164:165], v184 offset:47296
  ds_read_b64_tr_b16 v[166:167], v184 offset:49856
  v_mfma_f32_16x16x32_bf16 v[64:67], v[120:123], v[88:91], v[64:67]
  ds_read_b64_tr_b16 v[168:169], v186 offset:47328
  v_mfma_f32_16x16x32_bf16 v[28:31], v[124:127], v[84:87], v[28:31]
  ds_read_b64_tr_b16 v[170:171], v186 offset:49888
  v_mfma_f32_16x16x32_bf16 v[68:71], v[124:127], v[88:91], v[68:71]
  ds_read_b64_tr_b16 v[172:173], v184 offset:47360
  ds_read_b64_tr_b16 v[174:175], v184 offset:49920
  v_mfma_f32_16x16x32_bf16 v[32:35], v[128:131], v[84:87], v[32:35]
  ds_read_b64_tr_b16 v[176:177], v186 offset:47392
  v_mfma_f32_16x16x32_bf16 v[72:75], v[128:131], v[88:91], v[72:75]
  ds_read_b64_tr_b16 v[178:179], v186 offset:49952
  v_mfma_f32_16x16x32_bf16 v[36:39], v[132:135], v[84:87], v[36:39]
  v_mfma_f32_16x16x32_bf16 v[76:79], v[132:135], v[88:91], v[76:79]
  v_mfma_f32_16x16x32_bf16 v[40:43], v[136:139], v[84:87], v[40:43]
  v_mfma_f32_16x16x32_bf16 v[80:83], v[136:139], v[88:91], v[80:83]
  s_cmp_lg_u32 s21, 2
  s_cbranch_scc1 .cm_13
  v_mfma_f32_16x16x32_bf16 v[232:235], v[132:135], v[212:215], v[232:235]
  v_mfma_f32_16x16x32_bf16 v[236:239], v[136:139], v[212:215], v[236:239]
  s_cmp_eq_u32 s64, 0
  s_cbranch_scc1 .cm_13
  v_mfma_f32_16x16x32_bf16 v[224:227], v[124:127], v[212:215], v[224:227]
  v_mfma_f32_16x16x32_bf16 v[228:231], v[128:131], v[212:215], v[228:231]
.cm_13:
  s_waitcnt lgkmcnt(0)
  s_barrier
  v_mfma_f32_16x16x32_bf16 v[4:7], v[140:143], v[92:95], v[4:7]
  ds_read_b64_tr_b16 v[100:101], v185 offset:0
  ds_read_b64_tr_b16 v[102:103], v185 offset:2560
  v_mfma_f32_16x16x32_bf16 v[44:47], v[140:143], v[96:99], v[44:47]
  ds_read_b128 v[84:87], v181 offset:0
  v_mfma_f32_16x16x32_bf16 v[8:11], v[144:147], v[92:95], v[8:11]
  ds_read_b128 v[88:91], v181 offset:2048
  ds_read_b64_tr_b16 v[104:105], v187 offset:32
  v_mfma_f32_16x16x32_bf16 v[48:51], v[144:147], v[96:99], v[48:51]
  ds_read_b64_tr_b16 v[106:107], v187 offset:2592
  v_mfma_f32_16x16x32_bf16 v[12:15], v[148:151], v[92:95], v[12:15]
  ds_read_b64_tr_b16 v[108:109], v185 offset:64
  v_mfma_f32_16x16x32_bf16 v[52:55], v[148:151], v[96:99], v[52:55]
  ds_read_b64_tr_b16 v[110:111], v185 offset:2624
  ds_read_b64_tr_b16 v[112:113], v187 offset:96
  v_mfma_f32_16x16x32_bf16 v[16:19], v[152:155], v[92:95], v[16:19]
  ds_read_b64_tr_b16 v[114:115], v187 offset:2656
  v_mfma_f32_16x16x32_bf16 v[56:59], v[152:155], v[96:99], v[56:59]
  ds_read_b64_tr_b16 v[116:117], v185 offset:128
  v_mfma_f32_16x16x32_bf16 v[20:23], v[156:159], v[92:95], v[20:23]
  ds_read_b64_tr_b16 v[118:119], v185 offset:2688
  ds_read_b64_tr_b16 v[120:121], v187 offset:160
  v_mfma_f32_16x16x32_bf16 v[60:63], v[156:159], v[96:99], v[60:63]
  ds_read_b64_tr_b16 v[122:123], v187 offset:2720
  v_mfma_f32_16x16x32_bf16 v[24:27], v[160:163], v[92:95], v[24:27]
  ds_read_b64_tr_b16 v[124:125], v185 offset:192
  ds_read_b64_tr_b16 v[126:127], v185 offset:2752
  v_mfma_f32_16x16x32_bf16 v[64:67], v[160:163], v[96:99], v[64:67]
  ds_read_b64_tr_b16 v[128:129], v187 offset:224
  v_mfma_f32_16x16x32_bf16 v[28:31], v[164:167], v[92:95], v[28:31]
  ds_read_b64_tr_b16 v[130:131], v187 offset:2784
  v_mfma_f32_16x16x32_bf16 v[68:71], v[164:167], v[96:99], v[68:71]
  ds_read_b64_tr_b16 v[132:133], v185 offset:256
  ds_read_b64_tr_b16 v[134:135], v185 offset:2816
  v_mfma_f32_16x16x32_bf16 v[32:35], v[168:171], v[92:95], v[32:35]
  ds_read_b64_tr_b16 v[136:137], v187 offset:288
  v_mfma_f32_16x16x32_bf16 v[72:75], v[168:171], v[96:99], v[72:75]
  ds_read_b64_tr_b16 v[138:139], v187 offset:2848
  v_mfma_f32_16x16x32_bf16 v[36:39], v[172:175], v[92:95], v[36:39]
  v_mfma_f32_16x16x32_bf16 v[76:79], v[172:175], v[96:99], v[76:79]
  v_mfma_f32_16x16x32_bf16 v[40:43], v[176:179], v[92:95], v[40:43]
  v_mfma_f32_16x16x32_bf16 v[80:83], v[176:179], v[96:99], v[80:83]
  s_cmp_lg_u32 s21, 3
  s_cbranch_scc1 .cm_14
  v_mfma_f32_16x16x32_bf16 v[232:235], v[172:175], v[212:215], v[232:235]
  v_mfma_f32_16x16x32_bf16 v[236:239], v[176:179], v[212:215], v[236:239]
  s_cmp_eq_u32 s64, 0
  s_cbranch_scc1 .cm_14
  v_mfma_f32_16x16x32_bf16 v[224:227], v[164:167], v[212:215], v[224:227]
  v_mfma_f32_16x16x32_bf16 v[228:231], v[168:171], v[212:215], v[228:231]
.cm_14:
  s_waitcnt lgkmcnt(0)
  v_mfma_f32_16x16x32_bf16 v[4:7], v[100:103], v[84:87], v[4:7]
  ds_read_b64_tr_b16 v[140:141], v185 offset:10240
  ds_read_b64_tr_b16 v[142:143], v185 offset:12800
  v_mfma_f32_16x16x32_bf16 v[44:47], v[100:103], v[88:91], v[44:47]
  ds_read_b128 v[92:95], v183 offset:0
  v_mfma_f32_16x16x32_bf16 v[8:11], v[104:107], v[84:87], v[8:11]
  ds_read_b128 v[96:99], v183 offset:2048
  ds_read_b64_tr_b16 v[144:145], v187 offset:10272
  v_mfma_f32_16x16x32_bf16 v[48:51], v[104:107], v[88:91], v[48:51]
  ds_read_b64_tr_b16 v[146:147], v187 offset:12832
  v_mfma_f32_16x16x32_bf16 v[12:15], v[108:111], v[84:87], v[12:15]
  ds_read_b64_tr_b16 v[148:149], v185 offset:10304
  v_mfma_f32_16x16x32_bf16 v[52:55], v[108:111], v[88:91], v[52:55]
  ds_read_b64_tr_b16 v[150:151], v185 offset:12864
  ds_read_b64_tr_b16 v[152:153], v187 offset:10336
  v_mfma_f32_16x16x32_bf16 v[16:19], v[112:115], v[84:87], v[16:19]
  ds_read_b64_tr_b16 v[154:155], v187 offset:12896
  v_mfma_f32_16x16x32_bf16 v[56:59], v[112:115], v[88:91], v[56:59]
  ds_read_b64_tr_b16 v[156:157], v185 offset:10368
  v_mfma_f32_16x16x32_bf16 v[20:23], v[116:119], v[84:87], v[20:23]
  ds_read_b64_tr_b16 v[158:159], v185 offset:12928
  ds_read_b64_tr_b16 v[160:161], v187 offset:10400
  v_mfma_f32_16x16x32_bf16 v[60:63], v[116:119], v[88:91], v[60:63]
  ds_read_b64_tr_b16 v[162:163], v187 offset:12960
  v_mfma_f32_16x16x32_bf16 v[24:27], v[120:123], v[84:87], v[24:27]
  ds_read_b64_tr_b16 v[164:165], v185 offset:10432
  ds_read_b64_tr_b16 v[166:167], v185 offset:12992
  v_mfma_f32_16x16x32_bf16 v[64:67], v[120:123], v[88:91], v[64:67]
  ds_read_b64_tr_b16 v[168:169], v187 offset:10464
  v_mfma_f32_16x16x32_bf16 v[28:31], v[124:127], v[84:87], v[28:31]
  ds_read_b64_tr_b16 v[170:171], v187 offset:13024
  v_mfma_f32_16x16x32_bf16 v[68:71], v[124:127], v[88:91], v[68:71]
  ds_read_b64_tr_b16 v[172:173], v185 offset:10496
  ds_read_b64_tr_b16 v[174:175], v185 offset:13056
  v_mfma_f32_16x16x32_bf16 v[32:35], v[128:131], v[84:87], v[32:35]
  ds_read_b64_tr_b16 v[176:177], v187 offset:10528
  v_mfma_f32_16x16x32_bf16 v[72:75], v[128:131], v[88:91], v[72:75]
  ds_read_b64_tr_b16 v[178:179], v187 offset:13088
  v_mfma_f32_16x16x32_bf16 v[36:39], v[132:135], v[84:87], v[36:39]
  v_mfma_f32_16x16x32_bf16 v[76:79], v[132:135], v[88:91], v[76:79]
  v_mfma_f32_16x16x32_bf16 v[40:43], v[136:139], v[84:87], v[40:43]
  v_mfma_f32_16x16x32_bf16 v[80:83], v[136:139], v[88:91], v[80:83]
  s_cmp_lg_u32 s21, 0
  s_cbranch_scc1 .cm_15
  v_mfma_f32_16x16x32_bf16 v[232:235], v[132:135], v[212:215], v[232:235]
  v_mfma_f32_16x16x32_bf16 v[236:239], v[136:139], v[212:215], v[236:239]
  s_cmp_eq_u32 s64, 0
  s_cbranch_scc1 .cm_15
  v_mfma_f32_16x16x32_bf16 v[224:227], v[124:127], v[212:215], v[224:227]
  v_mfma_f32_16x16x32_bf16 v[228:231], v[128:131], v[212:215], v[228:231]
.cm_15:
  s_waitcnt lgkmcnt(0)
  s_barrier
  v_mfma_f32_16x16x32_bf16 v[4:7], v[140:143], v[92:95], v[4:7]
  ds_read_b64_tr_b16 v[100:101], v185 offset:36864
  ds_read_b64_tr_b16 v[102:103], v185 offset:39424
  v_mfma_f32_16x16x32_bf16 v[44:47], v[140:143], v[96:99], v[44:47]
  ds_read_b128 v[84:87], v181 offset:36864
  v_mfma_f32_16x16x32_bf16 v[8:11], v[144:147], v[92:95], v[8:11]
  ds_read_b128 v[88:91], v181 offset:38912
  ds_read_b64_tr_b16 v[104:105], v187 offset:36896
  v_mfma_f32_16x16x32_bf16 v[48:51], v[144:147], v[96:99], v[48:51]
  ds_read_b64_tr_b16 v[106:107], v187 offset:39456
  v_mfma_f32_16x16x32_bf16 v[12:15], v[148:151], v[92:95], v[12:15]
  ds_read_b64_tr_b16 v[108:109], v185 offset:36928
  v_mfma_f32_16x16x32_bf16 v[52:55], v[148:151], v[96:99], v[52:55]
  ds_read_b64_tr_b16 v[110:111], v185 offset:39488
  ds_read_b64_tr_b16 v[112:113], v187 offset:36960
  v_mfma_f32_16x16x32_bf16 v[16:19], v[152:155], v[92:95], v[16:19]
  ds_read_b64_tr_b16 v[114:115], v187 offset:39520
  v_mfma_f32_16x16x32_bf16 v[56:59], v[152:155], v[96:99], v[56:59]
  ds_read_b64_tr_b16 v[116:117], v185 offset:36992
  v_mfma_f32_16x16x32_bf16 v[20:23], v[156:159], v[92:95], v[20:23]
  ds_read_b64_tr_b16 v[118:119], v185 offset:39552
  ds_read_b64_tr_b16 v[120:121], v187 offset:37024
  v_mfma_f32_16x16x32_bf16 v[60:63], v[156:159], v[96:99], v[60:63]
  ds_read_b64_tr_b16 v[122:123], v187 offset:39584
  v_mfma_f32_16x16x32_bf16 v[24:27], v[160:163], v[92:95], v[24:27]
  ds_read_b64_tr_b16 v[124:125], v185 offset:37056
  ds_read_b64_tr_b16 v[126:127], v185 offset:39616
  v_mfma_f32_16x16x32_bf16 v[64:67], v[160:163], v[96:99], v[64:67]
  ds_read_b64_tr_b16 v[128:129], v187 offset:37088
  v_mfma_f32_16x16x32_bf16 v[28:31], v[164:167], v[92:95], v[28:31]
  ds_read_b64_tr_b16 v[130:131], v187 offset:39648
  v_mfma_f32_16x16x32_bf16 v[68:71], v[164:167], v[96:99], v[68:71]
  ds_read_b64_tr_b16 v[132:133], v185 offset:37120
  ds_read_b64_tr_b16 v[134:135], v185 offset:39680
  v_mfma_f32_16x16x32_bf16 v[32:35], v[168:171], v[92:95], v[32:35]
  ds_read_b64_tr_b16 v[136:137], v187 offset:37152
  v_mfma_f32_16x16x32_bf16 v[72:75], v[168:171], v[96:99], v[72:75]
  ds_read_b64_tr_b16 v[138:139], v187 offset:39712
  v_mfma_f32_16x16x32_bf16 v[36:39], v[172:175], v[92:95], v[36:39]
  v_mfma_f32_16x16x32_bf16 v[76:79], v[172:175], v[96:99], v[76:79]
  v_mfma_f32_16x16x32_bf16 v[40:43], v[176:179], v[92:95], v[40:43]
  v_mfma_f32_16x16x32_bf16 v[80:83], v[176:179], v[96:99], v[80:83]
  s_cmp_lg_u32 s21, 1
  s_cbranch_scc1 .cm_16
  v_mfma_f32_16x16x32_bf16 v[232:235], v[172:175], v[212:215], v[232:235]
  v_mfma_f32_16x16x32_bf16 v[236:239], v[176:179], v[212:215], v[236:239]
  s_cmp_eq_u32 s64, 0
  s_cbranch_scc1 .cm_16
  v_mfma_f32_16x16x32_bf16 v[224:227], v[164:167], v[212:215], v[224:227]
  v_mfma_f32_16x16x32_bf16 v[228:231], v[168:171], v[212:215], v[228:231]
.cm_16:
  s_waitcnt lgkmcnt(0)
  v_mfma_f32_16x16x32_bf16 v[4:7], v[100:103], v[84:87], v[4:7]
  ds_read_b64_tr_b16 v[140:141], v185 offset:47104
  ds_read_b64_tr_b16 v[142:143], v185 offset:49664
  v_mfma_f32_16x16x32_bf16 v[44:47], v[100:103], v[88:91], v[44:47]
  ds_read_b128 v[92:95], v183 offset:36864
  v_mfma_f32_16x16x32_bf16 v[8:11], v[104:107], v[84:87], v[8:11]
  ds_read_b128 v[96:99], v183 offset:38912
  ds_read_b64_tr_b16 v[144:145], v187 offset:47136
  v_mfma_f32_16x16x32_bf16 v[48:51], v[104:107], v[88:91], v[48:51]
  ds_read_b64_tr_b16 v[146:147], v187 offset:49696
  v_mfma_f32_16x16x32_bf16 v[12:15], v[108:111], v[84:87], v[12:15]
  ds_read_b64_tr_b16 v[148:149], v185 offset:47168
  v_mfma_f32_16x16x32_bf16 v[52:55], v[108:111], v[88:91], v[52:55]
  ds_read_b64_tr_b16 v[150:151], v185 offset:49728
  ds_read_b64_tr_b16 v[152:153], v187 offset:47200
  v_mfma_f32_16x16x32_bf16 v[16:19], v[112:115], v[84:87], v[16:19]
  ds_read_b64_tr_b16 v[154:155], v187 offset:49760
  v_mfma_f32_16x16x32_bf16 v[56:59], v[112:115], v[88:91], v[56:59]
  ds_read_b64_tr_b16 v[156:157], v185 offset:47232
  v_mfma_f32_16x16x32_bf16 v[20:23], v[116:119], v[84:87], v[20:23]
  ds_read_b64_tr_b16 v[158:159], v185 offset:49792
  ds_read_b64_tr_b16 v[160:161], v187 offset:47264
  v_mfma_f32_16x16x32_bf16 v[60:63], v[116:119], v[88:91], v[60:63]
  ds_read_b64_tr_b16 v[162:163], v187 offset:49824
  v_mfma_f32_16x16x32_bf16 v[24:27], v[120:123], v[84:87], v[24:27]
  ds_read_b64_tr_b16 v[164:165], v185 offset:47296
  ds_read_b64_tr_b16 v[166:167], v185 offset:49856
  v_mfma_f32_16x16x32_bf16 v[64:67], v[120:123], v[88:91], v[64:67]
  ds_read_b64_tr_b16 v[168:169], v187 offset:47328
  v_mfma_f32_16x16x32_bf16 v[28:31], v[124:127], v[84:87], v[28:31]
  ds_read_b64_tr_b16 v[170:171], v187 offset:49888
  v_mfma_f32_16x16x32_bf16 v[68:71], v[124:127], v[88:91], v[68:71]
  ds_read_b64_tr_b16 v[172:173], v185 offset:47360
  ds_read_b64_tr_b16 v[174:175], v185 offset:49920
  v_mfma_f32_16x16x32_bf16 v[32:35], v[128:131], v[84:87], v[32:35]
  ds_read_b64_tr_b16 v[176:177], v187 offset:47392
  v_mfma_f32_16x16x32_bf16 v[72:75], v[128:131], v[88:91], v[72:75]
  ds_read_b64_tr_b16 v[178:179], v187 offset:49952
  v_mfma_f32_16x16x32_bf16 v[36:39], v[132:135], v[84:87], v[36:39]
  v_mfma_f32_16x16x32_bf16 v[76:79], v[132:135], v[88:91], v[76:79]
  v_mfma_f32_16x16x32_bf16 v[40:43], v[136:139], v[84:87], v[40:43]
  v_mfma_f32_16x16x32_bf16 v[80:83], v[136:139], v[88:91], v[80:83]
  s_cmp_lg_u32 s21, 2
  s_cbranch_scc1 .cm_17
  v_mfma_f32_16x16x32_bf16 v[232:235], v[132:135], v[212:215], v[232:235]
  v_mfma_f32_16x16x32_bf16 v[236:239], v[136:139], v[212:215], v[236:239]
  s_cmp_eq_u32 s64, 0
  s_cbranch_scc1 .cm_17
  v_mfma_f32_16x16x32_bf16 v[224:227], v[124:127], v[212:215], v[224:227]
  v_mfma_f32_16x16x32_bf16 v[228:231], v[128:131], v[212:215], v[228:231]
.cm_17:
  s_waitcnt lgkmcnt(0)
  s_barrier
  v_mfma_f32_16x16x32_bf16 v[4:7], v[140:143], v[92:95], v[4:7]
  ds_read_b64_tr_b16 v[100:101], v184 offset:0
  ds_read_b64_tr_b16 v[102:103], v184 offset:2560
  v_mfma_f32_16x16x32_bf16 v[44:47], v[140:143], v[96:99], v[44:47]
  ds_read_b128 v[84:87], v180 offset:0
  v_mfma_f32_16x16x32_bf16 v[8:11], v[144:147], v[92:95], v[8:11]
  ds_read_b128 v[88:91], v180 offset:2048
  ds_read_b64_tr_b16 v[104:105], v186 offset:32
  v_mfma_f32_16x16x32_bf16 v[48:51], v[144:147], v[96:99], v[48:51]
  ds_read_b64_tr_b16 v[106:107], v186 offset:2592
  v_mfma_f32_16x16x32_bf16 v[12:15], v[148:151], v[92:95], v[12:15]
  ds_read_b64_tr_b16 v[108:109], v184 offset:64
  v_mfma_f32_16x16x32_bf16 v[52:55], v[148:151], v[96:99], v[52:55]
  ds_read_b64_tr_b16 v[110:111], v184 offset:2624
  ds_read_b64_tr_b16 v[112:113], v186 offset:96
  v_mfma_f32_16x16x32_bf16 v[16:19], v[152:155], v[92:95], v[16:19]
  ds_read_b64_tr_b16 v[114:115], v186 offset:2656
  v_mfma_f32_16x16x32_bf16 v[56:59], v[152:155], v[96:99], v[56:59]
  ds_read_b64_tr_b16 v[116:117], v184 offset:128
  v_mfma_f32_16x16x32_bf16 v[20:23], v[156:159], v[92:95], v[20:23]
  ds_read_b64_tr_b16 v[118:119], v184 offset:2688
  ds_read_b64_tr_b16 v[120:121], v186 offset:160
  v_mfma_f32_16x16x32_bf16 v[60:63], v[156:159], v[96:99], v[60:63]
  ds_read_b64_tr_b16 v[122:123], v186 offset:2720
  v_mfma_f32_16x16x32_bf16 v[24:27], v[160:163], v[92:95], v[24:27]
  ds_read_b64_tr_b16 v[124:125], v184 offset:192
  ds_read_b64_tr_b16 v[126:127], v184 offset:2752
  v_mfma_f32_16x16x32_bf16 v[64:67], v[160:163], v[96:99], v[64:67]
  ds_read_b64_tr_b16 v[128:129], v186 offset:224
  v_mfma_f32_16x16x32_bf16 v[28:31], v[164:167], v[92:95], v[28:31]
  ds_read_b64_tr_b16 v[130:131], v186 offset:2784
  v_mfma_f32_16x16x32_bf16 v[68:71], v[164:167], v[96:99], v[68:71]
  ds_read_b64_tr_b16 v[132:133], v184 offset:256
  ds_read_b64_tr_b16 v[134:135], v184 offset:2816
  v_mfma_f32_16x16x32_bf16 v[32:35], v[168:171], v[92:95], v[32:35]
  ds_read_b64_tr_b16 v[136:137], v186 offset:288
  v_mfma_f32_16x16x32_bf16 v[72:75], v[168:171], v[96:99], v[72:75]
  ds_read_b64_tr_b16 v[138:139], v186 offset:2848
  v_mfma_f32_16x16x32_bf16 v[36:39], v[172:175], v[92:95], v[36:39]
  v_mfma_f32_16x16x32_bf16 v[76:79], v[172:175], v[96:99], v[76:79]
  v_mfma_f32_16x16x32_bf16 v[40:43], v[176:179], v[92:95], v[40:43]
  v_mfma_f32_16x16x32_bf16 v[80:83], v[176:179], v[96:99], v[80:83]
  s_cmp_lg_u32 s21, 3
  s_cbranch_scc1 .cm_18
  v_mfma_f32_16x16x32_bf16 v[232:235], v[172:175], v[212:215], v[232:235]
  v_mfma_f32_16x16x32_bf16 v[236:239], v[176:179], v[212:215], v[236:239]
  s_cmp_eq_u32 s64, 0
  s_cbranch_scc1 .cm_18
  v_mfma_f32_16x16x32_bf16 v[224:227], v[164:167], v[212:215], v[224:227]
  v_mfma_f32_16x16x32_bf16 v[228:231], v[168:171], v[212:215], v[228:231]
.cm_18:
  s_waitcnt lgkmcnt(0)
  v_mfma_f32_16x16x32_bf16 v[4:7], v[100:103], v[84:87], v[4:7]
  ds_read_b64_tr_b16 v[140:141], v184 offset:10240
  ds_read_b64_tr_b16 v[142:143], v184 offset:12800
  v_mfma_f32_16x16x32_bf16 v[44:47], v[100:103], v[88:91], v[44:47]
  ds_read_b128 v[92:95], v182 offset:0
  v_mfma_f32_16x16x32_bf16 v[8:11], v[104:107], v[84:87], v[8:11]
  ds_read_b128 v[96:99], v182 offset:2048
  ds_read_b64_tr_b16 v[144:145], v186 offset:10272
  v_mfma_f32_16x16x32_bf16 v[48:51], v[104:107], v[88:91], v[48:51]
  ds_read_b64_tr_b16 v[146:147], v186 offset:12832
  v_mfma_f32_16x16x32_bf16 v[12:15], v[108:111], v[84:87], v[12:15]
  ds_read_b64_tr_b16 v[148:149], v184 offset:10304
  v_mfma_f32_16x16x32_bf16 v[52:55], v[108:111], v[88:91], v[52:55]
  ds_read_b64_tr_b16 v[150:151], v184 offset:12864
  ds_read_b64_tr_b16 v[152:153], v186 offset:10336
  v_mfma_f32_16x16x32_bf16 v[16:19], v[112:115], v[84:87], v[16:19]
  ds_read_b64_tr_b16 v[154:155], v186 offset:12896
  v_mfma_f32_16x16x32_bf16 v[56:59], v[112:115], v[88:91], v[56:59]
  ds_read_b64_tr_b16 v[156:157], v184 offset:10368
  v_mfma_f32_16x16x32_bf16 v[20:23], v[116:119], v[84:87], v[20:23]
  ds_read_b64_tr_b16 v[158:159], v184 offset:12928
  ds_read_b64_tr_b16 v[160:161], v186 offset:10400
  v_mfma_f32_16x16x32_bf16 v[60:63], v[116:119], v[88:91], v[60:63]
  ds_read_b64_tr_b16 v[162:163], v186 offset:12960
  v_mfma_f32_16x16x32_bf16 v[24:27], v[120:123], v[84:87], v[24:27]
  ds_read_b64_tr_b16 v[164:165], v184 offset:10432
  ds_read_b64_tr_b16 v[166:167], v184 offset:12992
  v_mfma_f32_16x16x32_bf16 v[64:67], v[120:123], v[88:91], v[64:67]
  ds_read_b64_tr_b16 v[168:169], v186 offset:10464
  v_mfma_f32_16x16x32_bf16 v[28:31], v[124:127], v[84:87], v[28:31]
  ds_read_b64_tr_b16 v[170:171], v186 offset:13024
  v_mfma_f32_16x16x32_bf16 v[68:71], v[124:127], v[88:91], v[68:71]
  ds_read_b64_tr_b16 v[172:173], v184 offset:10496
  ds_read_b64_tr_b16 v[174:175], v184 offset:13056
  v_mfma_f32_16x16x32_bf16 v[32:35], v[128:131], v[84:87], v[32:35]
  ds_read_b64_tr_b16 v[176:177], v186 offset:10528
  v_mfma_f32_16x16x32_bf16 v[72:75], v[128:131], v[88:91], v[72:75]
  ds_read_b64_tr_b16 v[178:179], v186 offset:13088
  v_mfma_f32_16x16x32_bf16 v[36:39], v[132:135], v[84:87], v[36:39]
  v_mfma_f32_16x16x32_bf16 v[76:79], v[132:135], v[88:91], v[76:79]
  v_mfma_f32_16x16x32_bf16 v[40:43], v[136:139], v[84:87], v[40:43]
  v_mfma_f32_16x16x32_bf16 v[80:83], v[136:139], v[88:91], v[80:83]
  s_cmp_lg_u32 s21, 0
  s_cbranch_scc1 .cm_19
  v_mfma_f32_16x16x32_bf16 v[232:235], v[132:135], v[212:215], v[232:235]
  v_mfma_f32_16x16x32_bf16 v[236:239], v[136:139], v[212:215], v[236:239]
  s_cmp_eq_u32 s64, 0
  s_cbranch_scc1 .cm_19
  v_mfma_f32_16x16x32_bf16 v[224:227], v[124:127], v[212:215], v[224:227]
  v_mfma_f32_16x16x32_bf16 v[228:231], v[128:131], v[212:215], v[228:231]
.cm_19:
  s_waitcnt lgkmcnt(0)
  s_barrier
  v_mfma_f32_16x16x32_bf16 v[4:7], v[140:143], v[92:95], v[4:7]
  ds_read_b64_tr_b16 v[100:101], v184 offset:36864
  ds_read_b64_tr_b16 v[102:103], v184 offset:39424
  v_mfma_f32_16x16x32_bf16 v[44:47], v[140:143], v[96:99], v[44:47]
  ds_read_b128 v[84:87], v180 offset:36864
  v_mfma_f32_16x16x32_bf16 v[8:11], v[144:147], v[92:95], v[8:11]
  ds_read_b128 v[88:91], v180 offset:38912
  ds_read_b64_tr_b16 v[104:105], v186 offset:36896
  v_mfma_f32_16x16x32_bf16 v[48:51], v[144:147], v[96:99], v[48:51]
  ds_read_b64_tr_b16 v[106:107], v186 offset:39456
  v_mfma_f32_16x16x32_bf16 v[12:15], v[148:151], v[92:95], v[12:15]
  ds_read_b64_tr_b16 v[108:109], v184 offset:36928
  v_mfma_f32_16x16x32_bf16 v[52:55], v[148:151], v[96:99], v[52:55]
  ds_read_b64_tr_b16 v[110:111], v184 offset:39488
  ds_read_b64_tr_b16 v[112:113], v186 offset:36960
  v_mfma_f32_16x16x32_bf16 v[16:19], v[152:155], v[92:95], v[16:19]
  ds_read_b64_tr_b16 v[114:115], v186 offset:39520
  v_mfma_f32_16x16x32_bf16 v[56:59], v[152:155], v[96:99], v[56:59]
  ds_read_b64_tr_b16 v[116:117], v184 offset:36992
  v_mfma_f32_16x16x32_bf16 v[20:23], v[156:159], v[92:95], v[20:23]
  ds_read_b64_tr_b16 v[118:119], v184 offset:39552
  ds_read_b64_tr_b16 v[120:121], v186 offset:37024
  v_mfma_f32_16x16x32_bf16 v[60:63], v[156:159], v[96:99], v[60:63]
  ds_read_b64_tr_b16 v[122:123], v186 offset:39584
  v_mfma_f32_16x16x32_bf16 v[24:27], v[160:163], v[92:95], v[24:27]
  ds_read_b64_tr_b16 v[124:125], v184 offset:37056
  ds_read_b64_tr_b16 v[126:127], v184 offset:39616
  v_mfma_f32_16x16x32_bf16 v[64:67], v[160:163], v[96:99], v[64:67]
  ds_read_b64_tr_b16 v[128:129], v186 offset:37088
  v_mfma_f32_16x16x32_bf16 v[28:31], v[164:167], v[92:95], v[28:31]
  ds_read_b64_tr_b16 v[130:131], v186 offset:39648
  v_mfma_f32_16x16x32_bf16 v[68:71], v[164:167], v[96:99], v[68:71]
  ds_read_b64_tr_b16 v[132:133], v184 offset:37120
  ds_read_b64_tr_b16 v[134:135], v184 offset:39680
  v_mfma_f32_16x16x32_bf16 v[32:35], v[168:171], v[92:95], v[32:35]
  ds_read_b64_tr_b16 v[136:137], v186 offset:37152
  v_mfma_f32_16x16x32_bf16 v[72:75], v[168:171], v[96:99], v[72:75]
  ds_read_b64_tr_b16 v[138:139], v186 offset:39712
  v_mfma_f32_16x16x32_bf16 v[36:39], v[172:175], v[92:95], v[36:39]
  v_mfma_f32_16x16x32_bf16 v[76:79], v[172:175], v[96:99], v[76:79]
  v_mfma_f32_16x16x32_bf16 v[40:43], v[176:179], v[92:95], v[40:43]
  v_mfma_f32_16x16x32_bf16 v[80:83], v[176:179], v[96:99], v[80:83]
  s_cmp_lg_u32 s21, 1
  s_cbranch_scc1 .cm_20
  v_mfma_f32_16x16x32_bf16 v[232:235], v[172:175], v[212:215], v[232:235]
  v_mfma_f32_16x16x32_bf16 v[236:239], v[176:179], v[212:215], v[236:239]
  s_cmp_eq_u32 s64, 0
  s_cbranch_scc1 .cm_20
  v_mfma_f32_16x16x32_bf16 v[224:227], v[164:167], v[212:215], v[224:227]
  v_mfma_f32_16x16x32_bf16 v[228:231], v[168:171], v[212:215], v[228:231]
.cm_20:
  s_waitcnt lgkmcnt(0)
  v_mfma_f32_16x16x32_bf16 v[4:7], v[100:103], v[84:87], v[4:7]
  ds_read_b64_tr_b16 v[140:141], v184 offset:47104
  ds_read_b64_tr_b16 v[142:143], v184 offset:49664
  v_mfma_f32_16x16x32_bf16 v[44:47], v[100:103], v[88:91], v[44:47]
  ds_read_b128 v[92:95], v182 offset:36864
  v_mfma_f32_16x16x32_bf16 v[8:11], v[104:107], v[84:87], v[8:11]
  ds_read_b128 v[96:99], v182 offset:38912
  ds_read_b64_tr_b16 v[144:145], v186 offset:47136
  v_mfma_f32_16x16x32_bf16 v[48:51], v[104:107], v[88:91], v[48:51]
  ds_read_b64_tr_b16 v[146:147], v186 offset:49696
  v_mfma_f32_16x16x32_bf16 v[12:15], v[108:111], v[84:87], v[12:15]
  ds_read_b64_tr_b16 v[148:149], v184 offset:47168
  v_mfma_f32_16x16x32_bf16 v[52:55], v[108:111], v[88:91], v[52:55]
  ds_read_b64_tr_b16 v[150:151], v184 offset:49728
  ds_read_b64_tr_b16 v[152:153], v186 offset:47200
  v_mfma_f32_16x16x32_bf16 v[16:19], v[112:115], v[84:87], v[16:19]
  ds_read_b64_tr_b16 v[154:155], v186 offset:49760
  v_mfma_f32_16x16x32_bf16 v[56:59], v[112:115], v[88:91], v[56:59]
  ds_read_b64_tr_b16 v[156:157], v184 offset:47232
  v_mfma_f32_16x16x32_bf16 v[20:23], v[116:119], v[84:87], v[20:23]
  ds_read_b64_tr_b16 v[158:159], v184 offset:49792
  ds_read_b64_tr_b16 v[160:161], v186 offset:47264
  v_mfma_f32_16x16x32_bf16 v[60:63], v[116:119], v[88:91], v[60:63]
  ds_read_b64_tr_b16 v[162:163], v186 offset:49824
  v_mfma_f32_16x16x32_bf16 v[24:27], v[120:123], v[84:87], v[24:27]
  ds_read_b64_tr_b16 v[164:165], v184 offset:47296
  ds_read_b64_tr_b16 v[166:167], v184 offset:49856
  v_mfma_f32_16x16x32_bf16 v[64:67], v[120:123], v[88:91], v[64:67]
  ds_read_b64_tr_b16 v[168:169], v186 offset:47328
  v_mfma_f32_16x16x32_bf16 v[28:31], v[124:127], v[84:87], v[28:31]
  ds_read_b64_tr_b16 v[170:171], v186 offset:49888
  v_mfma_f32_16x16x32_bf16 v[68:71], v[124:127], v[88:91], v[68:71]
  ds_read_b64_tr_b16 v[172:173], v184 offset:47360
  ds_read_b64_tr_b16 v[174:175], v184 offset:49920
  v_mfma_f32_16x16x32_bf16 v[32:35], v[128:131], v[84:87], v[32:35]
  ds_read_b64_tr_b16 v[176:177], v186 offset:47392
  v_mfma_f32_16x16x32_bf16 v[72:75], v[128:131], v[88:91], v[72:75]
  ds_read_b64_tr_b16 v[178:179], v186 offset:49952
  v_mfma_f32_16x16x32_bf16 v[36:39], v[132:135], v[84:87], v[36:39]
  v_mfma_f32_16x16x32_bf16 v[76:79], v[132:135], v[88:91], v[76:79]
  v_mfma_f32_16x16x32_bf16 v[40:43], v[136:139], v[84:87], v[40:43]
  v_mfma_f32_16x16x32_bf16 v[80:83], v[136:139], v[88:91], v[80:83]
  ds_write_b128 v207, v[224:227] offset:0
  ds_write_b128 v207, v[228:231] offset:64
  ds_write_b128 v207, v[232:235] offset:128
  ds_write_b128 v207, v[236:239] offset:192
  v_mfma_f32_16x16x32_bf16 v[248:251], v[132:135], v[212:215], v[248:251]
  v_mfma_f32_16x16x32_bf16 v[252:255], v[136:139], v[212:215], v[252:255]
  s_cmp_eq_u32 s64, 0
  s_cbranch_scc1 .cm_21
  v_mfma_f32_16x16x32_bf16 v[240:243], v[124:127], v[212:215], v[240:243]
  v_mfma_f32_16x16x32_bf16 v[244:247], v[128:131], v[212:215], v[244:247]
.cm_21:
  s_waitcnt lgkmcnt(0)
  s_barrier
  v_mfma_f32_16x16x32_bf16 v[4:7], v[140:143], v[92:95], v[4:7]
  ds_read_b64 v[84:85], v205
  v_mfma_f32_16x16x32_bf16 v[44:47], v[140:143], v[96:99], v[44:47]
  ds_read_b64 v[86:87], v205 offset:256
  v_mfma_f32_16x16x32_bf16 v[8:11], v[144:147], v[92:95], v[8:11]
  ds_read_b128 v[100:103], v206 offset:0
  v_mfma_f32_16x16x32_bf16 v[48:51], v[144:147], v[96:99], v[48:51]
  ds_read_b128 v[104:107], v206 offset:256
  v_mfma_f32_16x16x32_bf16 v[12:15], v[148:151], v[92:95], v[12:15]
  ds_read_b128 v[224:227], v206 offset:512
  v_mfma_f32_16x16x32_bf16 v[52:55], v[148:151], v[96:99], v[52:55]
  ds_read_b128 v[108:111], v206 offset:64
  v_mfma_f32_16x16x32_bf16 v[16:19], v[152:155], v[92:95], v[16:19]
  ds_read_b128 v[112:115], v206 offset:320
  v_mfma_f32_16x16x32_bf16 v[56:59], v[152:155], v[96:99], v[56:59]
  v_mfma_f32_16x16x32_bf16 v[20:23], v[156:159], v[92:95], v[20:23]
  ds_read_b128 v[228:231], v206 offset:576
  v_mfma_f32_16x16x32_bf16 v[60:63], v[156:159], v[96:99], v[60:63]
  ds_read_b128 v[116:119], v206 offset:128
  v_mfma_f32_16x16x32_bf16 v[24:27], v[160:163], v[92:95], v[24:27]
  ds_read_b128 v[120:123], v206 offset:384
  v_mfma_f32_16x16x32_bf16 v[64:67], v[160:163], v[96:99], v[64:67]
  ds_read_b128 v[232:235], v206 offset:640
  v_mfma_f32_16x16x32_bf16 v[28:31], v[164:167], v[92:95], v[28:31]
  ds_read_b128 v[124:127], v206 offset:192
  v_mfma_f32_16x16x32_bf16 v[68:71], v[164:167], v[96:99], v[68:71]
  ds_read_b128 v[128:131], v206 offset:448
  v_mfma_f32_16x16x32_bf16 v[32:35], v[168:171], v[92:95], v[32:35]
  ds_read_b128 v[236:239], v206 offset:704
  v_mfma_f32_16x16x32_bf16 v[72:75], v[168:171], v[96:99], v[72:75]
  v_mfma_f32_16x16x32_bf16 v[36:39], v[172:175], v[92:95], v[36:39]
  v_mfma_f32_16x16x32_bf16 v[76:79], v[172:175], v[96:99], v[76:79]
  v_mfma_f32_16x16x32_bf16 v[40:43], v[176:179], v[92:95], v[40:43]
  v_mfma_f32_16x16x32_bf16 v[80:83], v[176:179], v[96:99], v[80:83]
  v_mfma_f32_16x16x32_bf16 v[248:251], v[172:175], v[212:215], v[248:251]
  v_mfma_f32_16x16x32_bf16 v[252:255], v[176:179], v[212:215], v[252:255]
  s_cmp_eq_u32 s64, 0
  s_cbranch_scc1 .cm_22
  v_mfma_f32_16x16x32_bf16 v[240:243], v[164:167], v[212:215], v[240:243]
  v_mfma_f32_16x16x32_bf16 v[244:247], v[168:171], v[212:215], v[244:247]
.cm_22:
  ds_read_b128 v[188:191], v206 offset:768
  ds_read_b128 v[192:195], v206 offset:832
  ds_read_b128 v[196:199], v206 offset:896
  ds_read_b128 v[200:203], v206 offset:960
  v_mov_b32 v222, 162816
  ds_read_b32 v220, v222 offset:8
  ds_read_b64 v[222:223], v222
  s_lshl_b32 s30, s23, 8
  s_mul_i32 s31, s23, 192
  s_add_u32 s31, s31, 768
  s_lshl_b32 s32, s23, 6
  s_sub_u32 s32, s32, 256
  s_lshl_b32 s33, s23, 7
  s_sub_u32 s33, s33, 960
  s_cmp_eq_u32 s64, 0
  s_cselect_b32 s30, s30, s31
  s_cselect_b32 s32, s32, s33
  s_add_u32 s32, s32, 0x800000
  s_lshl_b32 s31, s22, 7
  v_add_u32 v207, s31, v204
  v_lshrrev_b32 v205, 4, v1
  v_lshlrev_b32 v204, 3, v205
  v_and_b32 v205, 1, v205
  v_mul_u32_u24 v205, 24, v205
  v_add_u32 v205, v205, v204
  v_mul_u32_u24 v210, 1280, v207
  v_add3_u32 v210, v210, v205, s32
  v_mul_u32_u24 v207, 3840, v207
  v_add3_u32 v207, v207, v205, s30
  s_waitcnt lgkmcnt(0)
  v_readfirstlane_b32 s26, v222
  v_readfirstlane_b32 s27, v223
  v_readfirstlane_b32 s25, v220
  s_nop 3
  s_cmp_eq_u32 s21, 0
  s_cselect_b32 s3, 0, s25
  s_cmp_eq_u32 s21, 3
  s_cselect_b32 s73, 0, s25
  v_pk_add_f32 v[100:101], v[100:101], v[104:105]
  v_pk_add_f32 v[224:225], v[224:225], v[188:189]
  v_pk_add_f32 v[100:101], v[100:101], v[240:241]
  v_pk_add_f32 v[100:101], v[100:101], v[224:225]
  v_pk_add_f32 v[102:103], v[102:103], v[106:107]
  v_pk_add_f32 v[226:227], v[226:227], v[190:191]
  v_pk_add_f32 v[102:103], v[102:103], v[242:243]
  v_pk_add_f32 v[102:103], v[102:103], v[226:227]
  v_pk_add_f32 v[108:109], v[108:109], v[112:113]
  v_pk_add_f32 v[228:229], v[228:229], v[192:193]
  v_pk_add_f32 v[108:109], v[108:109], v[244:245]
  v_pk_add_f32 v[108:109], v[108:109], v[228:229]
  v_pk_add_f32 v[110:111], v[110:111], v[114:115]
  v_pk_add_f32 v[230:231], v[230:231], v[194:195]
  v_pk_add_f32 v[110:111], v[110:111], v[246:247]
  v_pk_add_f32 v[110:111], v[110:111], v[230:231]
  v_pk_add_f32 v[116:117], v[116:117], v[120:121]
  v_pk_add_f32 v[232:233], v[232:233], v[196:197]
  v_pk_add_f32 v[116:117], v[116:117], v[248:249]
  v_pk_add_f32 v[116:117], v[116:117], v[232:233]
  v_pk_add_f32 v[118:119], v[118:119], v[122:123]
  v_pk_add_f32 v[234:235], v[234:235], v[198:199]
  v_pk_add_f32 v[118:119], v[118:119], v[250:251]
  v_pk_add_f32 v[118:119], v[118:119], v[234:235]
  v_pk_add_f32 v[124:125], v[124:125], v[128:129]
  v_pk_add_f32 v[236:237], v[236:237], v[200:201]
  v_pk_add_f32 v[124:125], v[124:125], v[252:253]
  v_pk_add_f32 v[124:125], v[124:125], v[236:237]
  v_pk_add_f32 v[126:127], v[126:127], v[130:131]
  v_pk_add_f32 v[238:239], v[238:239], v[202:203]
  v_pk_add_f32 v[126:127], v[126:127], v[254:255]
  v_pk_add_f32 v[126:127], v[126:127], v[238:239]
  v_pk_fma_f32 v[36:37], v[116:117], v[84:85], v[36:37] op_sel_hi:[1,0,1]
  v_pk_fma_f32 v[38:39], v[118:119], v[84:85], v[38:39] op_sel_hi:[1,0,1]
  v_pk_mul_f32 v[36:37], v[36:37], v[84:85] op_sel:[0,1] op_sel_hi:[1,1]
  v_pk_mul_f32 v[38:39], v[38:39], v[84:85] op_sel:[0,1] op_sel_hi:[1,1]
  v_pk_mul_f32 v[188:189], v[36:37], v[36:37]
  v_pk_mul_f32 v[190:191], v[38:39], v[38:39]
  v_pk_fma_f32 v[188:189], v[188:189], s[28:29], s[28:29] op_sel:[0,1,0] op_sel_hi:[1,1,0]
  v_pk_fma_f32 v[190:191], v[190:191], s[28:29], s[28:29] op_sel:[0,1,0] op_sel_hi:[1,1,0]
  v_pk_mul_f32 v[188:189], v[188:189], v[36:37]
  v_pk_mul_f32 v[190:191], v[190:191], v[38:39]
  v_exp_f32 v188, v188
  v_exp_f32 v189, v189
  v_exp_f32 v190, v190
  v_exp_f32 v191, v191
  v_pk_add_f32 v[188:189], v[188:189], 1.0 op_sel_hi:[1,0]
  v_pk_add_f32 v[190:191], v[190:191], 1.0 op_sel_hi:[1,0]
  v_rcp_f32 v188, v188
  v_rcp_f32 v189, v189
  v_rcp_f32 v190, v190
  v_rcp_f32 v191, v191
  v_pk_mul_f32 v[36:37], v[188:189], v[36:37]
  v_pk_mul_f32 v[38:39], v[190:191], v[38:39]
  v_pk_fma_f32 v[40:41], v[124:125], v[84:85], v[40:41] op_sel_hi:[1,0,1]
  v_pk_fma_f32 v[42:43], v[126:127], v[84:85], v[42:43] op_sel_hi:[1,0,1]
  v_pk_mul_f32 v[40:41], v[40:41], v[84:85] op_sel:[0,1] op_sel_hi:[1,1]
  v_pk_mul_f32 v[42:43], v[42:43], v[84:85] op_sel:[0,1] op_sel_hi:[1,1]
  v_pk_mul_f32 v[192:193], v[40:41], v[40:41]
  v_pk_mul_f32 v[194:195], v[42:43], v[42:43]
  v_pk_fma_f32 v[192:193], v[192:193], s[28:29], s[28:29] op_sel:[0,1,0] op_sel_hi:[1,1,0]
  v_pk_fma_f32 v[194:195], v[194:195], s[28:29], s[28:29] op_sel:[0,1,0] op_sel_hi:[1,1,0]
  v_pk_mul_f32 v[192:193], v[192:193], v[40:41]
  v_pk_mul_f32 v[194:195], v[194:195], v[42:43]
  v_exp_f32 v192, v192
  v_exp_f32 v193, v193
  v_exp_f32 v194, v194
  v_exp_f32 v195, v195
  v_pk_add_f32 v[192:193], v[192:193], 1.0 op_sel_hi:[1,0]
  v_pk_add_f32 v[194:195], v[194:195], 1.0 op_sel_hi:[1,0]
  v_rcp_f32 v192, v192
  v_rcp_f32 v193, v193
  v_rcp_f32 v194, v194
  v_rcp_f32 v195, v195
  v_pk_mul_f32 v[40:41], v[192:193], v[40:41]
  v_pk_mul_f32 v[42:43], v[194:195], v[42:43]
  v_cvt_pk_bf16_f32 v148, v36, v37
  v_cvt_pk_bf16_f32 v149, v38, v39
  v_cvt_pk_bf16_f32 v150, v40, v41
  v_cvt_pk_bf16_f32 v151, v42, v43
  s_nop 1
  v_permlane16_swap_b32 v148, v150
  v_permlane16_swap_b32 v149, v151
  s_mov_b32 s30, 0
  s_cmp_lg_u32 s3, 0
  s_cbranch_scc1 .dp_23
  buffer_store_dwordx4 v[148:151], v210, s[4:7], s30 offen offset:256 sc1
  s_branch .de_24
.dp_23:
  buffer_store_dwordx4 v[148:151], v210, s[4:7], s30 offen offset:256
.de_24:
  v_pk_fma_f32 v[76:77], v[116:117], v[86:87], v[76:77] op_sel_hi:[1,0,1]
  v_pk_fma_f32 v[78:79], v[118:119], v[86:87], v[78:79] op_sel_hi:[1,0,1]
  v_pk_mul_f32 v[76:77], v[76:77], v[86:87] op_sel:[0,1] op_sel_hi:[1,1]
  v_pk_mul_f32 v[78:79], v[78:79], v[86:87] op_sel:[0,1] op_sel_hi:[1,1]
  v_pk_mul_f32 v[188:189], v[76:77], v[76:77]
  v_pk_mul_f32 v[190:191], v[78:79], v[78:79]
  v_pk_fma_f32 v[188:189], v[188:189], s[28:29], s[28:29] op_sel:[0,1,0] op_sel_hi:[1,1,0]
  v_pk_fma_f32 v[190:191], v[190:191], s[28:29], s[28:29] op_sel:[0,1,0] op_sel_hi:[1,1,0]
  v_pk_mul_f32 v[188:189], v[188:189], v[76:77]
  v_pk_mul_f32 v[190:191], v[190:191], v[78:79]
  v_exp_f32 v188, v188
  v_exp_f32 v189, v189
  v_exp_f32 v190, v190
  v_exp_f32 v191, v191
  v_pk_add_f32 v[188:189], v[188:189], 1.0 op_sel_hi:[1,0]
  v_pk_add_f32 v[190:191], v[190:191], 1.0 op_sel_hi:[1,0]
  v_rcp_f32 v188, v188
  v_rcp_f32 v189, v189
  v_rcp_f32 v190, v190
  v_rcp_f32 v191, v191
  v_pk_mul_f32 v[76:77], v[188:189], v[76:77]
  v_pk_mul_f32 v[78:79], v[190:191], v[78:79]
  v_pk_fma_f32 v[80:81], v[124:125], v[86:87], v[80:81] op_sel_hi:[1,0,1]
  v_pk_fma_f32 v[82:83], v[126:127], v[86:87], v[82:83] op_sel_hi:[1,0,1]
  v_pk_mul_f32 v[80:81], v[80:81], v[86:87] op_sel:[0,1] op_sel_hi:[1,1]
  v_pk_mul_f32 v[82:83], v[82:83], v[86:87] op_sel:[0,1] op_sel_hi:[1,1]
  v_pk_mul_f32 v[192:193], v[80:81], v[80:81]
  v_pk_mul_f32 v[194:195], v[82:83], v[82:83]
  v_pk_fma_f32 v[192:193], v[192:193], s[28:29], s[28:29] op_sel:[0,1,0] op_sel_hi:[1,1,0]
  v_pk_fma_f32 v[194:195], v[194:195], s[28:29], s[28:29] op_sel:[0,1,0] op_sel_hi:[1,1,0]
  v_pk_mul_f32 v[192:193], v[192:193], v[80:81]
  v_pk_mul_f32 v[194:195], v[194:195], v[82:83]
  v_exp_f32 v192, v192
  v_exp_f32 v193, v193
  v_exp_f32 v194, v194
  v_exp_f32 v195, v195
  v_pk_add_f32 v[192:193], v[192:193], 1.0 op_sel_hi:[1,0]
  v_pk_add_f32 v[194:195], v[194:195], 1.0 op_sel_hi:[1,0]
  v_rcp_f32 v192, v192
  v_rcp_f32 v193, v193
  v_rcp_f32 v194, v194
  v_rcp_f32 v195, v195
  v_pk_mul_f32 v[80:81], v[192:193], v[80:81]
  v_pk_mul_f32 v[82:83], v[194:195], v[82:83]
  v_cvt_pk_bf16_f32 v152, v76, v77
  v_cvt_pk_bf16_f32 v153, v78, v79
  v_cvt_pk_bf16_f32 v154, v80, v81
  v_cvt_pk_bf16_f32 v155, v82, v83
  s_nop 1
  v_permlane16_swap_b32 v152, v154
  v_permlane16_swap_b32 v153, v155
  s_mov_b32 s30, 20480
  s_cmp_lg_u32 s73, 0
  s_cbranch_scc1 .dp_25
  buffer_store_dwordx4 v[152:155], v210, s[4:7], s30 offen offset:256 sc1
  s_branch .de_26
.dp_25:
  buffer_store_dwordx4 v[152:155], v210, s[4:7], s30 offen offset:256
.de_26:
  s_cmp_eq_u32 s64, 0
  s_cbranch_scc1 .sm_27
  v_pk_fma_f32 v[28:29], v[100:101], v[84:85], v[28:29] op_sel_hi:[1,0,1]
  v_pk_fma_f32 v[30:31], v[102:103], v[84:85], v[30:31] op_sel_hi:[1,0,1]
  v_pk_mul_f32 v[28:29], v[28:29], v[84:85] op_sel:[0,1] op_sel_hi:[1,1]
  v_pk_mul_f32 v[30:31], v[30:31], v[84:85] op_sel:[0,1] op_sel_hi:[1,1]
  v_pk_mul_f32 v[188:189], v[28:29], v[28:29]
  v_pk_mul_f32 v[190:191], v[30:31], v[30:31]
  v_pk_fma_f32 v[188:189], v[188:189], s[28:29], s[28:29] op_sel:[0,1,0] op_sel_hi:[1,1,0]
  v_pk_fma_f32 v[190:191], v[190:191], s[28:29], s[28:29] op_sel:[0,1,0] op_sel_hi:[1,1,0]
  v_pk_mul_f32 v[188:189], v[188:189], v[28:29]
  v_pk_mul_f32 v[190:191], v[190:191], v[30:31]
  v_exp_f32 v188, v188
  v_exp_f32 v189, v189
  v_exp_f32 v190, v190
  v_exp_f32 v191, v191
  v_pk_add_f32 v[188:189], v[188:189], 1.0 op_sel_hi:[1,0]
  v_pk_add_f32 v[190:191], v[190:191], 1.0 op_sel_hi:[1,0]
  v_rcp_f32 v188, v188
  v_rcp_f32 v189, v189
  v_rcp_f32 v190, v190
  v_rcp_f32 v191, v191
  v_pk_mul_f32 v[28:29], v[188:189], v[28:29]
  v_pk_mul_f32 v[30:31], v[190:191], v[30:31]
  v_pk_fma_f32 v[32:33], v[108:109], v[84:85], v[32:33] op_sel_hi:[1,0,1]
  v_pk_fma_f32 v[34:35], v[110:111], v[84:85], v[34:35] op_sel_hi:[1,0,1]
  v_pk_mul_f32 v[32:33], v[32:33], v[84:85] op_sel:[0,1] op_sel_hi:[1,1]
  v_pk_mul_f32 v[34:35], v[34:35], v[84:85] op_sel:[0,1] op_sel_hi:[1,1]
  v_pk_mul_f32 v[192:193], v[32:33], v[32:33]
  v_pk_mul_f32 v[194:195], v[34:35], v[34:35]
  v_pk_fma_f32 v[192:193], v[192:193], s[28:29], s[28:29] op_sel:[0,1,0] op_sel_hi:[1,1,0]
  v_pk_fma_f32 v[194:195], v[194:195], s[28:29], s[28:29] op_sel:[0,1,0] op_sel_hi:[1,1,0]
  v_pk_mul_f32 v[192:193], v[192:193], v[32:33]
  v_pk_mul_f32 v[194:195], v[194:195], v[34:35]
  v_exp_f32 v192, v192
  v_exp_f32 v193, v193
  v_exp_f32 v194, v194
  v_exp_f32 v195, v195
  v_pk_add_f32 v[192:193], v[192:193], 1.0 op_sel_hi:[1,0]
  v_pk_add_f32 v[194:195], v[194:195], 1.0 op_sel_hi:[1,0]
  v_rcp_f32 v192, v192
  v_rcp_f32 v193, v193
  v_rcp_f32 v194, v194
  v_rcp_f32 v195, v195
  v_pk_mul_f32 v[32:33], v[192:193], v[32:33]
  v_pk_mul_f32 v[34:35], v[194:195], v[34:35]
  v_cvt_pk_bf16_f32 v140, v28, v29
  v_cvt_pk_bf16_f32 v141, v30, v31
  v_cvt_pk_bf16_f32 v142, v32, v33
  v_cvt_pk_bf16_f32 v143, v34, v35
  s_nop 1
  v_permlane16_swap_b32 v140, v142
  v_permlane16_swap_b32 v141, v143
  s_mov_b32 s30, 0
  s_cmp_lg_u32 s3, 0
  s_cbranch_scc1 .dp_28
  buffer_store_dwordx4 v[140:143], v210, s[4:7], s30 offen offset:192 sc1
  s_branch .de_29
.dp_28:
  buffer_store_dwordx4 v[140:143], v210, s[4:7], s30 offen offset:192
.de_29:
  v_pk_fma_f32 v[68:69], v[100:101], v[86:87], v[68:69] op_sel_hi:[1,0,1]
  v_pk_fma_f32 v[70:71], v[102:103], v[86:87], v[70:71] op_sel_hi:[1,0,1]
  v_pk_mul_f32 v[68:69], v[68:69], v[86:87] op_sel:[0,1] op_sel_hi:[1,1]
  v_pk_mul_f32 v[70:71], v[70:71], v[86:87] op_sel:[0,1] op_sel_hi:[1,1]
  v_pk_mul_f32 v[188:189], v[68:69], v[68:69]
  v_pk_mul_f32 v[190:191], v[70:71], v[70:71]
  v_pk_fma_f32 v[188:189], v[188:189], s[28:29], s[28:29] op_sel:[0,1,0] op_sel_hi:[1,1,0]
  v_pk_fma_f32 v[190:191], v[190:191], s[28:29], s[28:29] op_sel:[0,1,0] op_sel_hi:[1,1,0]
  v_pk_mul_f32 v[188:189], v[188:189], v[68:69]
  v_pk_mul_f32 v[190:191], v[190:191], v[70:71]
  v_exp_f32 v188, v188
  v_exp_f32 v189, v189
  v_exp_f32 v190, v190
  v_exp_f32 v191, v191
  v_pk_add_f32 v[188:189], v[188:189], 1.0 op_sel_hi:[1,0]
  v_pk_add_f32 v[190:191], v[190:191], 1.0 op_sel_hi:[1,0]
  v_rcp_f32 v188, v188
  v_rcp_f32 v189, v189
  v_rcp_f32 v190, v190
  v_rcp_f32 v191, v191
  v_pk_mul_f32 v[68:69], v[188:189], v[68:69]
  v_pk_mul_f32 v[70:71], v[190:191], v[70:71]
  v_pk_fma_f32 v[72:73], v[108:109], v[86:87], v[72:73] op_sel_hi:[1,0,1]
  v_pk_fma_f32 v[74:75], v[110:111], v[86:87], v[74:75] op_sel_hi:[1,0,1]
  v_pk_mul_f32 v[72:73], v[72:73], v[86:87] op_sel:[0,1] op_sel_hi:[1,1]
  v_pk_mul_f32 v[74:75], v[74:75], v[86:87] op_sel:[0,1] op_sel_hi:[1,1]
  v_pk_mul_f32 v[192:193], v[72:73], v[72:73]
  v_pk_mul_f32 v[194:195], v[74:75], v[74:75]
  v_pk_fma_f32 v[192:193], v[192:193], s[28:29], s[28:29] op_sel:[0,1,0] op_sel_hi:[1,1,0]
  v_pk_fma_f32 v[194:195], v[194:195], s[28:29], s[28:29] op_sel:[0,1,0] op_sel_hi:[1,1,0]
  v_pk_mul_f32 v[192:193], v[192:193], v[72:73]
  v_pk_mul_f32 v[194:195], v[194:195], v[74:75]
  v_exp_f32 v192, v192
  v_exp_f32 v193, v193
  v_exp_f32 v194, v194
  v_exp_f32 v195, v195
  v_pk_add_f32 v[192:193], v[192:193], 1.0 op_sel_hi:[1,0]
  v_pk_add_f32 v[194:195], v[194:195], 1.0 op_sel_hi:[1,0]
  v_rcp_f32 v192, v192
  v_rcp_f32 v193, v193
  v_rcp_f32 v194, v194
  v_rcp_f32 v195, v195
  v_pk_mul_f32 v[72:73], v[192:193], v[72:73]
  v_pk_mul_f32 v[74:75], v[194:195], v[74:75]
  v_cvt_pk_bf16_f32 v144, v68, v69
  v_cvt_pk_bf16_f32 v145, v70, v71
  v_cvt_pk_bf16_f32 v146, v72, v73
  v_cvt_pk_bf16_f32 v147, v74, v75
  s_nop 1
  v_permlane16_swap_b32 v144, v146
  v_permlane16_swap_b32 v145, v147
  s_mov_b32 s30, 20480
  s_cmp_lg_u32 s73, 0
  s_cbranch_scc1 .dp_30
  buffer_store_dwordx4 v[144:147], v210, s[4:7], s30 offen offset:192 sc1
  s_branch .de_31
.dp_30:
  buffer_store_dwordx4 v[144:147], v210, s[4:7], s30 offen offset:192
.de_31:
.sm_27:
  v_cvt_pk_bf16_f32 v224, v4, v5
  v_cvt_pk_bf16_f32 v225, v6, v7
  v_cvt_pk_bf16_f32 v226, v8, v9
  v_cvt_pk_bf16_f32 v227, v10, v11
  v_cvt_pk_bf16_f32 v228, v12, v13
  v_cvt_pk_bf16_f32 v229, v14, v15
  v_cvt_pk_bf16_f32 v230, v16, v17
  v_cvt_pk_bf16_f32 v231, v18, v19
  v_cvt_pk_bf16_f32 v232, v20, v21
  v_cvt_pk_bf16_f32 v233, v22, v23
  v_cvt_pk_bf16_f32 v234, v24, v25
  v_cvt_pk_bf16_f32 v235, v26, v27
  v_cvt_pk_bf16_f32 v236, v28, v29
  v_cvt_pk_bf16_f32 v237, v30, v31
  v_cvt_pk_bf16_f32 v238, v32, v33
  v_cvt_pk_bf16_f32 v239, v34, v35
  s_waitcnt vmcnt(0)
  v_mov_b32 v188, 162884
  v_mov_b32 v189, 1
  s_mov_b64 exec, 1
  ds_add_rtn_u32 v190, v188, v189
  s_mov_b64 exec, -1
  s_lshl_b32 s30, s24, 3
  s_add_u32 s30, s30, 0x1b60000
  s_waitcnt lgkmcnt(0)
  v_readfirstlane_b32 s31, v190
  v_mov_b32 v188, s30
  v_mov_b32 v190, s26
  v_mov_b32 v191, s27
  s_cmp_lg_u32 s31, 3
  s_cbranch_scc1 .sg_32
  s_mov_b64 exec, 1
  s_mov_b32 s30, 57344
  s_cmp_lg_u32 s25, 0
  s_cbranch_scc1 .dp_33
  buffer_store_dwordx2 v[190:191], v188, s[4:7], s30 offen sc1
  s_branch .de_34
.dp_33:
  buffer_store_dwordx2 v[190:191], v188, s[4:7], s30 offen
.de_34:
  s_mov_b32 s30, 8192
  buffer_store_dwordx2 v[190:191], v188, s[4:7], s30 offen sc1
  s_mov_b64 exec, -1
.sg_32:
  v_cvt_pk_bf16_f32 v240, v44, v45
  v_cvt_pk_bf16_f32 v241, v46, v47
  v_cvt_pk_bf16_f32 v242, v48, v49
  v_cvt_pk_bf16_f32 v243, v50, v51
  v_cvt_pk_bf16_f32 v244, v52, v53
  v_cvt_pk_bf16_f32 v245, v54, v55
  v_cvt_pk_bf16_f32 v246, v56, v57
  v_cvt_pk_bf16_f32 v247, v58, v59
  v_cvt_pk_bf16_f32 v248, v60, v61
  v_cvt_pk_bf16_f32 v249, v62, v63
  v_cvt_pk_bf16_f32 v250, v64, v65
  v_cvt_pk_bf16_f32 v251, v66, v67
  v_cvt_pk_bf16_f32 v252, v68, v69
  v_cvt_pk_bf16_f32 v253, v70, v71
  v_cvt_pk_bf16_f32 v254, v72, v73
  v_cvt_pk_bf16_f32 v255, v74, v75
  s_nop 0
  v_permlane16_swap_b32 v224, v226
  v_permlane16_swap_b32 v225, v227
  v_permlane16_swap_b32 v228, v230
  v_permlane16_swap_b32 v229, v231
  v_permlane16_swap_b32 v232, v234
  v_permlane16_swap_b32 v233, v235
  v_permlane16_swap_b32 v236, v238
  v_permlane16_swap_b32 v237, v239
  v_permlane16_swap_b32 v240, v242
  v_permlane16_swap_b32 v241, v243
  v_permlane16_swap_b32 v244, v246
  v_permlane16_swap_b32 v245, v247
  v_permlane16_swap_b32 v248, v250
  v_permlane16_swap_b32 v249, v251
  v_permlane16_swap_b32 v252, v254
  v_permlane16_swap_b32 v253, v255
  s_mov_b32 s32, 0
  s_cmp_lg_u32 s25, 0
  s_cbranch_scc1 .dp_35
  buffer_store_dwordx4 v[224:227], v207, s[4:7], s32 offen offset:0 sc1
  buffer_store_dwordx4 v[228:231], v207, s[4:7], s32 offen offset:64 sc1
  buffer_store_dwordx4 v[232:235], v207, s[4:7], s32 offen offset:128 sc1
  s_branch .de_36
.dp_35:
  buffer_store_dwordx4 v[224:227], v207, s[4:7], s32 offen offset:0
  buffer_store_dwordx4 v[228:231], v207, s[4:7], s32 offen offset:64
  buffer_store_dwordx4 v[232:235], v207, s[4:7], s32 offen offset:128
.de_36:
  s_mov_b32 s32, 61440
  s_cmp_lg_u32 s73, 0
  s_cbranch_scc1 .dp_37
  buffer_store_dwordx4 v[240:243], v207, s[4:7], s32 offen offset:0 sc1
  buffer_store_dwordx4 v[244:247], v207, s[4:7], s32 offen offset:64 sc1
  buffer_store_dwordx4 v[248:251], v207, s[4:7], s32 offen offset:128 sc1
  s_branch .de_38
.dp_37:
  buffer_store_dwordx4 v[240:243], v207, s[4:7], s32 offen offset:0
  buffer_store_dwordx4 v[244:247], v207, s[4:7], s32 offen offset:64
  buffer_store_dwordx4 v[248:251], v207, s[4:7], s32 offen offset:128
.de_38:
  s_cmp_lg_u32 s64, 0
  s_cbranch_scc1 .q3_39
  s_mov_b32 s32, 0
  s_cmp_lg_u32 s25, 0
  s_cbranch_scc1 .dp_40
  buffer_store_dwordx4 v[236:239], v207, s[4:7], s32 offen offset:192 sc1
  s_branch .de_41
.dp_40:
  buffer_store_dwordx4 v[236:239], v207, s[4:7], s32 offen offset:192
.de_41:
  s_mov_b32 s32, 61440
  s_cmp_lg_u32 s73, 0
  s_cbranch_scc1 .dp_42
  buffer_store_dwordx4 v[252:255], v207, s[4:7], s32 offen offset:192 sc1
  s_branch .de_43
.dp_42:
  buffer_store_dwordx4 v[252:255], v207, s[4:7], s32 offen offset:192
.de_43:
.q3_39:
  s_mov_b32 s8, s40
  s_mov_b32 s9, s41
  s_mov_b32 s10, 0x280000
  s_mov_b32 s11, 0x20000
  s_lshl_b32 s30, s21, 4
  s_add_u32 s30, s30, s67
  v_and_b32 v204, 15, v1
  v_add_u32 v204, s30, v204
  v_lshrrev_b32 v201, 4, v1
  v_mul_u32_u24 v206, 1280, v204
  s_mul_i32 s30, s66, 160
  v_lshl_add_u32 v206, v201, 3, v206
  v_add_u32 v206, s30, v206
  buffer_load_dwordx2 v[212:213], v206, s[8:11], 0 offen offset:0
  buffer_load_dwordx2 v[214:215], v206, s[8:11], 0 offen offset:32
  buffer_load_dwordx2 v[216:217], v206, s[8:11], 0 offen offset:64
  buffer_load_dwordx2 v[218:219], v206, s[8:11], 0 offen offset:96
  buffer_load_dwordx2 v[220:221], v206, s[8:11], 0 offen offset:128
  v_mul_u32_u24 v184, 160, v208
  v_add_u32 v184, v184, v209
  v_add_u32 v185, 73728, v184
  s_lshl_b32 s30, s21, 11
  s_add_u32 s30, s30, 20480
  v_add_u32 v180, s30, v211
  v_xor_b32 v182, 64, v180
  v_add_u32 v181, 73728, v180
  v_add_u32 v183, 73728, v182
  s_waitcnt vmcnt(0)
  v_mov_b32 v188, 162888
  v_mov_b32 v189, 1
  s_mov_b64 exec, 1
  ds_add_rtn_u32 v190, v188, v189
  s_mov_b64 exec, -1
  s_lshl_b32 s30, s24, 3
  s_add_u32 s30, s30, 0x1b60000
  s_waitcnt lgkmcnt(0)
  v_readfirstlane_b32 s31, v190
  v_mov_b32 v188, s30
  v_mov_b32 v190, s26
  v_mov_b32 v191, s27
  s_cmp_lg_u32 s31, 3
  s_cbranch_scc1 .sg_44
  s_mov_b64 exec, 1
  s_mov_b32 s30, 65536
  s_cmp_lg_u32 s25, 0
  s_cbranch_scc1 .dp_45
  buffer_store_dwordx2 v[190:191], v188, s[4:7], s30 offen sc1
  s_branch .de_46
.dp_45:
  buffer_store_dwordx2 v[190:191], v188, s[4:7], s30 offen
.de_46:
  s_mov_b32 s30, 16384
  buffer_store_dwordx2 v[190:191], v188, s[4:7], s30 offen sc1
  s_mov_b64 exec, -1
.sg_44:
  s_barrier
  ds_read_b64_tr_b16 v[100:101], v185 offset:0
  ds_read_b64_tr_b16 v[102:103], v185 offset:1280
  ds_read_b128 v[84:87], v181 offset:0
  ds_read_b64_tr_b16 v[104:105], v185 offset:32
  ds_read_b64_tr_b16 v[106:107], v185 offset:1312
  ds_read_b64_tr_b16 v[108:109], v185 offset:64
  ds_read_b64_tr_b16 v[110:111], v185 offset:1344
  ds_read_b64_tr_b16 v[112:113], v185 offset:96
  ds_read_b64_tr_b16 v[114:115], v185 offset:1376
  ds_read_b64_tr_b16 v[116:117], v185 offset:128
  ds_read_b64_tr_b16 v[118:119], v185 offset:1408
  ds_read_b64_tr_b16 v[120:121], v185 offset:5120
  ds_read_b64_tr_b16 v[122:123], v185 offset:6400
  ds_read_b128 v[88:91], v183 offset:0
  ds_read_b64_tr_b16 v[124:125], v185 offset:5152
  ds_read_b64_tr_b16 v[126:127], v185 offset:6432
  ds_read_b64_tr_b16 v[128:129], v185 offset:5184
  ds_read_b64_tr_b16 v[130:131], v185 offset:6464
  ds_read_b64_tr_b16 v[132:133], v185 offset:5216
  ds_read_b64_tr_b16 v[134:135], v185 offset:6496
  ds_read_b64_tr_b16 v[136:137], v185 offset:5248
  ds_read_b64_tr_b16 v[138:139], v185 offset:6528
  s_waitcnt lgkmcnt(11)
  v_mfma_f32_16x16x32_bf16 v[160:163], v[100:103], v[84:87], 0
  ds_read_b64_tr_b16 v[140:141], v185 offset:10240
  ds_read_b64_tr_b16 v[142:143], v185 offset:11520
  ds_read_b128 v[92:95], v181 offset:8192
  v_mfma_f32_16x16x32_bf16 v[164:167], v[104:107], v[84:87], 0
  ds_read_b64_tr_b16 v[144:145], v185 offset:10272
  ds_read_b64_tr_b16 v[146:147], v185 offset:11552
  v_mfma_f32_16x16x32_bf16 v[168:171], v[108:111], v[84:87], 0
  ds_read_b64_tr_b16 v[148:149], v185 offset:10304
  ds_read_b64_tr_b16 v[150:151], v185 offset:11584
  v_mfma_f32_16x16x32_bf16 v[172:175], v[112:115], v[84:87], 0
  ds_read_b64_tr_b16 v[152:153], v185 offset:10336
  ds_read_b64_tr_b16 v[154:155], v185 offset:11616
  v_mfma_f32_16x16x32_bf16 v[176:179], v[116:119], v[84:87], 0
  ds_read_b64_tr_b16 v[156:157], v185 offset:10368
  ds_read_b64_tr_b16 v[158:159], v185 offset:11648
  s_waitcnt lgkmcnt(11)
  v_mfma_f32_16x16x32_bf16 v[160:163], v[120:123], v[88:91], v[160:163]
  ds_read_b64_tr_b16 v[100:101], v185 offset:15360
  ds_read_b64_tr_b16 v[102:103], v185 offset:16640
  ds_read_b128 v[84:87], v183 offset:8192
  v_mfma_f32_16x16x32_bf16 v[164:167], v[124:127], v[88:91], v[164:167]
  ds_read_b64_tr_b16 v[104:105], v185 offset:15392
  ds_read_b64_tr_b16 v[106:107], v185 offset:16672
  v_mfma_f32_16x16x32_bf16 v[168:171], v[128:131], v[88:91], v[168:171]
  ds_read_b64_tr_b16 v[108:109], v185 offset:15424
  ds_read_b64_tr_b16 v[110:111], v185 offset:16704
  v_mfma_f32_16x16x32_bf16 v[172:175], v[132:135], v[88:91], v[172:175]
  ds_read_b64_tr_b16 v[112:113], v185 offset:15456
  ds_read_b64_tr_b16 v[114:115], v185 offset:16736
  v_mfma_f32_16x16x32_bf16 v[176:179], v[136:139], v[88:91], v[176:179]
  ds_read_b64_tr_b16 v[116:117], v185 offset:15488
  ds_read_b64_tr_b16 v[118:119], v185 offset:16768
  s_waitcnt lgkmcnt(11)
  s_barrier
  v_mfma_f32_16x16x32_bf16 v[160:163], v[140:143], v[92:95], v[160:163]
  ds_read_b64_tr_b16 v[120:121], v185 offset:36864
  ds_read_b64_tr_b16 v[122:123], v185 offset:38144
  ds_read_b128 v[88:91], v181 offset:36864
  v_mfma_f32_16x16x32_bf16 v[164:167], v[144:147], v[92:95], v[164:167]
  ds_read_b64_tr_b16 v[124:125], v185 offset:36896
  ds_read_b64_tr_b16 v[126:127], v185 offset:38176
  v_mfma_f32_16x16x32_bf16 v[168:171], v[148:151], v[92:95], v[168:171]
  ds_read_b64_tr_b16 v[128:129], v185 offset:36928
  ds_read_b64_tr_b16 v[130:131], v185 offset:38208
  v_mfma_f32_16x16x32_bf16 v[172:175], v[152:155], v[92:95], v[172:175]
  ds_read_b64_tr_b16 v[132:133], v185 offset:36960
  ds_read_b64_tr_b16 v[134:135], v185 offset:38240
  v_mfma_f32_16x16x32_bf16 v[176:179], v[156:159], v[92:95], v[176:179]
  ds_read_b64_tr_b16 v[136:137], v185 offset:36992
  ds_read_b64_tr_b16 v[138:139], v185 offset:38272
  s_waitcnt lgkmcnt(11)
  v_mfma_f32_16x16x32_bf16 v[160:163], v[100:103], v[84:87], v[160:163]
  ds_read_b64_tr_b16 v[140:141], v185 offset:41984
  ds_read_b64_tr_b16 v[142:143], v185 offset:43264
  ds_read_b128 v[92:95], v183 offset:36864
  v_mfma_f32_16x16x32_bf16 v[164:167], v[104:107], v[84:87], v[164:167]
  ds_read_b64_tr_b16 v[144:145], v185 offset:42016
  ds_read_b64_tr_b16 v[146:147], v185 offset:43296
  v_mfma_f32_16x16x32_bf16 v[168:171], v[108:111], v[84:87], v[168:171]
  ds_read_b64_tr_b16 v[148:149], v185 offset:42048
  ds_read_b64_tr_b16 v[150:151], v185 offset:43328
  v_mfma_f32_16x16x32_bf16 v[172:175], v[112:115], v[84:87], v[172:175]
  ds_read_b64_tr_b16 v[152:153], v185 offset:42080
  ds_read_b64_tr_b16 v[154:155], v185 offset:43360
  v_mfma_f32_16x16x32_bf16 v[176:179], v[116:119], v[84:87], v[176:179]
  ds_read_b64_tr_b16 v[156:157], v185 offset:42112
  ds_read_b64_tr_b16 v[158:159], v185 offset:43392
  s_waitcnt lgkmcnt(11)
  v_mfma_f32_16x16x32_bf16 v[160:163], v[120:123], v[88:91], v[160:163]
  ds_read_b64_tr_b16 v[100:101], v185 offset:47104
  ds_read_b64_tr_b16 v[102:103], v185 offset:48384
  ds_read_b128 v[84:87], v181 offset:45056
  v_mfma_f32_16x16x32_bf16 v[164:167], v[124:127], v[88:91], v[164:167]
  ds_read_b64_tr_b16 v[104:105], v185 offset:47136
  ds_read_b64_tr_b16 v[106:107], v185 offset:48416
  v_mfma_f32_16x16x32_bf16 v[168:171], v[128:131], v[88:91], v[168:171]
  ds_read_b64_tr_b16 v[108:109], v185 offset:47168
  ds_read_b64_tr_b16 v[110:111], v185 offset:48448
  v_mfma_f32_16x16x32_bf16 v[172:175], v[132:135], v[88:91], v[172:175]
  ds_read_b64_tr_b16 v[112:113], v185 offset:47200
  ds_read_b64_tr_b16 v[114:115], v185 offset:48480
  v_mfma_f32_16x16x32_bf16 v[176:179], v[136:139], v[88:91], v[176:179]
  ds_read_b64_tr_b16 v[116:117], v185 offset:47232
  ds_read_b64_tr_b16 v[118:119], v185 offset:48512
  s_waitcnt lgkmcnt(11)
  v_mfma_f32_16x16x32_bf16 v[160:163], v[140:143], v[92:95], v[160:163]
  ds_read_b64_tr_b16 v[120:121], v185 offset:52224
  ds_read_b64_tr_b16 v[122:123], v185 offset:53504
  ds_read_b128 v[88:91], v183 offset:45056
  v_mfma_f32_16x16x32_bf16 v[164:167], v[144:147], v[92:95], v[164:167]
  ds_read_b64_tr_b16 v[124:125], v185 offset:52256
  ds_read_b64_tr_b16 v[126:127], v185 offset:53536
  v_mfma_f32_16x16x32_bf16 v[168:171], v[148:151], v[92:95], v[168:171]
  ds_read_b64_tr_b16 v[128:129], v185 offset:52288
  ds_read_b64_tr_b16 v[130:131], v185 offset:53568
  v_mfma_f32_16x16x32_bf16 v[172:175], v[152:155], v[92:95], v[172:175]
  ds_read_b64_tr_b16 v[132:133], v185 offset:52320
  ds_read_b64_tr_b16 v[134:135], v185 offset:53600
  v_mfma_f32_16x16x32_bf16 v[176:179], v[156:159], v[92:95], v[176:179]
  ds_read_b64_tr_b16 v[136:137], v185 offset:52352
  ds_read_b64_tr_b16 v[138:139], v185 offset:53632
  s_waitcnt lgkmcnt(11)
  s_barrier
  v_mfma_f32_16x16x32_bf16 v[160:163], v[100:103], v[84:87], v[160:163]
  ds_read_b64_tr_b16 v[140:141], v184 offset:0
  ds_read_b64_tr_b16 v[142:143], v184 offset:1280
  ds_read_b128 v[92:95], v180 offset:0
  v_mfma_f32_16x16x32_bf16 v[164:167], v[104:107], v[84:87], v[164:167]
  ds_read_b64_tr_b16 v[144:145], v184 offset:32
  ds_read_b64_tr_b16 v[146:147], v184 offset:1312
  v_mfma_f32_16x16x32_bf16 v[168:171], v[108:111], v[84:87], v[168:171]
  ds_read_b64_tr_b16 v[148:149], v184 offset:64
  ds_read_b64_tr_b16 v[150:151], v184 offset:1344
  v_mfma_f32_16x16x32_bf16 v[172:175], v[112:115], v[84:87], v[172:175]
  ds_read_b64_tr_b16 v[152:153], v184 offset:96
  ds_read_b64_tr_b16 v[154:155], v184 offset:1376
  v_mfma_f32_16x16x32_bf16 v[176:179], v[116:119], v[84:87], v[176:179]
  ds_read_b64_tr_b16 v[156:157], v184 offset:128
  ds_read_b64_tr_b16 v[158:159], v184 offset:1408
  s_waitcnt lgkmcnt(11)
  v_mfma_f32_16x16x32_bf16 v[160:163], v[120:123], v[88:91], v[160:163]
  ds_read_b64_tr_b16 v[100:101], v184 offset:5120
  ds_read_b64_tr_b16 v[102:103], v184 offset:6400
  ds_read_b128 v[84:87], v182 offset:0
  v_mfma_f32_16x16x32_bf16 v[164:167], v[124:127], v[88:91], v[164:167]
  ds_read_b64_tr_b16 v[104:105], v184 offset:5152
  ds_read_b64_tr_b16 v[106:107], v184 offset:6432
  v_mfma_f32_16x16x32_bf16 v[168:171], v[128:131], v[88:91], v[168:171]
  ds_read_b64_tr_b16 v[108:109], v184 offset:5184
  ds_read_b64_tr_b16 v[110:111], v184 offset:6464
  v_mfma_f32_16x16x32_bf16 v[172:175], v[132:135], v[88:91], v[172:175]
  ds_read_b64_tr_b16 v[112:113], v184 offset:5216
  ds_read_b64_tr_b16 v[114:115], v184 offset:6496
  v_mfma_f32_16x16x32_bf16 v[176:179], v[136:139], v[88:91], v[176:179]
  ds_read_b64_tr_b16 v[116:117], v184 offset:5248
  ds_read_b64_tr_b16 v[118:119], v184 offset:6528
  s_waitcnt lgkmcnt(11)
  v_mfma_f32_16x16x32_bf16 v[160:163], v[140:143], v[92:95], v[160:163]
  ds_read_b64_tr_b16 v[120:121], v184 offset:10240
  ds_read_b64_tr_b16 v[122:123], v184 offset:11520
  ds_read_b128 v[88:91], v180 offset:8192
  v_mfma_f32_16x16x32_bf16 v[164:167], v[144:147], v[92:95], v[164:167]
  ds_read_b64_tr_b16 v[124:125], v184 offset:10272
  ds_read_b64_tr_b16 v[126:127], v184 offset:11552
  v_mfma_f32_16x16x32_bf16 v[168:171], v[148:151], v[92:95], v[168:171]
  ds_read_b64_tr_b16 v[128:129], v184 offset:10304
  ds_read_b64_tr_b16 v[130:131], v184 offset:11584
  v_mfma_f32_16x16x32_bf16 v[172:175], v[152:155], v[92:95], v[172:175]
  ds_read_b64_tr_b16 v[132:133], v184 offset:10336
  ds_read_b64_tr_b16 v[134:135], v184 offset:11616
  v_mfma_f32_16x16x32_bf16 v[176:179], v[156:159], v[92:95], v[176:179]
  ds_read_b64_tr_b16 v[136:137], v184 offset:10368
  ds_read_b64_tr_b16 v[138:139], v184 offset:11648
  s_waitcnt lgkmcnt(11)
  v_mfma_f32_16x16x32_bf16 v[160:163], v[100:103], v[84:87], v[160:163]
  ds_read_b64_tr_b16 v[140:141], v184 offset:15360
  ds_read_b64_tr_b16 v[142:143], v184 offset:16640
  ds_read_b128 v[92:95], v182 offset:8192
  v_mfma_f32_16x16x32_bf16 v[164:167], v[104:107], v[84:87], v[164:167]
  ds_read_b64_tr_b16 v[144:145], v184 offset:15392
  ds_read_b64_tr_b16 v[146:147], v184 offset:16672
  v_mfma_f32_16x16x32_bf16 v[168:171], v[108:111], v[84:87], v[168:171]
  ds_read_b64_tr_b16 v[148:149], v184 offset:15424
  ds_read_b64_tr_b16 v[150:151], v184 offset:16704
  v_mfma_f32_16x16x32_bf16 v[172:175], v[112:115], v[84:87], v[172:175]
  ds_read_b64_tr_b16 v[152:153], v184 offset:15456
  ds_read_b64_tr_b16 v[154:155], v184 offset:16736
  v_mfma_f32_16x16x32_bf16 v[176:179], v[116:119], v[84:87], v[176:179]
  ds_read_b64_tr_b16 v[156:157], v184 offset:15488
  ds_read_b64_tr_b16 v[158:159], v184 offset:16768
  s_waitcnt lgkmcnt(11)
  s_barrier
  v_mfma_f32_16x16x32_bf16 v[160:163], v[120:123], v[88:91], v[160:163]
  ds_read_b64_tr_b16 v[100:101], v184 offset:36864
  ds_read_b64_tr_b16 v[102:103], v184 offset:38144
  ds_read_b128 v[84:87], v180 offset:36864
  v_mfma_f32_16x16x32_bf16 v[164:167], v[124:127], v[88:91], v[164:167]
  ds_read_b64_tr_b16 v[104:105], v184 offset:36896
  ds_read_b64_tr_b16 v[106:107], v184 offset:38176
  v_mfma_f32_16x16x32_bf16 v[168:171], v[128:131], v[88:91], v[168:171]
  ds_read_b64_tr_b16 v[108:109], v184 offset:36928
  ds_read_b64_tr_b16 v[110:111], v184 offset:38208
  v_mfma_f32_16x16x32_bf16 v[172:175], v[132:135], v[88:91], v[172:175]
  ds_read_b64_tr_b16 v[112:113], v184 offset:36960
  ds_read_b64_tr_b16 v[114:115], v184 offset:38240
  v_mfma_f32_16x16x32_bf16 v[176:179], v[136:139], v[88:91], v[176:179]
  ds_read_b64_tr_b16 v[116:117], v184 offset:36992
  ds_read_b64_tr_b16 v[118:119], v184 offset:38272
  s_waitcnt lgkmcnt(11)
  v_mfma_f32_16x16x32_bf16 v[160:163], v[140:143], v[92:95], v[160:163]
  ds_read_b64_tr_b16 v[120:121], v184 offset:41984
  ds_read_b64_tr_b16 v[122:123], v184 offset:43264
  ds_read_b128 v[88:91], v182 offset:36864
  v_mfma_f32_16x16x32_bf16 v[164:167], v[144:147], v[92:95], v[164:167]
  ds_read_b64_tr_b16 v[124:125], v184 offset:42016
  ds_read_b64_tr_b16 v[126:127], v184 offset:43296
  v_mfma_f32_16x16x32_bf16 v[168:171], v[148:151], v[92:95], v[168:171]
  ds_read_b64_tr_b16 v[128:129], v184 offset:42048
  ds_read_b64_tr_b16 v[130:131], v184 offset:43328
  v_mfma_f32_16x16x32_bf16 v[172:175], v[152:155], v[92:95], v[172:175]
  ds_read_b64_tr_b16 v[132:133], v184 offset:42080
  ds_read_b64_tr_b16 v[134:135], v184 offset:43360
  v_mfma_f32_16x16x32_bf16 v[176:179], v[156:159], v[92:95], v[176:179]
  ds_read_b64_tr_b16 v[136:137], v184 offset:42112
  ds_read_b64_tr_b16 v[138:139], v184 offset:43392
  s_waitcnt lgkmcnt(11)
  v_mfma_f32_16x16x32_bf16 v[160:163], v[100:103], v[84:87], v[160:163]
  ds_read_b64_tr_b16 v[140:141], v184 offset:47104
  ds_read_b64_tr_b16 v[142:143], v184 offset:48384
  ds_read_b128 v[92:95], v180 offset:45056
  v_mfma_f32_16x16x32_bf16 v[164:167], v[104:107], v[84:87], v[164:167]
  ds_read_b64_tr_b16 v[144:145], v184 offset:47136
  ds_read_b64_tr_b16 v[146:147], v184 offset:48416
  v_mfma_f32_16x16x32_bf16 v[168:171], v[108:111], v[84:87], v[168:171]
  ds_read_b64_tr_b16 v[148:149], v184 offset:47168
  ds_read_b64_tr_b16 v[150:151], v184 offset:48448
  v_mfma_f32_16x16x32_bf16 v[172:175], v[112:115], v[84:87], v[172:175]
  ds_read_b64_tr_b16 v[152:153], v184 offset:47200
  ds_read_b64_tr_b16 v[154:155], v184 offset:48480
  v_mfma_f32_16x16x32_bf16 v[176:179], v[116:119], v[84:87], v[176:179]
  ds_read_b64_tr_b16 v[156:157], v184 offset:47232
  ds_read_b64_tr_b16 v[158:159], v184 offset:48512
  s_waitcnt lgkmcnt(11)
  v_mfma_f32_16x16x32_bf16 v[160:163], v[120:123], v[88:91], v[160:163]
  ds_read_b64_tr_b16 v[100:101], v184 offset:52224
  ds_read_b64_tr_b16 v[102:103], v184 offset:53504
  ds_read_b128 v[84:87], v182 offset:45056
  v_mfma_f32_16x16x32_bf16 v[164:167], v[124:127], v[88:91], v[164:167]
  ds_read_b64_tr_b16 v[104:105], v184 offset:52256
  ds_read_b64_tr_b16 v[106:107], v184 offset:53536
  v_mfma_f32_16x16x32_bf16 v[168:171], v[128:131], v[88:91], v[168:171]
  ds_read_b64_tr_b16 v[108:109], v184 offset:52288
  ds_read_b64_tr_b16 v[110:111], v184 offset:53568
  v_mfma_f32_16x16x32_bf16 v[172:175], v[132:135], v[88:91], v[172:175]
  ds_read_b64_tr_b16 v[112:113], v184 offset:52320
  ds_read_b64_tr_b16 v[114:115], v184 offset:53600
  v_mfma_f32_16x16x32_bf16 v[176:179], v[136:139], v[88:91], v[176:179]
  ds_read_b64_tr_b16 v[116:117], v184 offset:52352
  ds_read_b64_tr_b16 v[118:119], v184 offset:53632
  s_waitcnt lgkmcnt(11)
  s_barrier
  v_mfma_f32_16x16x32_bf16 v[160:163], v[140:143], v[92:95], v[160:163]
  ds_read_b64_tr_b16 v[120:121], v185 offset:0
  ds_read_b64_tr_b16 v[122:123], v185 offset:1280
  ds_read_b128 v[88:91], v181 offset:0
  v_mfma_f32_16x16x32_bf16 v[164:167], v[144:147], v[92:95], v[164:167]
  ds_read_b64_tr_b16 v[124:125], v185 offset:32
  ds_read_b64_tr_b16 v[126:127], v185 offset:1312
  v_mfma_f32_16x16x32_bf16 v[168:171], v[148:151], v[92:95], v[168:171]
  ds_read_b64_tr_b16 v[128:129], v185 offset:64
  ds_read_b64_tr_b16 v[130:131], v185 offset:1344
  v_mfma_f32_16x16x32_bf16 v[172:175], v[152:155], v[92:95], v[172:175]
  ds_read_b64_tr_b16 v[132:133], v185 offset:96
  ds_read_b64_tr_b16 v[134:135], v185 offset:1376
  v_mfma_f32_16x16x32_bf16 v[176:179], v[156:159], v[92:95], v[176:179]
  ds_read_b64_tr_b16 v[136:137], v185 offset:128
  ds_read_b64_tr_b16 v[138:139], v185 offset:1408
  s_waitcnt lgkmcnt(11)
  v_mfma_f32_16x16x32_bf16 v[160:163], v[100:103], v[84:87], v[160:163]
  ds_read_b64_tr_b16 v[140:141], v185 offset:5120
  ds_read_b64_tr_b16 v[142:143], v185 offset:6400
  ds_read_b128 v[92:95], v183 offset:0
  v_mfma_f32_16x16x32_bf16 v[164:167], v[104:107], v[84:87], v[164:167]
  ds_read_b64_tr_b16 v[144:145], v185 offset:5152
  ds_read_b64_tr_b16 v[146:147], v185 offset:6432
  v_mfma_f32_16x16x32_bf16 v[168:171], v[108:111], v[84:87], v[168:171]
  ds_read_b64_tr_b16 v[148:149], v185 offset:5184
  ds_read_b64_tr_b16 v[150:151], v185 offset:6464
  v_mfma_f32_16x16x32_bf16 v[172:175], v[112:115], v[84:87], v[172:175]
  ds_read_b64_tr_b16 v[152:153], v185 offset:5216
  ds_read_b64_tr_b16 v[154:155], v185 offset:6496
  v_mfma_f32_16x16x32_bf16 v[176:179], v[116:119], v[84:87], v[176:179]
  ds_read_b64_tr_b16 v[156:157], v185 offset:5248
  ds_read_b64_tr_b16 v[158:159], v185 offset:6528
  s_waitcnt lgkmcnt(11)
  v_mfma_f32_16x16x32_bf16 v[160:163], v[120:123], v[88:91], v[160:163]
  ds_read_b64_tr_b16 v[100:101], v185 offset:10240
  ds_read_b64_tr_b16 v[102:103], v185 offset:11520
  ds_read_b128 v[84:87], v181 offset:8192
  v_mfma_f32_16x16x32_bf16 v[164:167], v[124:127], v[88:91], v[164:167]
  ds_read_b64_tr_b16 v[104:105], v185 offset:10272
  ds_read_b64_tr_b16 v[106:107], v185 offset:11552
  v_mfma_f32_16x16x32_bf16 v[168:171], v[128:131], v[88:91], v[168:171]
  ds_read_b64_tr_b16 v[108:109], v185 offset:10304
  ds_read_b64_tr_b16 v[110:111], v185 offset:11584
  v_mfma_f32_16x16x32_bf16 v[172:175], v[132:135], v[88:91], v[172:175]
  ds_read_b64_tr_b16 v[112:113], v185 offset:10336
  ds_read_b64_tr_b16 v[114:115], v185 offset:11616
  v_mfma_f32_16x16x32_bf16 v[176:179], v[136:139], v[88:91], v[176:179]
  ds_read_b64_tr_b16 v[116:117], v185 offset:10368
  ds_read_b64_tr_b16 v[118:119], v185 offset:11648
  s_waitcnt lgkmcnt(11)
  v_mfma_f32_16x16x32_bf16 v[160:163], v[140:143], v[92:95], v[160:163]
  ds_read_b64_tr_b16 v[120:121], v185 offset:15360
  ds_read_b64_tr_b16 v[122:123], v185 offset:16640
  ds_read_b128 v[88:91], v183 offset:8192
  v_mfma_f32_16x16x32_bf16 v[164:167], v[144:147], v[92:95], v[164:167]
  ds_read_b64_tr_b16 v[124:125], v185 offset:15392
  ds_read_b64_tr_b16 v[126:127], v185 offset:16672
  v_mfma_f32_16x16x32_bf16 v[168:171], v[148:151], v[92:95], v[168:171]
  ds_read_b64_tr_b16 v[128:129], v185 offset:15424
  ds_read_b64_tr_b16 v[130:131], v185 offset:16704
  v_mfma_f32_16x16x32_bf16 v[172:175], v[152:155], v[92:95], v[172:175]
  ds_read_b64_tr_b16 v[132:133], v185 offset:15456
  ds_read_b64_tr_b16 v[134:135], v185 offset:16736
  v_mfma_f32_16x16x32_bf16 v[176:179], v[156:159], v[92:95], v[176:179]
  ds_read_b64_tr_b16 v[136:137], v185 offset:15488
  ds_read_b64_tr_b16 v[138:139], v185 offset:16768
  s_waitcnt lgkmcnt(11)
  v_mfma_f32_16x16x32_bf16 v[160:163], v[100:103], v[84:87], v[160:163]
  v_mfma_f32_16x16x32_bf16 v[164:167], v[104:107], v[84:87], v[164:167]
  v_mfma_f32_16x16x32_bf16 v[168:171], v[108:111], v[84:87], v[168:171]
  v_mfma_f32_16x16x32_bf16 v[172:175], v[112:115], v[84:87], v[172:175]
  v_mfma_f32_16x16x32_bf16 v[176:179], v[116:119], v[84:87], v[176:179]
  s_waitcnt lgkmcnt(0)
  v_mfma_f32_16x16x32_bf16 v[160:163], v[120:123], v[88:91], v[160:163]
  v_mfma_f32_16x16x32_bf16 v[164:167], v[124:127], v[88:91], v[164:167]
  v_mfma_f32_16x16x32_bf16 v[168:171], v[128:131], v[88:91], v[168:171]
  v_mfma_f32_16x16x32_bf16 v[172:175], v[132:135], v[88:91], v[172:175]
  v_mfma_f32_16x16x32_bf16 v[176:179], v[136:139], v[88:91], v[176:179]
  s_barrier
  s_nop 7
  v_lshlrev_b32 v4, 16, v212
  v_and_b32 v5, 0xffff0000, v212
  v_lshlrev_b32 v6, 16, v213
  v_and_b32 v7, 0xffff0000, v213
  v_pk_add_f32 v[4:5], v[4:5], v[160:161]
  v_pk_add_f32 v[6:7], v[6:7], v[162:163]
  v_cvt_pk_bf16_f32 v212, v4, v5
  v_cvt_pk_bf16_f32 v213, v6, v7
  v_lshlrev_b32 v4, 16, v212
  v_and_b32 v5, 0xffff0000, v212
  v_lshlrev_b32 v6, 16, v213
  v_and_b32 v7, 0xffff0000, v213
  v_lshlrev_b32 v8, 16, v214
  v_and_b32 v9, 0xffff0000, v214
  v_lshlrev_b32 v10, 16, v215
  v_and_b32 v11, 0xffff0000, v215
  v_pk_add_f32 v[8:9], v[8:9], v[164:165]
  v_pk_add_f32 v[10:11], v[10:11], v[166:167]
  v_cvt_pk_bf16_f32 v214, v8, v9
  v_cvt_pk_bf16_f32 v215, v10, v11
  v_lshlrev_b32 v8, 16, v214
  v_and_b32 v9, 0xffff0000, v214
  v_lshlrev_b32 v10, 16, v215
  v_and_b32 v11, 0xffff0000, v215
  v_lshlrev_b32 v12, 16, v216
  v_and_b32 v13, 0xffff0000, v216
  v_lshlrev_b32 v14, 16, v217
  v_and_b32 v15, 0xffff0000, v217
  v_pk_add_f32 v[12:13], v[12:13], v[168:169]
  v_pk_add_f32 v[14:15], v[14:15], v[170:171]
  v_cvt_pk_bf16_f32 v216, v12, v13
  v_cvt_pk_bf16_f32 v217, v14, v15
  v_lshlrev_b32 v12, 16, v216
  v_and_b32 v13, 0xffff0000, v216
  v_lshlrev_b32 v14, 16, v217
  v_and_b32 v15, 0xffff0000, v217
  v_lshlrev_b32 v16, 16, v218
  v_and_b32 v17, 0xffff0000, v218
  v_lshlrev_b32 v18, 16, v219
  v_and_b32 v19, 0xffff0000, v219
  v_pk_add_f32 v[16:17], v[16:17], v[172:173]
  v_pk_add_f32 v[18:19], v[18:19], v[174:175]
  v_cvt_pk_bf16_f32 v218, v16, v17
  v_cvt_pk_bf16_f32 v219, v18, v19
  v_lshlrev_b32 v16, 16, v218
  v_and_b32 v17, 0xffff0000, v218
  v_lshlrev_b32 v18, 16, v219
  v_and_b32 v19, 0xffff0000, v219
  v_lshlrev_b32 v20, 16, v220
  v_and_b32 v21, 0xffff0000, v220
  v_lshlrev_b32 v22, 16, v221
  v_and_b32 v23, 0xffff0000, v221
  v_pk_add_f32 v[20:21], v[20:21], v[176:177]
  v_pk_add_f32 v[22:23], v[22:23], v[178:179]
  v_cvt_pk_bf16_f32 v220, v20, v21
  v_cvt_pk_bf16_f32 v221, v22, v23
  v_lshlrev_b32 v20, 16, v220
  v_and_b32 v21, 0xffff0000, v220
  v_lshlrev_b32 v22, 16, v221
  v_and_b32 v23, 0xffff0000, v221
  v_add_u32 v189, 0xb00000, v206
  s_cmp_lg_u32 s25, 0
  s_cbranch_scc1 .dp_47
  buffer_store_dwordx2 v[212:213], v189, s[4:7], 0 offen offset:0 sc1
  buffer_store_dwordx2 v[214:215], v189, s[4:7], 0 offen offset:32 sc1
  buffer_store_dwordx2 v[216:217], v189, s[4:7], 0 offen offset:64 sc1
  buffer_store_dwordx2 v[218:219], v189, s[4:7], 0 offen offset:96 sc1
  buffer_store_dwordx2 v[220:221], v189, s[4:7], 0 offen offset:128 sc1
  s_branch .de_48
.dp_47:
  buffer_store_dwordx2 v[212:213], v189, s[4:7], 0 offen offset:0
  buffer_store_dwordx2 v[214:215], v189, s[4:7], 0 offen offset:32
  buffer_store_dwordx2 v[216:217], v189, s[4:7], 0 offen offset:64
  buffer_store_dwordx2 v[218:219], v189, s[4:7], 0 offen offset:96
  buffer_store_dwordx2 v[220:221], v189, s[4:7], 0 offen offset:128
.de_48:
  v_pk_add_f32 v[200:201], v[4:5], v[6:7]
  v_pk_add_f32 v[200:201], v[200:201], v[8:9]
  v_pk_add_f32 v[200:201], v[200:201], v[10:11]
  v_pk_add_f32 v[200:201], v[200:201], v[12:13]
  v_pk_add_f32 v[200:201], v[200:201], v[14:15]
  v_pk_add_f32 v[200:201], v[200:201], v[16:17]
  v_pk_add_f32 v[200:201], v[200:201], v[18:19]
  v_pk_add_f32 v[200:201], v[200:201], v[20:21]
  v_pk_add_f32 v[200:201], v[200:201], v[22:23]
  v_add_f32 v196, v200, v201
  v_mov_b32 v200, v196
  s_nop 1
  v_permlane16_swap_b32 v196, v200
  v_add_f32 v196, v196, v200
  v_mov_b32 v200, v196
  s_nop 1
  v_permlane32_swap_b32 v196, v200
  v_add_f32 v196, v196, v200
  s_waitcnt vmcnt(0)
  v_mov_b32 v188, 162892
  v_mov_b32 v189, 1
  s_mov_b64 exec, 1
  ds_add_rtn_u32 v190, v188, v189
  s_mov_b64 exec, -1
  s_lshl_b32 s30, s24, 3
  s_add_u32 s30, s30, 0x1b60000
  s_waitcnt lgkmcnt(0)
  v_readfirstlane_b32 s31, v190
  v_mov_b32 v188, s30
  v_mov_b32 v190, s26
  v_mov_b32 v191, s27
  s_cmp_lg_u32 s31, 3
  s_cbranch_scc1 .sg_49
  s_mov_b64 exec, 1
  s_mov_b32 s30, 24576
  s_cmp_lg_u32 s25, 0
  s_cbranch_scc1 .dp_50
  buffer_store_dwordx2 v[190:191], v188, s[4:7], s30 offen sc1
  s_branch .de_51
.dp_50:
  buffer_store_dwordx2 v[190:191], v188, s[4:7], s30 offen
.de_51:
  s_mov_b64 exec, -1
.sg_49:
  v_mul_f32 v198, 0xbc4ccccd, v196
  v_pk_add_f32 v[4:5], v[4:5], v[198:199] op_sel_hi:[1,0]
  v_pk_add_f32 v[6:7], v[6:7], v[198:199] op_sel_hi:[1,0]
  v_pk_add_f32 v[8:9], v[8:9], v[198:199] op_sel_hi:[1,0]
  v_pk_add_f32 v[10:11], v[10:11], v[198:199] op_sel_hi:[1,0]
  v_pk_add_f32 v[12:13], v[12:13], v[198:199] op_sel_hi:[1,0]
  v_pk_add_f32 v[14:15], v[14:15], v[198:199] op_sel_hi:[1,0]
  v_pk_add_f32 v[16:17], v[16:17], v[198:199] op_sel_hi:[1,0]
  v_pk_add_f32 v[18:19], v[18:19], v[198:199] op_sel_hi:[1,0]
  v_pk_add_f32 v[20:21], v[20:21], v[198:199] op_sel_hi:[1,0]
  v_pk_add_f32 v[22:23], v[22:23], v[198:199] op_sel_hi:[1,0]
  v_pk_mul_f32 v[200:201], v[4:5], v[4:5]
  v_pk_fma_f32 v[200:201], v[6:7], v[6:7], v[200:201]
  v_pk_fma_f32 v[200:201], v[8:9], v[8:9], v[200:201]
  v_pk_fma_f32 v[200:201], v[10:11], v[10:11], v[200:201]
  v_pk_fma_f32 v[200:201], v[12:13], v[12:13], v[200:201]
  v_pk_fma_f32 v[200:201], v[14:15], v[14:15], v[200:201]
  v_pk_fma_f32 v[200:201], v[16:17], v[16:17], v[200:201]
  v_pk_fma_f32 v[200:201], v[18:19], v[18:19], v[200:201]
  v_pk_fma_f32 v[200:201], v[20:21], v[20:21], v[200:201]
  v_pk_fma_f32 v[200:201], v[22:23], v[22:23], v[200:201]
  v_add_f32 v197, v200, v201
  v_mov_b32 v200, v197
  s_nop 1
  v_permlane16_swap_b32 v197, v200
  v_add_f32 v197, v197, v200
  v_mov_b32 v200, v197
  s_nop 1
  v_permlane32_swap_b32 v197, v200
  v_add_f32 v197, v197, v200
  s_lshl_b32 s30, s66, 3
  s_add_u32 s30, s30, 0x1b10000
  v_lshl_add_u32 v200, v204, 6, s30
  s_cmp_lg_u32 s25, 0
  s_cbranch_scc1 .dp_52
  buffer_store_dwordx2 v[196:197], v200, s[4:7], 0 offen sc1
  s_branch .de_53
.dp_52:
  buffer_store_dwordx2 v[196:197], v200, s[4:7], 0 offen
.de_53:
  s_barrier
  s_lshl_b32 s30, s20, 3
  v_lshrrev_b32 v189, 3, v1
  v_add_u32 v189, s30, v189
  v_bfe_u32 v190, v1, 1, 2
  v_mul_u32_u24 v190, 40, v190
  v_mul_u32_u24 v188, 160, v189
  v_add_u32 v188, v188, v190
  v_add_u32 v188, 110592, v188
  v_and_b32 v192, 1, v1
  v_mul_u32_u24 v193, 1280, v192
  v_sub_u32 v193, v188, v193
  v_add_u32 v191, s67, v189
  ds_read_b64 v[4:5], v188 offset:0
  ds_read_b64 v[6:7], v188 offset:8
  ds_read_b64 v[8:9], v188 offset:16
  ds_read_b64 v[10:11], v188 offset:24
  ds_read_b64 v[12:13], v188 offset:32
  ds_read_b64 v[16:17], v193 offset:12480
  ds_read_b64 v[18:19], v193 offset:12488
  ds_read_b64 v[20:21], v193 offset:12496
  ds_read_b64 v[22:23], v193 offset:12504
  ds_read_b64 v[24:25], v193 offset:12512
  ds_read_b64 v[26:27], v193 offset:12160
  ds_read_b64 v[28:29], v193 offset:12168
  ds_read_b64 v[30:31], v193 offset:12176
  ds_read_b64 v[32:33], v193 offset:12184
  ds_read_b64 v[34:35], v193 offset:12192
  ds_read_b64 v[36:37], v193 offset:11840
  ds_read_b64 v[38:39], v193 offset:11848
  ds_read_b64 v[40:41], v193 offset:11856
  ds_read_b64 v[42:43], v193 offset:11864
  ds_read_b64 v[44:45], v193 offset:11872
  ds_read_b64 v[46:47], v193 offset:11520
  ds_read_b64 v[48:49], v193 offset:11528
  ds_read_b64 v[50:51], v193 offset:11536
  ds_read_b64 v[52:53], v193 offset:11544
  ds_read_b64 v[54:55], v193 offset:11552
  v_mov_b32 v196, 0
  v_mov_b32 v197, 0
  v_mov_b32 v198, 0
  v_mov_b32 v199, 0
  s_waitcnt lgkmcnt(0)
  v_dot2c_f32_bf16 v196, v4, v16
  v_dot2c_f32_bf16 v197, v4, v26
  v_dot2c_f32_bf16 v198, v4, v36
  v_dot2c_f32_bf16 v199, v4, v46
  v_dot2c_f32_bf16 v196, v5, v17
  v_dot2c_f32_bf16 v197, v5, v27
  v_dot2c_f32_bf16 v198, v5, v37
  v_dot2c_f32_bf16 v199, v5, v47
  v_dot2c_f32_bf16 v196, v6, v18
  v_dot2c_f32_bf16 v197, v6, v28
  v_dot2c_f32_bf16 v198, v6, v38
  v_dot2c_f32_bf16 v199, v6, v48
  v_dot2c_f32_bf16 v196, v7, v19
  v_dot2c_f32_bf16 v197, v7, v29
  v_dot2c_f32_bf16 v198, v7, v39
  v_dot2c_f32_bf16 v199, v7, v49
  v_dot2c_f32_bf16 v196, v8, v20
  v_dot2c_f32_bf16 v197, v8, v30
  v_dot2c_f32_bf16 v198, v8, v40
  v_dot2c_f32_bf16 v199, v8, v50
  v_dot2c_f32_bf16 v196, v9, v21
  v_dot2c_f32_bf16 v197, v9, v31
  v_dot2c_f32_bf16 v198, v9, v41
  v_dot2c_f32_bf16 v199, v9, v51
  v_dot2c_f32_bf16 v196, v10, v22
  v_dot2c_f32_bf16 v197, v10, v32
  v_dot2c_f32_bf16 v198, v10, v42
  v_dot2c_f32_bf16 v199, v10, v52
  v_dot2c_f32_bf16 v196, v11, v23
  v_dot2c_f32_bf16 v197, v11, v33
  v_dot2c_f32_bf16 v198, v11, v43
  v_dot2c_f32_bf16 v199, v11, v53
  v_dot2c_f32_bf16 v196, v12, v24
  v_dot2c_f32_bf16 v197, v12, v34
  v_dot2c_f32_bf16 v198, v12, v44
  v_dot2c_f32_bf16 v199, v12, v54
  v_dot2c_f32_bf16 v196, v13, v25
  v_dot2c_f32_bf16 v197, v13, v35
  v_dot2c_f32_bf16 v198, v13, v45
  v_dot2c_f32_bf16 v199, v13, v55
  s_nop 2
  ds_read_b64 v[16:17], v193 offset:24960
  ds_read_b64 v[18:19], v193 offset:24968
  ds_read_b64 v[20:21], v193 offset:24976
  ds_read_b64 v[22:23], v193 offset:24984
  ds_read_b64 v[24:25], v193 offset:24992
  ds_read_b64 v[26:27], v193 offset:24640
  ds_read_b64 v[28:29], v193 offset:24648
  ds_read_b64 v[30:31], v193 offset:24656
  ds_read_b64 v[32:33], v193 offset:24664
  ds_read_b64 v[34:35], v193 offset:24672
  ds_read_b64 v[36:37], v193 offset:24320
  ds_read_b64 v[38:39], v193 offset:24328
  ds_read_b64 v[40:41], v193 offset:24336
  ds_read_b64 v[42:43], v193 offset:24344
  ds_read_b64 v[44:45], v193 offset:24352
  ds_read_b64 v[46:47], v193 offset:24000
  ds_read_b64 v[48:49], v193 offset:24008
  ds_read_b64 v[50:51], v193 offset:24016
  ds_read_b64 v[52:53], v193 offset:24024
  ds_read_b64 v[54:55], v193 offset:24032
  v_cvt_pk_bf16_f32 v194, v196, v197
  v_lshlrev_b32 v196, 16, v194
  v_and_b32 v197, 0xffff0000, v194
  v_cvt_pk_bf16_f32 v194, v198, v199
  v_lshlrev_b32 v198, 16, v194
  v_and_b32 v199, 0xffff0000, v194
  v_mul_f32 v196, 0x3e64f92e, v196
  v_mul_f32 v197, 0x3e64f92e, v197
  v_mul_f32 v198, 0x3e64f92e, v198
  v_mul_f32 v199, 0x3e64f92e, v199
  v_cvt_pk_bf16_f32 v194, v196, v197
  v_lshlrev_b32 v196, 16, v194
  v_and_b32 v197, 0xffff0000, v194
  v_cvt_pk_bf16_f32 v194, v198, v199
  v_lshlrev_b32 v198, 16, v194
  v_and_b32 v199, 0xffff0000, v194
  s_add_u32 s30, s30, s67
  s_cmp_ge_u32 s30, 16
  s_cbranch_scc1 .nm_54
  v_mov_b32 v194, 0xce6e6b28
  v_lshlrev_b32 v195, 3, v192
  v_sub_u32 v195, v191, v195
  v_cmp_gt_i32 vcc, 0, v195
  s_nop 1
  v_cndmask_b32 v196, v196, v194, vcc
  v_cmp_gt_i32 vcc, 2, v195
  s_nop 1
  v_cndmask_b32 v197, v197, v194, vcc
  v_cmp_gt_i32 vcc, 4, v195
  s_nop 1
  v_cndmask_b32 v198, v198, v194, vcc
  v_cmp_gt_i32 vcc, 6, v195
  s_nop 1
  v_cndmask_b32 v199, v199, v194, vcc
.nm_54:
  v_max3_f32 v200, v196, v197, v198
  v_max_f32 v200, v200, v199
  s_nop 1
  v_max_f32_dpp v200, v200, v200 quad_perm:[1,0,3,2] row_mask:0xf bank_mask:0xf
  v_sub_f32 v196, v196, v200
  v_sub_f32 v197, v197, v200
  v_sub_f32 v198, v198, v200
  v_sub_f32 v199, v199, v200
  v_mul_f32 v196, 0x3fb8aa3b, v196
  v_mul_f32 v197, 0x3fb8aa3b, v197
  v_mul_f32 v198, 0x3fb8aa3b, v198
  v_mul_f32 v199, 0x3fb8aa3b, v199
  v_exp_f32 v196, v196
  v_exp_f32 v197, v197
  v_exp_f32 v198, v198
  v_exp_f32 v199, v199
  s_nop 0
  v_add_f32 v200, v196, v197
  v_add_f32 v201, v198, v199
  v_add_f32 v200, v200, v201
  s_nop 1
  v_add_f32_dpp v200, v200, v200 quad_perm:[1,0,3,2] row_mask:0xf bank_mask:0xf
  v_rcp_f32 v200, v200
  s_nop 0
  v_mul_f32 v196, v196, v200
  v_mul_f32 v197, v197, v200
  v_mul_f32 v198, v198, v200
  v_mul_f32 v199, v199, v200
  v_cvt_pk_bf16_f32 v202, v196, v197
  v_cvt_pk_bf16_f32 v203, v198, v199
  v_mov_b32 v56, 0
  v_mov_b32 v57, 0
  v_mov_b32 v58, 0
  v_mov_b32 v59, 0
  v_mov_b32 v60, 0
  v_mov_b32 v61, 0
  v_mov_b32 v62, 0
  v_mov_b32 v63, 0
  v_mov_b32 v64, 0
  v_mov_b32 v65, 0
  v_mov_b32 v66, 0
  v_mov_b32 v67, 0
  v_mov_b32 v68, 0
  v_mov_b32 v69, 0
  v_mov_b32 v70, 0
  v_mov_b32 v71, 0
  v_mov_b32 v72, 0
  v_mov_b32 v73, 0
  v_mov_b32 v74, 0
  v_mov_b32 v75, 0
  s_mov_b32 s30, 0x05040100
  s_mov_b32 s31, 0x07060302
  s_waitcnt lgkmcnt(0)
  v_perm_b32 v76, v26, v16, s30
  v_perm_b32 v77, v26, v16, s31
  v_perm_b32 v78, v27, v17, s30
  v_perm_b32 v79, v27, v17, s31
  v_perm_b32 v80, v28, v18, s30
  v_perm_b32 v81, v28, v18, s31
  v_perm_b32 v82, v29, v19, s30
  v_perm_b32 v83, v29, v19, s31
  v_perm_b32 v84, v30, v20, s30
  v_perm_b32 v85, v30, v20, s31
  v_perm_b32 v86, v31, v21, s30
  v_perm_b32 v87, v31, v21, s31
  v_perm_b32 v88, v32, v22, s30
  v_perm_b32 v89, v32, v22, s31
  v_perm_b32 v90, v33, v23, s30
  v_perm_b32 v91, v33, v23, s31
  v_perm_b32 v92, v34, v24, s30
  v_perm_b32 v93, v34, v24, s31
  v_perm_b32 v94, v35, v25, s30
  v_perm_b32 v95, v35, v25, s31
  v_dot2c_f32_bf16 v56, v76, v202
  v_dot2c_f32_bf16 v57, v77, v202
  v_dot2c_f32_bf16 v58, v78, v202
  v_dot2c_f32_bf16 v59, v79, v202
  v_dot2c_f32_bf16 v60, v80, v202
  v_dot2c_f32_bf16 v61, v81, v202
  v_dot2c_f32_bf16 v62, v82, v202
  v_dot2c_f32_bf16 v63, v83, v202
  v_dot2c_f32_bf16 v64, v84, v202
  v_dot2c_f32_bf16 v65, v85, v202
  v_dot2c_f32_bf16 v66, v86, v202
  v_dot2c_f32_bf16 v67, v87, v202
  v_dot2c_f32_bf16 v68, v88, v202
  v_dot2c_f32_bf16 v69, v89, v202
  v_dot2c_f32_bf16 v70, v90, v202
  v_dot2c_f32_bf16 v71, v91, v202
  v_dot2c_f32_bf16 v72, v92, v202
  v_dot2c_f32_bf16 v73, v93, v202
  v_dot2c_f32_bf16 v74, v94, v202
  v_dot2c_f32_bf16 v75, v95, v202
  v_perm_b32 v76, v46, v36, s30
  v_perm_b32 v77, v46, v36, s31
  v_perm_b32 v78, v47, v37, s30
  v_perm_b32 v79, v47, v37, s31
  v_perm_b32 v80, v48, v38, s30
  v_perm_b32 v81, v48, v38, s31
  v_perm_b32 v82, v49, v39, s30
  v_perm_b32 v83, v49, v39, s31
  v_perm_b32 v84, v50, v40, s30
  v_perm_b32 v85, v50, v40, s31
  v_perm_b32 v86, v51, v41, s30
  v_perm_b32 v87, v51, v41, s31
  v_perm_b32 v88, v52, v42, s30
  v_perm_b32 v89, v52, v42, s31
  v_perm_b32 v90, v53, v43, s30
  v_perm_b32 v91, v53, v43, s31
  v_perm_b32 v92, v54, v44, s30
  v_perm_b32 v93, v54, v44, s31
  v_perm_b32 v94, v55, v45, s30
  v_perm_b32 v95, v55, v45, s31
  v_dot2c_f32_bf16 v56, v76, v203
  v_dot2c_f32_bf16 v57, v77, v203
  v_dot2c_f32_bf16 v58, v78, v203
  v_dot2c_f32_bf16 v59, v79, v203
  v_dot2c_f32_bf16 v60, v80, v203
  v_dot2c_f32_bf16 v61, v81, v203
  v_dot2c_f32_bf16 v62, v82, v203
  v_dot2c_f32_bf16 v63, v83, v203
  v_dot2c_f32_bf16 v64, v84, v203
  v_dot2c_f32_bf16 v65, v85, v203
  v_dot2c_f32_bf16 v66, v86, v203
  v_dot2c_f32_bf16 v67, v87, v203
  v_dot2c_f32_bf16 v68, v88, v203
  v_dot2c_f32_bf16 v69, v89, v203
  v_dot2c_f32_bf16 v70, v90, v203
  v_dot2c_f32_bf16 v71, v91, v203
  v_dot2c_f32_bf16 v72, v92, v203
  v_dot2c_f32_bf16 v73, v93, v203
  v_dot2c_f32_bf16 v74, v94, v203
  v_dot2c_f32_bf16 v75, v95, v203
  s_nop 2
  v_add_f32_dpp v56, v56, v56 quad_perm:[1,0,3,2] row_mask:0xf bank_mask:0xf
  v_add_f32_dpp v57, v57, v57 quad_perm:[1,0,3,2] row_mask:0xf bank_mask:0xf
  v_add_f32_dpp v58, v58, v58 quad_perm:[1,0,3,2] row_mask:0xf bank_mask:0xf
  v_add_f32_dpp v59, v59, v59 quad_perm:[1,0,3,2] row_mask:0xf bank_mask:0xf
  v_add_f32_dpp v60, v60, v60 quad_perm:[1,0,3,2] row_mask:0xf bank_mask:0xf
  v_add_f32_dpp v61, v61, v61 quad_perm:[1,0,3,2] row_mask:0xf bank_mask:0xf
  v_add_f32_dpp v62, v62, v62 quad_perm:[1,0,3,2] row_mask:0xf bank_mask:0xf
  v_add_f32_dpp v63, v63, v63 quad_perm:[1,0,3,2] row_mask:0xf bank_mask:0xf
  v_add_f32_dpp v64, v64, v64 quad_perm:[1,0,3,2] row_mask:0xf bank_mask:0xf
  v_add_f32_dpp v65, v65, v65 quad_perm:[1,0,3,2] row_mask:0xf bank_mask:0xf
  v_add_f32_dpp v66, v66, v66 quad_perm:[1,0,3,2] row_mask:0xf bank_mask:0xf
  v_add_f32_dpp v67, v67, v67 quad_perm:[1,0,3,2] row_mask:0xf bank_mask:0xf
  v_add_f32_dpp v68, v68, v68 quad_perm:[1,0,3,2] row_mask:0xf bank_mask:0xf
  v_add_f32_dpp v69, v69, v69 quad_perm:[1,0,3,2] row_mask:0xf bank_mask:0xf
  v_add_f32_dpp v70, v70, v70 quad_perm:[1,0,3,2] row_mask:0xf bank_mask:0xf
  v_add_f32_dpp v71, v71, v71 quad_perm:[1,0,3,2] row_mask:0xf bank_mask:0xf
  v_add_f32_dpp v72, v72, v72 quad_perm:[1,0,3,2] row_mask:0xf bank_mask:0xf
  v_add_f32_dpp v73, v73, v73 quad_perm:[1,0,3,2] row_mask:0xf bank_mask:0xf
  v_add_f32_dpp v74, v74, v74 quad_perm:[1,0,3,2] row_mask:0xf bank_mask:0xf
  v_add_f32_dpp v75, v75, v75 quad_perm:[1,0,3,2] row_mask:0xf bank_mask:0xf
  v_cvt_pk_bf16_f32 v4, v56, v57
  v_cvt_pk_bf16_f32 v5, v58, v59
  v_cvt_pk_bf16_f32 v6, v60, v61
  v_cvt_pk_bf16_f32 v7, v62, v63
  v_cvt_pk_bf16_f32 v8, v64, v65
  v_cvt_pk_bf16_f32 v9, v66, v67
  v_cvt_pk_bf16_f32 v10, v68, v69
  v_cvt_pk_bf16_f32 v11, v70, v71
  v_cvt_pk_bf16_f32 v12, v72, v73
  v_cvt_pk_bf16_f32 v13, v74, v75
  v_mul_u32_u24 v188, 1280, v191
  v_add_u32 v188, v188, v190
  v_lshl_or_b32 v188, v192, 31, v188
  s_mul_i32 s30, s66, 160
  s_add_u32 s30, s30, 0xe00000
  s_cmp_lg_u32 s25, 0
  s_cbranch_scc1 .dp_55
  buffer_store_dwordx4 v[4:7], v188, s[4:7], s30 offen sc1
  buffer_store_dwordx4 v[8:11], v188, s[4:7], s30 offen offset:16 sc1
  buffer_store_dwordx2 v[12:13], v188, s[4:7], s30 offen offset:32 sc1
  s_branch .de_56
.dp_55:
  buffer_store_dwordx4 v[4:7], v188, s[4:7], s30 offen
  buffer_store_dwordx4 v[8:11], v188, s[4:7], s30 offen offset:16
  buffer_store_dwordx2 v[12:13], v188, s[4:7], s30 offen offset:32
.de_56:
  s_barrier
  s_lshl_b32 s30, s21, 12
  s_add_u32 s30, s30, 14336
  v_add_u32 v180, s30, v211
  v_xor_b32 v182, 64, v180
  v_add_u32 v181, 61440, v180
  v_add_u32 v183, 61440, v182
  v_mul_u32_u24 v184, 224, v208
  v_add_u32 v184, v184, v209
  v_add_u32 v185, 61440, v184
  s_lshl_b32 s30, s21, 5
  v_and_b32 v205, 15, v1
  v_add_u32 v205, s30, v205
  v_lshlrev_b32 v207, 3, v205
  v_add_u32 v207, 159744, v207
  v_lshrrev_b32 v188, 4, v1
  v_lshlrev_b32 v210, 4, v188
  v_add_u32 v210, 161792, v210
  s_barrier
  ds_read_b64_tr_b16 v[100:101], v184 offset:0
  ds_read_b64_tr_b16 v[102:103], v184 offset:1792
  ds_read_b128 v[84:87], v180 offset:0
  ds_read_b128 v[88:91], v180 offset:2048
  ds_read_b64_tr_b16 v[104:105], v184 offset:32
  ds_read_b64_tr_b16 v[106:107], v184 offset:1824
  ds_read_b64_tr_b16 v[108:109], v184 offset:64
  ds_read_b64_tr_b16 v[110:111], v184 offset:1856
  ds_read_b64_tr_b16 v[112:113], v184 offset:96
  ds_read_b64_tr_b16 v[114:115], v184 offset:1888
  ds_read_b64_tr_b16 v[116:117], v184 offset:128
  ds_read_b64_tr_b16 v[118:119], v184 offset:1920
  ds_read_b64_tr_b16 v[120:121], v184 offset:160
  ds_read_b64_tr_b16 v[122:123], v184 offset:1952
  ds_read_b64_tr_b16 v[124:125], v184 offset:192
  ds_read_b64_tr_b16 v[126:127], v184 offset:1984
  s_waitcnt lgkmcnt(0)
  v_mfma_f32_16x16x32_bf16 v[4:7], v[100:103], v[84:87], 0
  ds_read_b64_tr_b16 v[140:141], v184 offset:7168
  ds_read_b64_tr_b16 v[142:143], v184 offset:8960
  v_mfma_f32_16x16x32_bf16 v[32:35], v[100:103], v[88:91], 0
  ds_read_b128 v[92:95], v182 offset:0
  v_mfma_f32_16x16x32_bf16 v[8:11], v[104:107], v[84:87], 0
  ds_read_b128 v[96:99], v182 offset:2048
  ds_read_b64_tr_b16 v[144:145], v184 offset:7200
  v_mfma_f32_16x16x32_bf16 v[36:39], v[104:107], v[88:91], 0
  ds_read_b64_tr_b16 v[146:147], v184 offset:8992
  v_mfma_f32_16x16x32_bf16 v[12:15], v[108:111], v[84:87], 0
  ds_read_b64_tr_b16 v[148:149], v184 offset:7232
  ds_read_b64_tr_b16 v[150:151], v184 offset:9024
  v_mfma_f32_16x16x32_bf16 v[40:43], v[108:111], v[88:91], 0
  ds_read_b64_tr_b16 v[152:153], v184 offset:7264
  v_mfma_f32_16x16x32_bf16 v[16:19], v[112:115], v[84:87], 0
  ds_read_b64_tr_b16 v[154:155], v184 offset:9056
  ds_read_b64_tr_b16 v[156:157], v184 offset:7296
  v_mfma_f32_16x16x32_bf16 v[44:47], v[112:115], v[88:91], 0
  ds_read_b64_tr_b16 v[158:159], v184 offset:9088
  v_mfma_f32_16x16x32_bf16 v[20:23], v[116:119], v[84:87], 0
  ds_read_b64_tr_b16 v[160:161], v184 offset:7328
  ds_read_b64_tr_b16 v[162:163], v184 offset:9120
  v_mfma_f32_16x16x32_bf16 v[48:51], v[116:119], v[88:91], 0
  ds_read_b64_tr_b16 v[164:165], v184 offset:7360
  v_mfma_f32_16x16x32_bf16 v[24:27], v[120:123], v[84:87], 0
  ds_read_b64_tr_b16 v[166:167], v184 offset:9152
  v_mfma_f32_16x16x32_bf16 v[52:55], v[120:123], v[88:91], 0
  v_mfma_f32_16x16x32_bf16 v[28:31], v[124:127], v[84:87], 0
  v_mfma_f32_16x16x32_bf16 v[56:59], v[124:127], v[88:91], 0
  s_waitcnt lgkmcnt(0)
  s_barrier
  v_mfma_f32_16x16x32_bf16 v[4:7], v[140:143], v[92:95], v[4:7]
  ds_read_b64_tr_b16 v[100:101], v184 offset:30720
  ds_read_b64_tr_b16 v[102:103], v184 offset:32512
  v_mfma_f32_16x16x32_bf16 v[32:35], v[140:143], v[96:99], v[32:35]
  ds_read_b128 v[84:87], v180 offset:30720
  v_mfma_f32_16x16x32_bf16 v[8:11], v[144:147], v[92:95], v[8:11]
  ds_read_b128 v[88:91], v180 offset:32768
  ds_read_b64_tr_b16 v[104:105], v184 offset:30752
  v_mfma_f32_16x16x32_bf16 v[36:39], v[144:147], v[96:99], v[36:39]
  ds_read_b64_tr_b16 v[106:107], v184 offset:32544
  v_mfma_f32_16x16x32_bf16 v[12:15], v[148:151], v[92:95], v[12:15]
  ds_read_b64_tr_b16 v[108:109], v184 offset:30784
  ds_read_b64_tr_b16 v[110:111], v184 offset:32576
  v_mfma_f32_16x16x32_bf16 v[40:43], v[148:151], v[96:99], v[40:43]
  ds_read_b64_tr_b16 v[112:113], v184 offset:30816
  v_mfma_f32_16x16x32_bf16 v[16:19], v[152:155], v[92:95], v[16:19]
  ds_read_b64_tr_b16 v[114:115], v184 offset:32608
  ds_read_b64_tr_b16 v[116:117], v184 offset:30848
  v_mfma_f32_16x16x32_bf16 v[44:47], v[152:155], v[96:99], v[44:47]
  ds_read_b64_tr_b16 v[118:119], v184 offset:32640
  v_mfma_f32_16x16x32_bf16 v[20:23], v[156:159], v[92:95], v[20:23]
  ds_read_b64_tr_b16 v[120:121], v184 offset:30880
  ds_read_b64_tr_b16 v[122:123], v184 offset:32672
  v_mfma_f32_16x16x32_bf16 v[48:51], v[156:159], v[96:99], v[48:51]
  ds_read_b64_tr_b16 v[124:125], v184 offset:30912
  v_mfma_f32_16x16x32_bf16 v[24:27], v[160:163], v[92:95], v[24:27]
  ds_read_b64_tr_b16 v[126:127], v184 offset:32704
  v_mfma_f32_16x16x32_bf16 v[52:55], v[160:163], v[96:99], v[52:55]
  v_mfma_f32_16x16x32_bf16 v[28:31], v[164:167], v[92:95], v[28:31]
  v_mfma_f32_16x16x32_bf16 v[56:59], v[164:167], v[96:99], v[56:59]
  s_waitcnt lgkmcnt(0)
  v_mfma_f32_16x16x32_bf16 v[4:7], v[100:103], v[84:87], v[4:7]
  ds_read_b64_tr_b16 v[140:141], v184 offset:37888
  ds_read_b64_tr_b16 v[142:143], v184 offset:39680
  v_mfma_f32_16x16x32_bf16 v[32:35], v[100:103], v[88:91], v[32:35]
  ds_read_b128 v[92:95], v182 offset:30720
  v_mfma_f32_16x16x32_bf16 v[8:11], v[104:107], v[84:87], v[8:11]
  ds_read_b128 v[96:99], v182 offset:32768
  ds_read_b64_tr_b16 v[144:145], v184 offset:37920
  v_mfma_f32_16x16x32_bf16 v[36:39], v[104:107], v[88:91], v[36:39]
  ds_read_b64_tr_b16 v[146:147], v184 offset:39712
  v_mfma_f32_16x16x32_bf16 v[12:15], v[108:111], v[84:87], v[12:15]
  ds_read_b64_tr_b16 v[148:149], v184 offset:37952
  ds_read_b64_tr_b16 v[150:151], v184 offset:39744
  v_mfma_f32_16x16x32_bf16 v[40:43], v[108:111], v[88:91], v[40:43]
  ds_read_b64_tr_b16 v[152:153], v184 offset:37984
  v_mfma_f32_16x16x32_bf16 v[16:19], v[112:115], v[84:87], v[16:19]
  ds_read_b64_tr_b16 v[154:155], v184 offset:39776
  ds_read_b64_tr_b16 v[156:157], v184 offset:38016
  v_mfma_f32_16x16x32_bf16 v[44:47], v[112:115], v[88:91], v[44:47]
  ds_read_b64_tr_b16 v[158:159], v184 offset:39808
  v_mfma_f32_16x16x32_bf16 v[20:23], v[116:119], v[84:87], v[20:23]
  ds_read_b64_tr_b16 v[160:161], v184 offset:38048
  ds_read_b64_tr_b16 v[162:163], v184 offset:39840
  v_mfma_f32_16x16x32_bf16 v[48:51], v[116:119], v[88:91], v[48:51]
  ds_read_b64_tr_b16 v[164:165], v184 offset:38080
  v_mfma_f32_16x16x32_bf16 v[24:27], v[120:123], v[84:87], v[24:27]
  ds_read_b64_tr_b16 v[166:167], v184 offset:39872
  v_mfma_f32_16x16x32_bf16 v[52:55], v[120:123], v[88:91], v[52:55]
  v_mfma_f32_16x16x32_bf16 v[28:31], v[124:127], v[84:87], v[28:31]
  v_mfma_f32_16x16x32_bf16 v[56:59], v[124:127], v[88:91], v[56:59]
  s_waitcnt lgkmcnt(0)
  s_waitcnt vmcnt(0)
  v_mov_b32 v188, 162900
  v_mov_b32 v189, 1
  s_mov_b64 exec, 1
  ds_add_rtn_u32 v190, v188, v189
  s_mov_b64 exec, -1
  s_lshl_b32 s30, s24, 3
  s_add_u32 s30, s30, 0x1b60000
  s_waitcnt lgkmcnt(0)
  v_readfirstlane_b32 s31, v190
  v_mov_b32 v188, s30
  v_mov_b32 v190, s26
  v_mov_b32 v191, s27
  s_cmp_lg_u32 s31, 7
  s_cbranch_scc1 .sg_57
  s_mov_b64 exec, 1
  s_mov_b32 s30, 40960
  s_cmp_lg_u32 s25, 0
  s_cbranch_scc1 .dp_58
  buffer_store_dwordx2 v[190:191], v188, s[4:7], s30 offen sc1
  s_branch .de_59
.dp_58:
  buffer_store_dwordx2 v[190:191], v188, s[4:7], s30 offen
.de_59:
  s_mov_b64 exec, -1
.sg_57:
  s_barrier
  v_mfma_f32_16x16x32_bf16 v[4:7], v[140:143], v[92:95], v[4:7]
  ds_read_b64_tr_b16 v[100:101], v185 offset:0
  ds_read_b64_tr_b16 v[102:103], v185 offset:1792
  v_mfma_f32_16x16x32_bf16 v[32:35], v[140:143], v[96:99], v[32:35]
  ds_read_b128 v[84:87], v181 offset:0
  v_mfma_f32_16x16x32_bf16 v[8:11], v[144:147], v[92:95], v[8:11]
  ds_read_b128 v[88:91], v181 offset:2048
  ds_read_b64_tr_b16 v[104:105], v185 offset:32
  v_mfma_f32_16x16x32_bf16 v[36:39], v[144:147], v[96:99], v[36:39]
  ds_read_b64_tr_b16 v[106:107], v185 offset:1824
  v_mfma_f32_16x16x32_bf16 v[12:15], v[148:151], v[92:95], v[12:15]
  ds_read_b64_tr_b16 v[108:109], v185 offset:64
  ds_read_b64_tr_b16 v[110:111], v185 offset:1856
  v_mfma_f32_16x16x32_bf16 v[40:43], v[148:151], v[96:99], v[40:43]
  ds_read_b64_tr_b16 v[112:113], v185 offset:96
  v_mfma_f32_16x16x32_bf16 v[16:19], v[152:155], v[92:95], v[16:19]
  ds_read_b64_tr_b16 v[114:115], v185 offset:1888
  ds_read_b64_tr_b16 v[116:117], v185 offset:128
  v_mfma_f32_16x16x32_bf16 v[44:47], v[152:155], v[96:99], v[44:47]
  ds_read_b64_tr_b16 v[118:119], v185 offset:1920
  v_mfma_f32_16x16x32_bf16 v[20:23], v[156:159], v[92:95], v[20:23]
  ds_read_b64_tr_b16 v[120:121], v185 offset:160
  ds_read_b64_tr_b16 v[122:123], v185 offset:1952
  v_mfma_f32_16x16x32_bf16 v[48:51], v[156:159], v[96:99], v[48:51]
  ds_read_b64_tr_b16 v[124:125], v185 offset:192
  v_mfma_f32_16x16x32_bf16 v[24:27], v[160:163], v[92:95], v[24:27]
  ds_read_b64_tr_b16 v[126:127], v185 offset:1984
  v_mfma_f32_16x16x32_bf16 v[52:55], v[160:163], v[96:99], v[52:55]
  v_mfma_f32_16x16x32_bf16 v[28:31], v[164:167], v[92:95], v[28:31]
  v_mfma_f32_16x16x32_bf16 v[56:59], v[164:167], v[96:99], v[56:59]
  s_waitcnt lgkmcnt(0)
  v_mfma_f32_16x16x32_bf16 v[4:7], v[100:103], v[84:87], v[4:7]
  ds_read_b64_tr_b16 v[140:141], v185 offset:7168
  ds_read_b64_tr_b16 v[142:143], v185 offset:8960
  v_mfma_f32_16x16x32_bf16 v[32:35], v[100:103], v[88:91], v[32:35]
  ds_read_b128 v[92:95], v183 offset:0
  v_mfma_f32_16x16x32_bf16 v[8:11], v[104:107], v[84:87], v[8:11]
  ds_read_b128 v[96:99], v183 offset:2048
  ds_read_b64_tr_b16 v[144:145], v185 offset:7200
  v_mfma_f32_16x16x32_bf16 v[36:39], v[104:107], v[88:91], v[36:39]
  ds_read_b64_tr_b16 v[146:147], v185 offset:8992
  v_mfma_f32_16x16x32_bf16 v[12:15], v[108:111], v[84:87], v[12:15]
  ds_read_b64_tr_b16 v[148:149], v185 offset:7232
  ds_read_b64_tr_b16 v[150:151], v185 offset:9024
  v_mfma_f32_16x16x32_bf16 v[40:43], v[108:111], v[88:91], v[40:43]
  ds_read_b64_tr_b16 v[152:153], v185 offset:7264
  v_mfma_f32_16x16x32_bf16 v[16:19], v[112:115], v[84:87], v[16:19]
  ds_read_b64_tr_b16 v[154:155], v185 offset:9056
  ds_read_b64_tr_b16 v[156:157], v185 offset:7296
  v_mfma_f32_16x16x32_bf16 v[44:47], v[112:115], v[88:91], v[44:47]
  ds_read_b64_tr_b16 v[158:159], v185 offset:9088
  v_mfma_f32_16x16x32_bf16 v[20:23], v[116:119], v[84:87], v[20:23]
  ds_read_b64_tr_b16 v[160:161], v185 offset:7328
  ds_read_b64_tr_b16 v[162:163], v185 offset:9120
  v_mfma_f32_16x16x32_bf16 v[48:51], v[116:119], v[88:91], v[48:51]
  ds_read_b64_tr_b16 v[164:165], v185 offset:7360
  v_mfma_f32_16x16x32_bf16 v[24:27], v[120:123], v[84:87], v[24:27]
  ds_read_b64_tr_b16 v[166:167], v185 offset:9152
  v_mfma_f32_16x16x32_bf16 v[52:55], v[120:123], v[88:91], v[52:55]
  v_mfma_f32_16x16x32_bf16 v[28:31], v[124:127], v[84:87], v[28:31]
  v_mfma_f32_16x16x32_bf16 v[56:59], v[124:127], v[88:91], v[56:59]
  s_waitcnt lgkmcnt(0)
  s_barrier
  v_mfma_f32_16x16x32_bf16 v[4:7], v[140:143], v[92:95], v[4:7]
  ds_read_b64_tr_b16 v[100:101], v185 offset:30720
  ds_read_b64_tr_b16 v[102:103], v185 offset:32512
  v_mfma_f32_16x16x32_bf16 v[32:35], v[140:143], v[96:99], v[32:35]
  ds_read_b128 v[84:87], v181 offset:30720
  v_mfma_f32_16x16x32_bf16 v[8:11], v[144:147], v[92:95], v[8:11]
  ds_read_b128 v[88:91], v181 offset:32768
  ds_read_b64_tr_b16 v[104:105], v185 offset:30752
  v_mfma_f32_16x16x32_bf16 v[36:39], v[144:147], v[96:99], v[36:39]
  ds_read_b64_tr_b16 v[106:107], v185 offset:32544
  v_mfma_f32_16x16x32_bf16 v[12:15], v[148:151], v[92:95], v[12:15]
  ds_read_b64_tr_b16 v[108:109], v185 offset:30784
  ds_read_b64_tr_b16 v[110:111], v185 offset:32576
  v_mfma_f32_16x16x32_bf16 v[40:43], v[148:151], v[96:99], v[40:43]
  ds_read_b64_tr_b16 v[112:113], v185 offset:30816
  v_mfma_f32_16x16x32_bf16 v[16:19], v[152:155], v[92:95], v[16:19]
  ds_read_b64_tr_b16 v[114:115], v185 offset:32608
  ds_read_b64_tr_b16 v[116:117], v185 offset:30848
  v_mfma_f32_16x16x32_bf16 v[44:47], v[152:155], v[96:99], v[44:47]
  ds_read_b64_tr_b16 v[118:119], v185 offset:32640
  v_mfma_f32_16x16x32_bf16 v[20:23], v[156:159], v[92:95], v[20:23]
  ds_read_b64_tr_b16 v[120:121], v185 offset:30880
  ds_read_b64_tr_b16 v[122:123], v185 offset:32672
  v_mfma_f32_16x16x32_bf16 v[48:51], v[156:159], v[96:99], v[48:51]
  ds_read_b64_tr_b16 v[124:125], v185 offset:30912
  v_mfma_f32_16x16x32_bf16 v[24:27], v[160:163], v[92:95], v[24:27]
  ds_read_b64_tr_b16 v[126:127], v185 offset:32704
  v_mfma_f32_16x16x32_bf16 v[52:55], v[160:163], v[96:99], v[52:55]
  v_mfma_f32_16x16x32_bf16 v[28:31], v[164:167], v[92:95], v[28:31]
  v_mfma_f32_16x16x32_bf16 v[56:59], v[164:167], v[96:99], v[56:59]
  s_waitcnt lgkmcnt(0)
  v_mfma_f32_16x16x32_bf16 v[4:7], v[100:103], v[84:87], v[4:7]
  ds_read_b64_tr_b16 v[140:141], v185 offset:37888
  ds_read_b64_tr_b16 v[142:143], v185 offset:39680
  v_mfma_f32_16x16x32_bf16 v[32:35], v[100:103], v[88:91], v[32:35]
  ds_read_b128 v[92:95], v183 offset:30720
  v_mfma_f32_16x16x32_bf16 v[8:11], v[104:107], v[84:87], v[8:11]
  ds_read_b128 v[96:99], v183 offset:32768
  ds_read_b64_tr_b16 v[144:145], v185 offset:37920
  v_mfma_f32_16x16x32_bf16 v[36:39], v[104:107], v[88:91], v[36:39]
  ds_read_b64_tr_b16 v[146:147], v185 offset:39712
  v_mfma_f32_16x16x32_bf16 v[12:15], v[108:111], v[84:87], v[12:15]
  ds_read_b64_tr_b16 v[148:149], v185 offset:37952
  ds_read_b64_tr_b16 v[150:151], v185 offset:39744
  v_mfma_f32_16x16x32_bf16 v[40:43], v[108:111], v[88:91], v[40:43]
  ds_read_b64_tr_b16 v[152:153], v185 offset:37984
  v_mfma_f32_16x16x32_bf16 v[16:19], v[112:115], v[84:87], v[16:19]
  ds_read_b64_tr_b16 v[154:155], v185 offset:39776
  ds_read_b64_tr_b16 v[156:157], v185 offset:38016
  v_mfma_f32_16x16x32_bf16 v[44:47], v[112:115], v[88:91], v[44:47]
  ds_read_b64_tr_b16 v[158:159], v185 offset:39808
  v_mfma_f32_16x16x32_bf16 v[20:23], v[116:119], v[84:87], v[20:23]
  ds_read_b64_tr_b16 v[160:161], v185 offset:38048
  ds_read_b64_tr_b16 v[162:163], v185 offset:39840
  v_mfma_f32_16x16x32_bf16 v[48:51], v[116:119], v[88:91], v[48:51]
  ds_read_b64_tr_b16 v[164:165], v185 offset:38080
  v_mfma_f32_16x16x32_bf16 v[24:27], v[120:123], v[84:87], v[24:27]
  ds_read_b64_tr_b16 v[166:167], v185 offset:39872
  v_mfma_f32_16x16x32_bf16 v[52:55], v[120:123], v[88:91], v[52:55]
  v_mfma_f32_16x16x32_bf16 v[28:31], v[124:127], v[84:87], v[28:31]
  v_mfma_f32_16x16x32_bf16 v[56:59], v[124:127], v[88:91], v[56:59]
  s_waitcnt lgkmcnt(0)
  s_barrier
  v_mfma_f32_16x16x32_bf16 v[4:7], v[140:143], v[92:95], v[4:7]
  ds_read_b64_tr_b16 v[100:101], v184 offset:0
  ds_read_b64_tr_b16 v[102:103], v184 offset:1792
  v_mfma_f32_16x16x32_bf16 v[32:35], v[140:143], v[96:99], v[32:35]
  ds_read_b128 v[84:87], v180 offset:0
  v_mfma_f32_16x16x32_bf16 v[8:11], v[144:147], v[92:95], v[8:11]
  ds_read_b128 v[88:91], v180 offset:2048
  ds_read_b64_tr_b16 v[104:105], v184 offset:32
  v_mfma_f32_16x16x32_bf16 v[36:39], v[144:147], v[96:99], v[36:39]
  ds_read_b64_tr_b16 v[106:107], v184 offset:1824
  v_mfma_f32_16x16x32_bf16 v[12:15], v[148:151], v[92:95], v[12:15]
  ds_read_b64_tr_b16 v[108:109], v184 offset:64
  ds_read_b64_tr_b16 v[110:111], v184 offset:1856
  v_mfma_f32_16x16x32_bf16 v[40:43], v[148:151], v[96:99], v[40:43]
  ds_read_b64_tr_b16 v[112:113], v184 offset:96
  v_mfma_f32_16x16x32_bf16 v[16:19], v[152:155], v[92:95], v[16:19]
  ds_read_b64_tr_b16 v[114:115], v184 offset:1888
  ds_read_b64_tr_b16 v[116:117], v184 offset:128
  v_mfma_f32_16x16x32_bf16 v[44:47], v[152:155], v[96:99], v[44:47]
  ds_read_b64_tr_b16 v[118:119], v184 offset:1920
  v_mfma_f32_16x16x32_bf16 v[20:23], v[156:159], v[92:95], v[20:23]
  ds_read_b64_tr_b16 v[120:121], v184 offset:160
  ds_read_b64_tr_b16 v[122:123], v184 offset:1952
  v_mfma_f32_16x16x32_bf16 v[48:51], v[156:159], v[96:99], v[48:51]
  ds_read_b64_tr_b16 v[124:125], v184 offset:192
  v_mfma_f32_16x16x32_bf16 v[24:27], v[160:163], v[92:95], v[24:27]
  ds_read_b64_tr_b16 v[126:127], v184 offset:1984
  v_mfma_f32_16x16x32_bf16 v[52:55], v[160:163], v[96:99], v[52:55]
  v_mfma_f32_16x16x32_bf16 v[28:31], v[164:167], v[92:95], v[28:31]
  v_mfma_f32_16x16x32_bf16 v[56:59], v[164:167], v[96:99], v[56:59]
  s_waitcnt lgkmcnt(0)
  v_mfma_f32_16x16x32_bf16 v[4:7], v[100:103], v[84:87], v[4:7]
  ds_read_b64_tr_b16 v[140:141], v184 offset:7168
  ds_read_b64_tr_b16 v[142:143], v184 offset:8960
  v_mfma_f32_16x16x32_bf16 v[32:35], v[100:103], v[88:91], v[32:35]
  ds_read_b128 v[92:95], v182 offset:0
  v_mfma_f32_16x16x32_bf16 v[8:11], v[104:107], v[84:87], v[8:11]
  ds_read_b128 v[96:99], v182 offset:2048
  ds_read_b64_tr_b16 v[144:145], v184 offset:7200
  v_mfma_f32_16x16x32_bf16 v[36:39], v[104:107], v[88:91], v[36:39]
  ds_read_b64_tr_b16 v[146:147], v184 offset:8992
  v_mfma_f32_16x16x32_bf16 v[12:15], v[108:111], v[84:87], v[12:15]
  ds_read_b64_tr_b16 v[148:149], v184 offset:7232
  ds_read_b64_tr_b16 v[150:151], v184 offset:9024
  v_mfma_f32_16x16x32_bf16 v[40:43], v[108:111], v[88:91], v[40:43]
  ds_read_b64_tr_b16 v[152:153], v184 offset:7264
  v_mfma_f32_16x16x32_bf16 v[16:19], v[112:115], v[84:87], v[16:19]
  ds_read_b64_tr_b16 v[154:155], v184 offset:9056
  ds_read_b64_tr_b16 v[156:157], v184 offset:7296
  v_mfma_f32_16x16x32_bf16 v[44:47], v[112:115], v[88:91], v[44:47]
  ds_read_b64_tr_b16 v[158:159], v184 offset:9088
  v_mfma_f32_16x16x32_bf16 v[20:23], v[116:119], v[84:87], v[20:23]
  ds_read_b64_tr_b16 v[160:161], v184 offset:7328
  ds_read_b64_tr_b16 v[162:163], v184 offset:9120
  v_mfma_f32_16x16x32_bf16 v[48:51], v[116:119], v[88:91], v[48:51]
  ds_read_b64_tr_b16 v[164:165], v184 offset:7360
  v_mfma_f32_16x16x32_bf16 v[24:27], v[120:123], v[84:87], v[24:27]
  ds_read_b64_tr_b16 v[166:167], v184 offset:9152
  v_mfma_f32_16x16x32_bf16 v[52:55], v[120:123], v[88:91], v[52:55]
  v_mfma_f32_16x16x32_bf16 v[28:31], v[124:127], v[84:87], v[28:31]
  v_mfma_f32_16x16x32_bf16 v[56:59], v[124:127], v[88:91], v[56:59]
  s_waitcnt lgkmcnt(0)
  s_barrier
  v_mfma_f32_16x16x32_bf16 v[4:7], v[140:143], v[92:95], v[4:7]
  ds_read_b64_tr_b16 v[100:101], v184 offset:30720
  ds_read_b64_tr_b16 v[102:103], v184 offset:32512
  v_mfma_f32_16x16x32_bf16 v[32:35], v[140:143], v[96:99], v[32:35]
  ds_read_b128 v[84:87], v180 offset:30720
  v_mfma_f32_16x16x32_bf16 v[8:11], v[144:147], v[92:95], v[8:11]
  ds_read_b128 v[88:91], v180 offset:32768
  ds_read_b64_tr_b16 v[104:105], v184 offset:30752
  v_mfma_f32_16x16x32_bf16 v[36:39], v[144:147], v[96:99], v[36:39]
  ds_read_b64_tr_b16 v[106:107], v184 offset:32544
  v_mfma_f32_16x16x32_bf16 v[12:15], v[148:151], v[92:95], v[12:15]
  ds_read_b64_tr_b16 v[108:109], v184 offset:30784
  ds_read_b64_tr_b16 v[110:111], v184 offset:32576
  v_mfma_f32_16x16x32_bf16 v[40:43], v[148:151], v[96:99], v[40:43]
  ds_read_b64_tr_b16 v[112:113], v184 offset:30816
  v_mfma_f32_16x16x32_bf16 v[16:19], v[152:155], v[92:95], v[16:19]
  ds_read_b64_tr_b16 v[114:115], v184 offset:32608
  ds_read_b64_tr_b16 v[116:117], v184 offset:30848
  v_mfma_f32_16x16x32_bf16 v[44:47], v[152:155], v[96:99], v[44:47]
  ds_read_b64_tr_b16 v[118:119], v184 offset:32640
  v_mfma_f32_16x16x32_bf16 v[20:23], v[156:159], v[92:95], v[20:23]
  ds_read_b64_tr_b16 v[120:121], v184 offset:30880
  ds_read_b64_tr_b16 v[122:123], v184 offset:32672
  v_mfma_f32_16x16x32_bf16 v[48:51], v[156:159], v[96:99], v[48:51]
  ds_read_b64_tr_b16 v[124:125], v184 offset:30912
  v_mfma_f32_16x16x32_bf16 v[24:27], v[160:163], v[92:95], v[24:27]
  ds_read_b64_tr_b16 v[126:127], v184 offset:32704
  v_mfma_f32_16x16x32_bf16 v[52:55], v[160:163], v[96:99], v[52:55]
  v_mfma_f32_16x16x32_bf16 v[28:31], v[164:167], v[92:95], v[28:31]
  v_mfma_f32_16x16x32_bf16 v[56:59], v[164:167], v[96:99], v[56:59]
  s_waitcnt lgkmcnt(0)
  v_mfma_f32_16x16x32_bf16 v[4:7], v[100:103], v[84:87], v[4:7]
  ds_read_b64_tr_b16 v[140:141], v184 offset:37888
  ds_read_b64_tr_b16 v[142:143], v184 offset:39680
  v_mfma_f32_16x16x32_bf16 v[32:35], v[100:103], v[88:91], v[32:35]
  ds_read_b128 v[92:95], v182 offset:30720
  v_mfma_f32_16x16x32_bf16 v[8:11], v[104:107], v[84:87], v[8:11]
  ds_read_b128 v[96:99], v182 offset:32768
  ds_read_b64_tr_b16 v[144:145], v184 offset:37920
  v_mfma_f32_16x16x32_bf16 v[36:39], v[104:107], v[88:91], v[36:39]
  ds_read_b64_tr_b16 v[146:147], v184 offset:39712
  v_mfma_f32_16x16x32_bf16 v[12:15], v[108:111], v[84:87], v[12:15]
  ds_read_b64_tr_b16 v[148:149], v184 offset:37952
  ds_read_b64_tr_b16 v[150:151], v184 offset:39744
  v_mfma_f32_16x16x32_bf16 v[40:43], v[108:111], v[88:91], v[40:43]
  ds_read_b64_tr_b16 v[152:153], v184 offset:37984
  v_mfma_f32_16x16x32_bf16 v[16:19], v[112:115], v[84:87], v[16:19]
  ds_read_b64_tr_b16 v[154:155], v184 offset:39776
  ds_read_b64_tr_b16 v[156:157], v184 offset:38016
  v_mfma_f32_16x16x32_bf16 v[44:47], v[112:115], v[88:91], v[44:47]
  ds_read_b64_tr_b16 v[158:159], v184 offset:39808
  v_mfma_f32_16x16x32_bf16 v[20:23], v[116:119], v[84:87], v[20:23]
  ds_read_b64_tr_b16 v[160:161], v184 offset:38048
  ds_read_b64_tr_b16 v[162:163], v184 offset:39840
  v_mfma_f32_16x16x32_bf16 v[48:51], v[116:119], v[88:91], v[48:51]
  ds_read_b64_tr_b16 v[164:165], v184 offset:38080
  v_mfma_f32_16x16x32_bf16 v[24:27], v[120:123], v[84:87], v[24:27]
  ds_read_b64_tr_b16 v[166:167], v184 offset:39872
  v_mfma_f32_16x16x32_bf16 v[52:55], v[120:123], v[88:91], v[52:55]
  v_mfma_f32_16x16x32_bf16 v[28:31], v[124:127], v[84:87], v[28:31]
  v_mfma_f32_16x16x32_bf16 v[56:59], v[124:127], v[88:91], v[56:59]
  s_waitcnt lgkmcnt(0)
  s_barrier
  v_mfma_f32_16x16x32_bf16 v[4:7], v[140:143], v[92:95], v[4:7]
  ds_read_b64_tr_b16 v[100:101], v185 offset:0
  ds_read_b64_tr_b16 v[102:103], v185 offset:1792
  v_mfma_f32_16x16x32_bf16 v[32:35], v[140:143], v[96:99], v[32:35]
  ds_read_b128 v[84:87], v181 offset:0
  v_mfma_f32_16x16x32_bf16 v[8:11], v[144:147], v[92:95], v[8:11]
  ds_read_b128 v[88:91], v181 offset:2048
  ds_read_b64_tr_b16 v[104:105], v185 offset:32
  v_mfma_f32_16x16x32_bf16 v[36:39], v[144:147], v[96:99], v[36:39]
  ds_read_b64_tr_b16 v[106:107], v185 offset:1824
  v_mfma_f32_16x16x32_bf16 v[12:15], v[148:151], v[92:95], v[12:15]
  ds_read_b64_tr_b16 v[108:109], v185 offset:64
  ds_read_b64_tr_b16 v[110:111], v185 offset:1856
  v_mfma_f32_16x16x32_bf16 v[40:43], v[148:151], v[96:99], v[40:43]
  ds_read_b64_tr_b16 v[112:113], v185 offset:96
  v_mfma_f32_16x16x32_bf16 v[16:19], v[152:155], v[92:95], v[16:19]
  ds_read_b64_tr_b16 v[114:115], v185 offset:1888
  ds_read_b64_tr_b16 v[116:117], v185 offset:128
  v_mfma_f32_16x16x32_bf16 v[44:47], v[152:155], v[96:99], v[44:47]
  ds_read_b64_tr_b16 v[118:119], v185 offset:1920
  v_mfma_f32_16x16x32_bf16 v[20:23], v[156:159], v[92:95], v[20:23]
  ds_read_b64_tr_b16 v[120:121], v185 offset:160
  ds_read_b64_tr_b16 v[122:123], v185 offset:1952
  v_mfma_f32_16x16x32_bf16 v[48:51], v[156:159], v[96:99], v[48:51]
  ds_read_b64_tr_b16 v[124:125], v185 offset:192
  v_mfma_f32_16x16x32_bf16 v[24:27], v[160:163], v[92:95], v[24:27]
  ds_read_b64_tr_b16 v[126:127], v185 offset:1984
  v_mfma_f32_16x16x32_bf16 v[52:55], v[160:163], v[96:99], v[52:55]
  v_mfma_f32_16x16x32_bf16 v[28:31], v[164:167], v[92:95], v[28:31]
  v_mfma_f32_16x16x32_bf16 v[56:59], v[164:167], v[96:99], v[56:59]
  s_waitcnt lgkmcnt(0)
  v_mfma_f32_16x16x32_bf16 v[4:7], v[100:103], v[84:87], v[4:7]
  ds_read_b64_tr_b16 v[140:141], v185 offset:7168
  ds_read_b64_tr_b16 v[142:143], v185 offset:8960
  v_mfma_f32_16x16x32_bf16 v[32:35], v[100:103], v[88:91], v[32:35]
  ds_read_b128 v[92:95], v183 offset:0
  v_mfma_f32_16x16x32_bf16 v[8:11], v[104:107], v[84:87], v[8:11]
  ds_read_b128 v[96:99], v183 offset:2048
  ds_read_b64_tr_b16 v[144:145], v185 offset:7200
  v_mfma_f32_16x16x32_bf16 v[36:39], v[104:107], v[88:91], v[36:39]
  ds_read_b64_tr_b16 v[146:147], v185 offset:8992
  v_mfma_f32_16x16x32_bf16 v[12:15], v[108:111], v[84:87], v[12:15]
  ds_read_b64_tr_b16 v[148:149], v185 offset:7232
  ds_read_b64_tr_b16 v[150:151], v185 offset:9024
  v_mfma_f32_16x16x32_bf16 v[40:43], v[108:111], v[88:91], v[40:43]
  ds_read_b64_tr_b16 v[152:153], v185 offset:7264
  v_mfma_f32_16x16x32_bf16 v[16:19], v[112:115], v[84:87], v[16:19]
  ds_read_b64_tr_b16 v[154:155], v185 offset:9056
  ds_read_b64_tr_b16 v[156:157], v185 offset:7296
  v_mfma_f32_16x16x32_bf16 v[44:47], v[112:115], v[88:91], v[44:47]
  ds_read_b64_tr_b16 v[158:159], v185 offset:9088
  v_mfma_f32_16x16x32_bf16 v[20:23], v[116:119], v[84:87], v[20:23]
  ds_read_b64_tr_b16 v[160:161], v185 offset:7328
  ds_read_b64_tr_b16 v[162:163], v185 offset:9120
  v_mfma_f32_16x16x32_bf16 v[48:51], v[116:119], v[88:91], v[48:51]
  ds_read_b64_tr_b16 v[164:165], v185 offset:7360
  v_mfma_f32_16x16x32_bf16 v[24:27], v[120:123], v[84:87], v[24:27]
  ds_read_b64_tr_b16 v[166:167], v185 offset:9152
  v_mfma_f32_16x16x32_bf16 v[52:55], v[120:123], v[88:91], v[52:55]
  v_mfma_f32_16x16x32_bf16 v[28:31], v[124:127], v[84:87], v[28:31]
  v_mfma_f32_16x16x32_bf16 v[56:59], v[124:127], v[88:91], v[56:59]
  s_waitcnt lgkmcnt(0)
  s_barrier
  v_mfma_f32_16x16x32_bf16 v[4:7], v[140:143], v[92:95], v[4:7]
  ds_read_b64_tr_b16 v[100:101], v185 offset:30720
  ds_read_b64_tr_b16 v[102:103], v185 offset:32512
  v_mfma_f32_16x16x32_bf16 v[32:35], v[140:143], v[96:99], v[32:35]
  ds_read_b128 v[84:87], v181 offset:30720
  v_mfma_f32_16x16x32_bf16 v[8:11], v[144:147], v[92:95], v[8:11]
  ds_read_b128 v[88:91], v181 offset:32768
  ds_read_b64_tr_b16 v[104:105], v185 offset:30752
  v_mfma_f32_16x16x32_bf16 v[36:39], v[144:147], v[96:99], v[36:39]
  ds_read_b64_tr_b16 v[106:107], v185 offset:32544
  v_mfma_f32_16x16x32_bf16 v[12:15], v[148:151], v[92:95], v[12:15]
  ds_read_b64_tr_b16 v[108:109], v185 offset:30784
  ds_read_b64_tr_b16 v[110:111], v185 offset:32576
  v_mfma_f32_16x16x32_bf16 v[40:43], v[148:151], v[96:99], v[40:43]
  ds_read_b64_tr_b16 v[112:113], v185 offset:30816
  v_mfma_f32_16x16x32_bf16 v[16:19], v[152:155], v[92:95], v[16:19]
  ds_read_b64_tr_b16 v[114:115], v185 offset:32608
  ds_read_b64_tr_b16 v[116:117], v185 offset:30848
  v_mfma_f32_16x16x32_bf16 v[44:47], v[152:155], v[96:99], v[44:47]
  ds_read_b64_tr_b16 v[118:119], v185 offset:32640
  v_mfma_f32_16x16x32_bf16 v[20:23], v[156:159], v[92:95], v[20:23]
  ds_read_b64_tr_b16 v[120:121], v185 offset:30880
  ds_read_b64_tr_b16 v[122:123], v185 offset:32672
  v_mfma_f32_16x16x32_bf16 v[48:51], v[156:159], v[96:99], v[48:51]
  ds_read_b64_tr_b16 v[124:125], v185 offset:30912
  v_mfma_f32_16x16x32_bf16 v[24:27], v[160:163], v[92:95], v[24:27]
  ds_read_b64_tr_b16 v[126:127], v185 offset:32704
  v_mfma_f32_16x16x32_bf16 v[52:55], v[160:163], v[96:99], v[52:55]
  v_mfma_f32_16x16x32_bf16 v[28:31], v[164:167], v[92:95], v[28:31]
  v_mfma_f32_16x16x32_bf16 v[56:59], v[164:167], v[96:99], v[56:59]
  s_waitcnt lgkmcnt(0)
  v_mfma_f32_16x16x32_bf16 v[4:7], v[100:103], v[84:87], v[4:7]
  ds_read_b64_tr_b16 v[140:141], v185 offset:37888
  ds_read_b64_tr_b16 v[142:143], v185 offset:39680
  v_mfma_f32_16x16x32_bf16 v[32:35], v[100:103], v[88:91], v[32:35]
  ds_read_b128 v[92:95], v183 offset:30720
  v_mfma_f32_16x16x32_bf16 v[8:11], v[104:107], v[84:87], v[8:11]
  ds_read_b128 v[96:99], v183 offset:32768
  ds_read_b64_tr_b16 v[144:145], v185 offset:37920
  v_mfma_f32_16x16x32_bf16 v[36:39], v[104:107], v[88:91], v[36:39]
  ds_read_b64_tr_b16 v[146:147], v185 offset:39712
  v_mfma_f32_16x16x32_bf16 v[12:15], v[108:111], v[84:87], v[12:15]
  ds_read_b64_tr_b16 v[148:149], v185 offset:37952
  ds_read_b64_tr_b16 v[150:151], v185 offset:39744
  v_mfma_f32_16x16x32_bf16 v[40:43], v[108:111], v[88:91], v[40:43]
  ds_read_b64_tr_b16 v[152:153], v185 offset:37984
  v_mfma_f32_16x16x32_bf16 v[16:19], v[112:115], v[84:87], v[16:19]
  ds_read_b64_tr_b16 v[154:155], v185 offset:39776
  ds_read_b64_tr_b16 v[156:157], v185 offset:38016
  v_mfma_f32_16x16x32_bf16 v[44:47], v[112:115], v[88:91], v[44:47]
  ds_read_b64_tr_b16 v[158:159], v185 offset:39808
  v_mfma_f32_16x16x32_bf16 v[20:23], v[116:119], v[84:87], v[20:23]
  ds_read_b64_tr_b16 v[160:161], v185 offset:38048
  ds_read_b64_tr_b16 v[162:163], v185 offset:39840
  v_mfma_f32_16x16x32_bf16 v[48:51], v[116:119], v[88:91], v[48:51]
  ds_read_b64_tr_b16 v[164:165], v185 offset:38080
  v_mfma_f32_16x16x32_bf16 v[24:27], v[120:123], v[84:87], v[24:27]
  ds_read_b64_tr_b16 v[166:167], v185 offset:39872
  v_mfma_f32_16x16x32_bf16 v[52:55], v[120:123], v[88:91], v[52:55]
  v_mfma_f32_16x16x32_bf16 v[28:31], v[124:127], v[84:87], v[28:31]
  v_mfma_f32_16x16x32_bf16 v[56:59], v[124:127], v[88:91], v[56:59]
  s_waitcnt lgkmcnt(0)
  s_barrier
  v_mfma_f32_16x16x32_bf16 v[4:7], v[140:143], v[92:95], v[4:7]
  ds_read_b64_tr_b16 v[100:101], v184 offset:0
  ds_read_b64_tr_b16 v[102:103], v184 offset:1792
  v_mfma_f32_16x16x32_bf16 v[32:35], v[140:143], v[96:99], v[32:35]
  ds_read_b128 v[84:87], v180 offset:0
  v_mfma_f32_16x16x32_bf16 v[8:11], v[144:147], v[92:95], v[8:11]
  ds_read_b128 v[88:91], v180 offset:2048
  ds_read_b64_tr_b16 v[104:105], v184 offset:32
  v_mfma_f32_16x16x32_bf16 v[36:39], v[144:147], v[96:99], v[36:39]
  ds_read_b64_tr_b16 v[106:107], v184 offset:1824
  v_mfma_f32_16x16x32_bf16 v[12:15], v[148:151], v[92:95], v[12:15]
  ds_read_b64_tr_b16 v[108:109], v184 offset:64
  ds_read_b64_tr_b16 v[110:111], v184 offset:1856
  v_mfma_f32_16x16x32_bf16 v[40:43], v[148:151], v[96:99], v[40:43]
  ds_read_b64_tr_b16 v[112:113], v184 offset:96
  v_mfma_f32_16x16x32_bf16 v[16:19], v[152:155], v[92:95], v[16:19]
  ds_read_b64_tr_b16 v[114:115], v184 offset:1888
  ds_read_b64_tr_b16 v[116:117], v184 offset:128
  v_mfma_f32_16x16x32_bf16 v[44:47], v[152:155], v[96:99], v[44:47]
  ds_read_b64_tr_b16 v[118:119], v184 offset:1920
  v_mfma_f32_16x16x32_bf16 v[20:23], v[156:159], v[92:95], v[20:23]
  ds_read_b64_tr_b16 v[120:121], v184 offset:160
  ds_read_b64_tr_b16 v[122:123], v184 offset:1952
  v_mfma_f32_16x16x32_bf16 v[48:51], v[156:159], v[96:99], v[48:51]
  ds_read_b64_tr_b16 v[124:125], v184 offset:192
  v_mfma_f32_16x16x32_bf16 v[24:27], v[160:163], v[92:95], v[24:27]
  ds_read_b64_tr_b16 v[126:127], v184 offset:1984
  v_mfma_f32_16x16x32_bf16 v[52:55], v[160:163], v[96:99], v[52:55]
  v_mfma_f32_16x16x32_bf16 v[28:31], v[164:167], v[92:95], v[28:31]
  v_mfma_f32_16x16x32_bf16 v[56:59], v[164:167], v[96:99], v[56:59]
  s_waitcnt lgkmcnt(0)
  v_mfma_f32_16x16x32_bf16 v[4:7], v[100:103], v[84:87], v[4:7]
  ds_read_b64_tr_b16 v[140:141], v184 offset:7168
  ds_read_b64_tr_b16 v[142:143], v184 offset:8960
  v_mfma_f32_16x16x32_bf16 v[32:35], v[100:103], v[88:91], v[32:35]
  ds_read_b128 v[92:95], v182 offset:0
  v_mfma_f32_16x16x32_bf16 v[8:11], v[104:107], v[84:87], v[8:11]
  ds_read_b128 v[96:99], v182 offset:2048
  ds_read_b64_tr_b16 v[144:145], v184 offset:7200
  v_mfma_f32_16x16x32_bf16 v[36:39], v[104:107], v[88:91], v[36:39]
  ds_read_b64_tr_b16 v[146:147], v184 offset:8992
  v_mfma_f32_16x16x32_bf16 v[12:15], v[108:111], v[84:87], v[12:15]
  ds_read_b64_tr_b16 v[148:149], v184 offset:7232
  ds_read_b64_tr_b16 v[150:151], v184 offset:9024
  v_mfma_f32_16x16x32_bf16 v[40:43], v[108:111], v[88:91], v[40:43]
  ds_read_b64_tr_b16 v[152:153], v184 offset:7264
  v_mfma_f32_16x16x32_bf16 v[16:19], v[112:115], v[84:87], v[16:19]
  ds_read_b64_tr_b16 v[154:155], v184 offset:9056
  ds_read_b64_tr_b16 v[156:157], v184 offset:7296
  v_mfma_f32_16x16x32_bf16 v[44:47], v[112:115], v[88:91], v[44:47]
  ds_read_b64_tr_b16 v[158:159], v184 offset:9088
  v_mfma_f32_16x16x32_bf16 v[20:23], v[116:119], v[84:87], v[20:23]
  ds_read_b64_tr_b16 v[160:161], v184 offset:7328
  ds_read_b64_tr_b16 v[162:163], v184 offset:9120
  v_mfma_f32_16x16x32_bf16 v[48:51], v[116:119], v[88:91], v[48:51]
  ds_read_b64_tr_b16 v[164:165], v184 offset:7360
  v_mfma_f32_16x16x32_bf16 v[24:27], v[120:123], v[84:87], v[24:27]
  ds_read_b64_tr_b16 v[166:167], v184 offset:9152
  v_mfma_f32_16x16x32_bf16 v[52:55], v[120:123], v[88:91], v[52:55]
  v_mfma_f32_16x16x32_bf16 v[28:31], v[124:127], v[84:87], v[28:31]
  v_mfma_f32_16x16x32_bf16 v[56:59], v[124:127], v[88:91], v[56:59]
  s_waitcnt lgkmcnt(0)
  s_barrier
  v_mfma_f32_16x16x32_bf16 v[4:7], v[140:143], v[92:95], v[4:7]
  ds_read_b64_tr_b16 v[100:101], v184 offset:30720
  ds_read_b64_tr_b16 v[102:103], v184 offset:32512
  v_mfma_f32_16x16x32_bf16 v[32:35], v[140:143], v[96:99], v[32:35]
  ds_read_b128 v[84:87], v180 offset:30720
  v_mfma_f32_16x16x32_bf16 v[8:11], v[144:147], v[92:95], v[8:11]
  ds_read_b128 v[88:91], v180 offset:32768
  ds_read_b64_tr_b16 v[104:105], v184 offset:30752
  v_mfma_f32_16x16x32_bf16 v[36:39], v[144:147], v[96:99], v[36:39]
  ds_read_b64_tr_b16 v[106:107], v184 offset:32544
  v_mfma_f32_16x16x32_bf16 v[12:15], v[148:151], v[92:95], v[12:15]
  ds_read_b64_tr_b16 v[108:109], v184 offset:30784
  ds_read_b64_tr_b16 v[110:111], v184 offset:32576
  v_mfma_f32_16x16x32_bf16 v[40:43], v[148:151], v[96:99], v[40:43]
  ds_read_b64_tr_b16 v[112:113], v184 offset:30816
  v_mfma_f32_16x16x32_bf16 v[16:19], v[152:155], v[92:95], v[16:19]
  ds_read_b64_tr_b16 v[114:115], v184 offset:32608
  ds_read_b64_tr_b16 v[116:117], v184 offset:30848
  v_mfma_f32_16x16x32_bf16 v[44:47], v[152:155], v[96:99], v[44:47]
  ds_read_b64_tr_b16 v[118:119], v184 offset:32640
  v_mfma_f32_16x16x32_bf16 v[20:23], v[156:159], v[92:95], v[20:23]
  ds_read_b64_tr_b16 v[120:121], v184 offset:30880
  ds_read_b64_tr_b16 v[122:123], v184 offset:32672
  v_mfma_f32_16x16x32_bf16 v[48:51], v[156:159], v[96:99], v[48:51]
  ds_read_b64_tr_b16 v[124:125], v184 offset:30912
  v_mfma_f32_16x16x32_bf16 v[24:27], v[160:163], v[92:95], v[24:27]
  ds_read_b64_tr_b16 v[126:127], v184 offset:32704
  v_mfma_f32_16x16x32_bf16 v[52:55], v[160:163], v[96:99], v[52:55]
  v_mfma_f32_16x16x32_bf16 v[28:31], v[164:167], v[92:95], v[28:31]
  v_mfma_f32_16x16x32_bf16 v[56:59], v[164:167], v[96:99], v[56:59]
  s_waitcnt lgkmcnt(0)
  v_mfma_f32_16x16x32_bf16 v[4:7], v[100:103], v[84:87], v[4:7]
  ds_read_b64_tr_b16 v[140:141], v184 offset:37888
  ds_read_b64_tr_b16 v[142:143], v184 offset:39680
  v_mfma_f32_16x16x32_bf16 v[32:35], v[100:103], v[88:91], v[32:35]
  ds_read_b128 v[92:95], v182 offset:30720
  v_mfma_f32_16x16x32_bf16 v[8:11], v[104:107], v[84:87], v[8:11]
  ds_read_b128 v[96:99], v182 offset:32768
  ds_read_b64_tr_b16 v[144:145], v184 offset:37920
  v_mfma_f32_16x16x32_bf16 v[36:39], v[104:107], v[88:91], v[36:39]
  ds_read_b64_tr_b16 v[146:147], v184 offset:39712
  v_mfma_f32_16x16x32_bf16 v[12:15], v[108:111], v[84:87], v[12:15]
  ds_read_b64_tr_b16 v[148:149], v184 offset:37952
  ds_read_b64_tr_b16 v[150:151], v184 offset:39744
  v_mfma_f32_16x16x32_bf16 v[40:43], v[108:111], v[88:91], v[40:43]
  ds_read_b64_tr_b16 v[152:153], v184 offset:37984
  v_mfma_f32_16x16x32_bf16 v[16:19], v[112:115], v[84:87], v[16:19]
  ds_read_b64_tr_b16 v[154:155], v184 offset:39776
  ds_read_b64_tr_b16 v[156:157], v184 offset:38016
  v_mfma_f32_16x16x32_bf16 v[44:47], v[112:115], v[88:91], v[44:47]
  ds_read_b64_tr_b16 v[158:159], v184 offset:39808
  v_mfma_f32_16x16x32_bf16 v[20:23], v[116:119], v[84:87], v[20:23]
  ds_read_b64_tr_b16 v[160:161], v184 offset:38048
  ds_read_b64_tr_b16 v[162:163], v184 offset:39840
  v_mfma_f32_16x16x32_bf16 v[48:51], v[116:119], v[88:91], v[48:51]
  ds_read_b64_tr_b16 v[164:165], v184 offset:38080
  v_mfma_f32_16x16x32_bf16 v[24:27], v[120:123], v[84:87], v[24:27]
  ds_read_b64_tr_b16 v[166:167], v184 offset:39872
  v_mfma_f32_16x16x32_bf16 v[52:55], v[120:123], v[88:91], v[52:55]
  v_mfma_f32_16x16x32_bf16 v[28:31], v[124:127], v[84:87], v[28:31]
  v_mfma_f32_16x16x32_bf16 v[56:59], v[124:127], v[88:91], v[56:59]
  s_waitcnt lgkmcnt(0)
  s_barrier
  v_mfma_f32_16x16x32_bf16 v[4:7], v[140:143], v[92:95], v[4:7]
  ds_read_b64 v[84:85], v207
  v_mfma_f32_16x16x32_bf16 v[32:35], v[140:143], v[96:99], v[32:35]
  ds_read_b64 v[86:87], v207 offset:128
  v_mfma_f32_16x16x32_bf16 v[8:11], v[144:147], v[92:95], v[8:11]
  ds_read_b128 v[100:103], v210 offset:0
  v_mfma_f32_16x16x32_bf16 v[36:39], v[144:147], v[96:99], v[36:39]
  ds_read_b128 v[104:107], v210 offset:64
  v_mfma_f32_16x16x32_bf16 v[12:15], v[148:151], v[92:95], v[12:15]
  ds_read_b128 v[108:111], v210 offset:128
  v_mfma_f32_16x16x32_bf16 v[40:43], v[148:151], v[96:99], v[40:43]
  v_mfma_f32_16x16x32_bf16 v[16:19], v[152:155], v[92:95], v[16:19]
  ds_read_b128 v[112:115], v210 offset:192
  v_mfma_f32_16x16x32_bf16 v[44:47], v[152:155], v[96:99], v[44:47]
  ds_read_b128 v[116:119], v210 offset:256
  v_mfma_f32_16x16x32_bf16 v[20:23], v[156:159], v[92:95], v[20:23]
  ds_read_b128 v[120:123], v210 offset:320
  v_mfma_f32_16x16x32_bf16 v[48:51], v[156:159], v[96:99], v[48:51]
  ds_read_b128 v[124:127], v210 offset:384
  v_mfma_f32_16x16x32_bf16 v[24:27], v[160:163], v[92:95], v[24:27]
  v_mfma_f32_16x16x32_bf16 v[52:55], v[160:163], v[96:99], v[52:55]
  v_mfma_f32_16x16x32_bf16 v[28:31], v[164:167], v[92:95], v[28:31]
  v_mfma_f32_16x16x32_bf16 v[56:59], v[164:167], v[96:99], v[56:59]
  s_lshl_b32 s30, s22, 7
  v_add_u32 v191, s30, v205
  v_lshrrev_b32 v188, 4, v1
  v_lshlrev_b32 v189, 3, v188
  v_and_b32 v188, 1, v188
  v_mul_u32_u24 v188, 24, v188
  v_add_u32 v188, v188, v189
  s_mul_i32 s30, s23, 224
  s_sub_u32 s31, 3456, s30
  s_add_u32 s30, s30, 0x1400000
  v_mul_u32_u24 v190, 3456, v191
  v_add_u32 v190, s30, v190
  v_add_u32 v196, v190, v188
  v_add_u32 v197, v190, v189
  v_sub_u32 v198, s31, v188
  v_sub_u32 v199, s31, v189
  v_mov_b32 v201, 0x80000000
  s_waitcnt lgkmcnt(0)
  s_mov_b32 s32, 0
  v_pk_fma_f32 v[4:5], v[100:101], v[84:85], v[4:5] op_sel_hi:[1,0,1]
  v_pk_fma_f32 v[6:7], v[102:103], v[84:85], v[6:7] op_sel_hi:[1,0,1]
  v_pk_mul_f32 v[4:5], v[4:5], v[84:85] op_sel:[0,1] op_sel_hi:[1,1]
  v_pk_mul_f32 v[6:7], v[6:7], v[84:85] op_sel:[0,1] op_sel_hi:[1,1]
  v_pk_mul_f32 v[188:189], v[4:5], v[4:5]
  v_pk_mul_f32 v[190:191], v[6:7], v[6:7]
  v_pk_fma_f32 v[188:189], v[188:189], s[28:29], s[28:29] op_sel:[0,1,0] op_sel_hi:[1,1,0]
  v_pk_fma_f32 v[190:191], v[190:191], s[28:29], s[28:29] op_sel:[0,1,0] op_sel_hi:[1,1,0]
  v_pk_mul_f32 v[188:189], v[188:189], v[4:5]
  v_pk_mul_f32 v[190:191], v[190:191], v[6:7]
  v_exp_f32 v188, v188
  v_exp_f32 v189, v189
  v_exp_f32 v190, v190
  v_exp_f32 v191, v191
  v_pk_add_f32 v[188:189], v[188:189], 1.0 op_sel_hi:[1,0]
  v_pk_add_f32 v[190:191], v[190:191], 1.0 op_sel_hi:[1,0]
  v_rcp_f32 v188, v188
  v_rcp_f32 v189, v189
  v_rcp_f32 v190, v190
  v_rcp_f32 v191, v191
  v_pk_mul_f32 v[4:5], v[188:189], v[4:5]
  v_pk_mul_f32 v[6:7], v[190:191], v[6:7]
  v_cvt_pk_bf16_f32 v140, v4, v5
  v_cvt_pk_bf16_f32 v141, v6, v7
  v_pk_fma_f32 v[8:9], v[104:105], v[84:85], v[8:9] op_sel_hi:[1,0,1]
  v_pk_fma_f32 v[10:11], v[106:107], v[84:85], v[10:11] op_sel_hi:[1,0,1]
  v_pk_mul_f32 v[8:9], v[8:9], v[84:85] op_sel:[0,1] op_sel_hi:[1,1]
  v_pk_mul_f32 v[10:11], v[10:11], v[84:85] op_sel:[0,1] op_sel_hi:[1,1]
  v_pk_mul_f32 v[192:193], v[8:9], v[8:9]
  v_pk_mul_f32 v[194:195], v[10:11], v[10:11]
  v_pk_fma_f32 v[192:193], v[192:193], s[28:29], s[28:29] op_sel:[0,1,0] op_sel_hi:[1,1,0]
  v_pk_fma_f32 v[194:195], v[194:195], s[28:29], s[28:29] op_sel:[0,1,0] op_sel_hi:[1,1,0]
  v_pk_mul_f32 v[192:193], v[192:193], v[8:9]
  v_pk_mul_f32 v[194:195], v[194:195], v[10:11]
  v_exp_f32 v192, v192
  v_exp_f32 v193, v193
  v_exp_f32 v194, v194
  v_exp_f32 v195, v195
  v_pk_add_f32 v[192:193], v[192:193], 1.0 op_sel_hi:[1,0]
  v_pk_add_f32 v[194:195], v[194:195], 1.0 op_sel_hi:[1,0]
  v_rcp_f32 v192, v192
  v_rcp_f32 v193, v193
  v_rcp_f32 v194, v194
  v_rcp_f32 v195, v195
  v_pk_mul_f32 v[8:9], v[192:193], v[8:9]
  v_pk_mul_f32 v[10:11], v[194:195], v[10:11]
  v_cvt_pk_bf16_f32 v142, v8, v9
  v_cvt_pk_bf16_f32 v143, v10, v11
  v_cmp_lt_i32 vcc, 0, v198
  s_nop 1
  v_permlane16_swap_b32 v140, v142
  v_permlane16_swap_b32 v141, v143
  v_cndmask_b32 v200, v201, v196, vcc
  s_cmp_lg_u32 s25, 0
  s_cbranch_scc1 .dp_60
  buffer_store_dwordx4 v[140:143], v200, s[4:7], s32 offen offset:0 sc1
  s_branch .de_61
.dp_60:
  buffer_store_dwordx4 v[140:143], v200, s[4:7], s32 offen offset:0
.de_61:
  v_pk_fma_f32 v[12:13], v[108:109], v[84:85], v[12:13] op_sel_hi:[1,0,1]
  v_pk_fma_f32 v[14:15], v[110:111], v[84:85], v[14:15] op_sel_hi:[1,0,1]
  v_pk_mul_f32 v[12:13], v[12:13], v[84:85] op_sel:[0,1] op_sel_hi:[1,1]
  v_pk_mul_f32 v[14:15], v[14:15], v[84:85] op_sel:[0,1] op_sel_hi:[1,1]
  v_pk_mul_f32 v[188:189], v[12:13], v[12:13]
  v_pk_mul_f32 v[190:191], v[14:15], v[14:15]
  v_pk_fma_f32 v[188:189], v[188:189], s[28:29], s[28:29] op_sel:[0,1,0] op_sel_hi:[1,1,0]
  v_pk_fma_f32 v[190:191], v[190:191], s[28:29], s[28:29] op_sel:[0,1,0] op_sel_hi:[1,1,0]
  v_pk_mul_f32 v[188:189], v[188:189], v[12:13]
  v_pk_mul_f32 v[190:191], v[190:191], v[14:15]
  v_exp_f32 v188, v188
  v_exp_f32 v189, v189
  v_exp_f32 v190, v190
  v_exp_f32 v191, v191
  v_pk_add_f32 v[188:189], v[188:189], 1.0 op_sel_hi:[1,0]
  v_pk_add_f32 v[190:191], v[190:191], 1.0 op_sel_hi:[1,0]
  v_rcp_f32 v188, v188
  v_rcp_f32 v189, v189
  v_rcp_f32 v190, v190
  v_rcp_f32 v191, v191
  v_pk_mul_f32 v[12:13], v[188:189], v[12:13]
  v_pk_mul_f32 v[14:15], v[190:191], v[14:15]
  v_cvt_pk_bf16_f32 v144, v12, v13
  v_cvt_pk_bf16_f32 v145, v14, v15
  v_pk_fma_f32 v[16:17], v[112:113], v[84:85], v[16:17] op_sel_hi:[1,0,1]
  v_pk_fma_f32 v[18:19], v[114:115], v[84:85], v[18:19] op_sel_hi:[1,0,1]
  v_pk_mul_f32 v[16:17], v[16:17], v[84:85] op_sel:[0,1] op_sel_hi:[1,1]
  v_pk_mul_f32 v[18:19], v[18:19], v[84:85] op_sel:[0,1] op_sel_hi:[1,1]
  v_pk_mul_f32 v[192:193], v[16:17], v[16:17]
  v_pk_mul_f32 v[194:195], v[18:19], v[18:19]
  v_pk_fma_f32 v[192:193], v[192:193], s[28:29], s[28:29] op_sel:[0,1,0] op_sel_hi:[1,1,0]
  v_pk_fma_f32 v[194:195], v[194:195], s[28:29], s[28:29] op_sel:[0,1,0] op_sel_hi:[1,1,0]
  v_pk_mul_f32 v[192:193], v[192:193], v[16:17]
  v_pk_mul_f32 v[194:195], v[194:195], v[18:19]
  v_exp_f32 v192, v192
  v_exp_f32 v193, v193
  v_exp_f32 v194, v194
  v_exp_f32 v195, v195
  v_pk_add_f32 v[192:193], v[192:193], 1.0 op_sel_hi:[1,0]
  v_pk_add_f32 v[194:195], v[194:195], 1.0 op_sel_hi:[1,0]
  v_rcp_f32 v192, v192
  v_rcp_f32 v193, v193
  v_rcp_f32 v194, v194
  v_rcp_f32 v195, v195
  v_pk_mul_f32 v[16:17], v[192:193], v[16:17]
  v_pk_mul_f32 v[18:19], v[194:195], v[18:19]
  v_cvt_pk_bf16_f32 v146, v16, v17
  v_cvt_pk_bf16_f32 v147, v18, v19
  v_cmp_lt_i32 vcc, 64, v198
  s_nop 1
  v_permlane16_swap_b32 v144, v146
  v_permlane16_swap_b32 v145, v147
  v_cndmask_b32 v200, v201, v196, vcc
  s_cmp_lg_u32 s25, 0
  s_cbranch_scc1 .dp_62
  buffer_store_dwordx4 v[144:147], v200, s[4:7], s32 offen offset:64 sc1
  s_branch .de_63
.dp_62:
  buffer_store_dwordx4 v[144:147], v200, s[4:7], s32 offen offset:64
.de_63:
  v_pk_fma_f32 v[20:21], v[116:117], v[84:85], v[20:21] op_sel_hi:[1,0,1]
  v_pk_fma_f32 v[22:23], v[118:119], v[84:85], v[22:23] op_sel_hi:[1,0,1]
  v_pk_mul_f32 v[20:21], v[20:21], v[84:85] op_sel:[0,1] op_sel_hi:[1,1]
  v_pk_mul_f32 v[22:23], v[22:23], v[84:85] op_sel:[0,1] op_sel_hi:[1,1]
  v_pk_mul_f32 v[188:189], v[20:21], v[20:21]
  v_pk_mul_f32 v[190:191], v[22:23], v[22:23]
  v_pk_fma_f32 v[188:189], v[188:189], s[28:29], s[28:29] op_sel:[0,1,0] op_sel_hi:[1,1,0]
  v_pk_fma_f32 v[190:191], v[190:191], s[28:29], s[28:29] op_sel:[0,1,0] op_sel_hi:[1,1,0]
  v_pk_mul_f32 v[188:189], v[188:189], v[20:21]
  v_pk_mul_f32 v[190:191], v[190:191], v[22:23]
  v_exp_f32 v188, v188
  v_exp_f32 v189, v189
  v_exp_f32 v190, v190
  v_exp_f32 v191, v191
  v_pk_add_f32 v[188:189], v[188:189], 1.0 op_sel_hi:[1,0]
  v_pk_add_f32 v[190:191], v[190:191], 1.0 op_sel_hi:[1,0]
  v_rcp_f32 v188, v188
  v_rcp_f32 v189, v189
  v_rcp_f32 v190, v190
  v_rcp_f32 v191, v191
  v_pk_mul_f32 v[20:21], v[188:189], v[20:21]
  v_pk_mul_f32 v[22:23], v[190:191], v[22:23]
  v_cvt_pk_bf16_f32 v148, v20, v21
  v_cvt_pk_bf16_f32 v149, v22, v23
  v_pk_fma_f32 v[24:25], v[120:121], v[84:85], v[24:25] op_sel_hi:[1,0,1]
  v_pk_fma_f32 v[26:27], v[122:123], v[84:85], v[26:27] op_sel_hi:[1,0,1]
  v_pk_mul_f32 v[24:25], v[24:25], v[84:85] op_sel:[0,1] op_sel_hi:[1,1]
  v_pk_mul_f32 v[26:27], v[26:27], v[84:85] op_sel:[0,1] op_sel_hi:[1,1]
  v_pk_mul_f32 v[192:193], v[24:25], v[24:25]
  v_pk_mul_f32 v[194:195], v[26:27], v[26:27]
  v_pk_fma_f32 v[192:193], v[192:193], s[28:29], s[28:29] op_sel:[0,1,0] op_sel_hi:[1,1,0]
  v_pk_fma_f32 v[194:195], v[194:195], s[28:29], s[28:29] op_sel:[0,1,0] op_sel_hi:[1,1,0]
  v_pk_mul_f32 v[192:193], v[192:193], v[24:25]
  v_pk_mul_f32 v[194:195], v[194:195], v[26:27]
  v_exp_f32 v192, v192
  v_exp_f32 v193, v193
  v_exp_f32 v194, v194
  v_exp_f32 v195, v195
  v_pk_add_f32 v[192:193], v[192:193], 1.0 op_sel_hi:[1,0]
  v_pk_add_f32 v[194:195], v[194:195], 1.0 op_sel_hi:[1,0]
  v_rcp_f32 v192, v192
  v_rcp_f32 v193, v193
  v_rcp_f32 v194, v194
  v_rcp_f32 v195, v195
  v_pk_mul_f32 v[24:25], v[192:193], v[24:25]
  v_pk_mul_f32 v[26:27], v[194:195], v[26:27]
  v_cvt_pk_bf16_f32 v150, v24, v25
  v_cvt_pk_bf16_f32 v151, v26, v27
  v_cmp_lt_i32 vcc, 128, v198
  s_nop 1
  v_permlane16_swap_b32 v148, v150
  v_permlane16_swap_b32 v149, v151
  v_cndmask_b32 v200, v201, v196, vcc
  s_cmp_lg_u32 s25, 0
  s_cbranch_scc1 .dp_64
  buffer_store_dwordx4 v[148:151], v200, s[4:7], s32 offen offset:128 sc1
  s_branch .de_65
.dp_64:
  buffer_store_dwordx4 v[148:151], v200, s[4:7], s32 offen offset:128
.de_65:
  v_pk_fma_f32 v[28:29], v[124:125], v[84:85], v[28:29] op_sel_hi:[1,0,1]
  v_pk_fma_f32 v[30:31], v[126:127], v[84:85], v[30:31] op_sel_hi:[1,0,1]
  v_pk_mul_f32 v[28:29], v[28:29], v[84:85] op_sel:[0,1] op_sel_hi:[1,1]
  v_pk_mul_f32 v[30:31], v[30:31], v[84:85] op_sel:[0,1] op_sel_hi:[1,1]
  v_pk_mul_f32 v[188:189], v[28:29], v[28:29]
  v_pk_mul_f32 v[190:191], v[30:31], v[30:31]
  v_pk_fma_f32 v[188:189], v[188:189], s[28:29], s[28:29] op_sel:[0,1,0] op_sel_hi:[1,1,0]
  v_pk_fma_f32 v[190:191], v[190:191], s[28:29], s[28:29] op_sel:[0,1,0] op_sel_hi:[1,1,0]
  v_pk_mul_f32 v[188:189], v[188:189], v[28:29]
  v_pk_mul_f32 v[190:191], v[190:191], v[30:31]
  v_exp_f32 v188, v188
  v_exp_f32 v189, v189
  v_exp_f32 v190, v190
  v_exp_f32 v191, v191
  v_pk_add_f32 v[188:189], v[188:189], 1.0 op_sel_hi:[1,0]
  v_pk_add_f32 v[190:191], v[190:191], 1.0 op_sel_hi:[1,0]
  v_rcp_f32 v188, v188
  v_rcp_f32 v189, v189
  v_rcp_f32 v190, v190
  v_rcp_f32 v191, v191
  v_pk_mul_f32 v[28:29], v[188:189], v[28:29]
  v_pk_mul_f32 v[30:31], v[190:191], v[30:31]
  v_cvt_pk_bf16_f32 v152, v28, v29
  v_cvt_pk_bf16_f32 v153, v30, v31
  v_cmp_lt_i32 vcc, 192, v199
  s_nop 1
  v_cndmask_b32 v200, v201, v197, vcc
  s_cmp_lg_u32 s25, 0
  s_cbranch_scc1 .dp_66
  buffer_store_dwordx2 v[152:153], v200, s[4:7], s32 offen offset:192 sc1
  s_branch .de_67
.dp_66:
  buffer_store_dwordx2 v[152:153], v200, s[4:7], s32 offen offset:192
.de_67:
  s_mov_b32 s32, 55296
  v_pk_fma_f32 v[32:33], v[100:101], v[86:87], v[32:33] op_sel_hi:[1,0,1]
  v_pk_fma_f32 v[34:35], v[102:103], v[86:87], v[34:35] op_sel_hi:[1,0,1]
  v_pk_mul_f32 v[32:33], v[32:33], v[86:87] op_sel:[0,1] op_sel_hi:[1,1]
  v_pk_mul_f32 v[34:35], v[34:35], v[86:87] op_sel:[0,1] op_sel_hi:[1,1]
  v_pk_mul_f32 v[188:189], v[32:33], v[32:33]
  v_pk_mul_f32 v[190:191], v[34:35], v[34:35]
  v_pk_fma_f32 v[188:189], v[188:189], s[28:29], s[28:29] op_sel:[0,1,0] op_sel_hi:[1,1,0]
  v_pk_fma_f32 v[190:191], v[190:191], s[28:29], s[28:29] op_sel:[0,1,0] op_sel_hi:[1,1,0]
  v_pk_mul_f32 v[188:189], v[188:189], v[32:33]
  v_pk_mul_f32 v[190:191], v[190:191], v[34:35]
  v_exp_f32 v188, v188
  v_exp_f32 v189, v189
  v_exp_f32 v190, v190
  v_exp_f32 v191, v191
  v_pk_add_f32 v[188:189], v[188:189], 1.0 op_sel_hi:[1,0]
  v_pk_add_f32 v[190:191], v[190:191], 1.0 op_sel_hi:[1,0]
  v_rcp_f32 v188, v188
  v_rcp_f32 v189, v189
  v_rcp_f32 v190, v190
  v_rcp_f32 v191, v191
  v_pk_mul_f32 v[32:33], v[188:189], v[32:33]
  v_pk_mul_f32 v[34:35], v[190:191], v[34:35]
  v_cvt_pk_bf16_f32 v156, v32, v33
  v_cvt_pk_bf16_f32 v157, v34, v35
  v_pk_fma_f32 v[36:37], v[104:105], v[86:87], v[36:37] op_sel_hi:[1,0,1]
  v_pk_fma_f32 v[38:39], v[106:107], v[86:87], v[38:39] op_sel_hi:[1,0,1]
  v_pk_mul_f32 v[36:37], v[36:37], v[86:87] op_sel:[0,1] op_sel_hi:[1,1]
  v_pk_mul_f32 v[38:39], v[38:39], v[86:87] op_sel:[0,1] op_sel_hi:[1,1]
  v_pk_mul_f32 v[192:193], v[36:37], v[36:37]
  v_pk_mul_f32 v[194:195], v[38:39], v[38:39]
  v_pk_fma_f32 v[192:193], v[192:193], s[28:29], s[28:29] op_sel:[0,1,0] op_sel_hi:[1,1,0]
  v_pk_fma_f32 v[194:195], v[194:195], s[28:29], s[28:29] op_sel:[0,1,0] op_sel_hi:[1,1,0]
  v_pk_mul_f32 v[192:193], v[192:193], v[36:37]
  v_pk_mul_f32 v[194:195], v[194:195], v[38:39]
  v_exp_f32 v192, v192
  v_exp_f32 v193, v193
  v_exp_f32 v194, v194
  v_exp_f32 v195, v195
  v_pk_add_f32 v[192:193], v[192:193], 1.0 op_sel_hi:[1,0]
  v_pk_add_f32 v[194:195], v[194:195], 1.0 op_sel_hi:[1,0]
  v_rcp_f32 v192, v192
  v_rcp_f32 v193, v193
  v_rcp_f32 v194, v194
  v_rcp_f32 v195, v195
  v_pk_mul_f32 v[36:37], v[192:193], v[36:37]
  v_pk_mul_f32 v[38:39], v[194:195], v[38:39]
  v_cvt_pk_bf16_f32 v158, v36, v37
  v_cvt_pk_bf16_f32 v159, v38, v39
  v_cmp_lt_i32 vcc, 0, v198
  s_nop 1
  v_permlane16_swap_b32 v156, v158
  v_permlane16_swap_b32 v157, v159
  v_cndmask_b32 v200, v201, v196, vcc
  s_cmp_lg_u32 s25, 0
  s_cbranch_scc1 .dp_68
  buffer_store_dwordx4 v[156:159], v200, s[4:7], s32 offen offset:0 sc1
  s_branch .de_69
.dp_68:
  buffer_store_dwordx4 v[156:159], v200, s[4:7], s32 offen offset:0
.de_69:
  v_pk_fma_f32 v[40:41], v[108:109], v[86:87], v[40:41] op_sel_hi:[1,0,1]
  v_pk_fma_f32 v[42:43], v[110:111], v[86:87], v[42:43] op_sel_hi:[1,0,1]
  v_pk_mul_f32 v[40:41], v[40:41], v[86:87] op_sel:[0,1] op_sel_hi:[1,1]
  v_pk_mul_f32 v[42:43], v[42:43], v[86:87] op_sel:[0,1] op_sel_hi:[1,1]
  v_pk_mul_f32 v[188:189], v[40:41], v[40:41]
  v_pk_mul_f32 v[190:191], v[42:43], v[42:43]
  v_pk_fma_f32 v[188:189], v[188:189], s[28:29], s[28:29] op_sel:[0,1,0] op_sel_hi:[1,1,0]
  v_pk_fma_f32 v[190:191], v[190:191], s[28:29], s[28:29] op_sel:[0,1,0] op_sel_hi:[1,1,0]
  v_pk_mul_f32 v[188:189], v[188:189], v[40:41]
  v_pk_mul_f32 v[190:191], v[190:191], v[42:43]
  v_exp_f32 v188, v188
  v_exp_f32 v189, v189
  v_exp_f32 v190, v190
  v_exp_f32 v191, v191
  v_pk_add_f32 v[188:189], v[188:189], 1.0 op_sel_hi:[1,0]
  v_pk_add_f32 v[190:191], v[190:191], 1.0 op_sel_hi:[1,0]
  v_rcp_f32 v188, v188
  v_rcp_f32 v189, v189
  v_rcp_f32 v190, v190
  v_rcp_f32 v191, v191
  v_pk_mul_f32 v[40:41], v[188:189], v[40:41]
  v_pk_mul_f32 v[42:43], v[190:191], v[42:43]
  v_cvt_pk_bf16_f32 v160, v40, v41
  v_cvt_pk_bf16_f32 v161, v42, v43
  v_pk_fma_f32 v[44:45], v[112:113], v[86:87], v[44:45] op_sel_hi:[1,0,1]
  v_pk_fma_f32 v[46:47], v[114:115], v[86:87], v[46:47] op_sel_hi:[1,0,1]
  v_pk_mul_f32 v[44:45], v[44:45], v[86:87] op_sel:[0,1] op_sel_hi:[1,1]
  v_pk_mul_f32 v[46:47], v[46:47], v[86:87] op_sel:[0,1] op_sel_hi:[1,1]
  v_pk_mul_f32 v[192:193], v[44:45], v[44:45]
  v_pk_mul_f32 v[194:195], v[46:47], v[46:47]
  v_pk_fma_f32 v[192:193], v[192:193], s[28:29], s[28:29] op_sel:[0,1,0] op_sel_hi:[1,1,0]
  v_pk_fma_f32 v[194:195], v[194:195], s[28:29], s[28:29] op_sel:[0,1,0] op_sel_hi:[1,1,0]
  v_pk_mul_f32 v[192:193], v[192:193], v[44:45]
  v_pk_mul_f32 v[194:195], v[194:195], v[46:47]
  v_exp_f32 v192, v192
  v_exp_f32 v193, v193
  v_exp_f32 v194, v194
  v_exp_f32 v195, v195
  v_pk_add_f32 v[192:193], v[192:193], 1.0 op_sel_hi:[1,0]
  v_pk_add_f32 v[194:195], v[194:195], 1.0 op_sel_hi:[1,0]
  v_rcp_f32 v192, v192
  v_rcp_f32 v193, v193
  v_rcp_f32 v194, v194
  v_rcp_f32 v195, v195
  v_pk_mul_f32 v[44:45], v[192:193], v[44:45]
  v_pk_mul_f32 v[46:47], v[194:195], v[46:47]
  v_cvt_pk_bf16_f32 v162, v44, v45
  v_cvt_pk_bf16_f32 v163, v46, v47
  v_cmp_lt_i32 vcc, 64, v198
  s_nop 1
  v_permlane16_swap_b32 v160, v162
  v_permlane16_swap_b32 v161, v163
  v_cndmask_b32 v200, v201, v196, vcc
  s_cmp_lg_u32 s25, 0
  s_cbranch_scc1 .dp_70
  buffer_store_dwordx4 v[160:163], v200, s[4:7], s32 offen offset:64 sc1
  s_branch .de_71
.dp_70:
  buffer_store_dwordx4 v[160:163], v200, s[4:7], s32 offen offset:64
.de_71:
  v_pk_fma_f32 v[48:49], v[116:117], v[86:87], v[48:49] op_sel_hi:[1,0,1]
  v_pk_fma_f32 v[50:51], v[118:119], v[86:87], v[50:51] op_sel_hi:[1,0,1]
  v_pk_mul_f32 v[48:49], v[48:49], v[86:87] op_sel:[0,1] op_sel_hi:[1,1]
  v_pk_mul_f32 v[50:51], v[50:51], v[86:87] op_sel:[0,1] op_sel_hi:[1,1]
  v_pk_mul_f32 v[188:189], v[48:49], v[48:49]
  v_pk_mul_f32 v[190:191], v[50:51], v[50:51]
  v_pk_fma_f32 v[188:189], v[188:189], s[28:29], s[28:29] op_sel:[0,1,0] op_sel_hi:[1,1,0]
  v_pk_fma_f32 v[190:191], v[190:191], s[28:29], s[28:29] op_sel:[0,1,0] op_sel_hi:[1,1,0]
  v_pk_mul_f32 v[188:189], v[188:189], v[48:49]
  v_pk_mul_f32 v[190:191], v[190:191], v[50:51]
  v_exp_f32 v188, v188
  v_exp_f32 v189, v189
  v_exp_f32 v190, v190
  v_exp_f32 v191, v191
  v_pk_add_f32 v[188:189], v[188:189], 1.0 op_sel_hi:[1,0]
  v_pk_add_f32 v[190:191], v[190:191], 1.0 op_sel_hi:[1,0]
  v_rcp_f32 v188, v188
  v_rcp_f32 v189, v189
  v_rcp_f32 v190, v190
  v_rcp_f32 v191, v191
  v_pk_mul_f32 v[48:49], v[188:189], v[48:49]
  v_pk_mul_f32 v[50:51], v[190:191], v[50:51]
  v_cvt_pk_bf16_f32 v164, v48, v49
  v_cvt_pk_bf16_f32 v165, v50, v51
  v_pk_fma_f32 v[52:53], v[120:121], v[86:87], v[52:53] op_sel_hi:[1,0,1]
  v_pk_fma_f32 v[54:55], v[122:123], v[86:87], v[54:55] op_sel_hi:[1,0,1]
  v_pk_mul_f32 v[52:53], v[52:53], v[86:87] op_sel:[0,1] op_sel_hi:[1,1]
  v_pk_mul_f32 v[54:55], v[54:55], v[86:87] op_sel:[0,1] op_sel_hi:[1,1]
  v_pk_mul_f32 v[192:193], v[52:53], v[52:53]
  v_pk_mul_f32 v[194:195], v[54:55], v[54:55]
  v_pk_fma_f32 v[192:193], v[192:193], s[28:29], s[28:29] op_sel:[0,1,0] op_sel_hi:[1,1,0]
  v_pk_fma_f32 v[194:195], v[194:195], s[28:29], s[28:29] op_sel:[0,1,0] op_sel_hi:[1,1,0]
  v_pk_mul_f32 v[192:193], v[192:193], v[52:53]
  v_pk_mul_f32 v[194:195], v[194:195], v[54:55]
  v_exp_f32 v192, v192
  v_exp_f32 v193, v193
  v_exp_f32 v194, v194
  v_exp_f32 v195, v195
  v_pk_add_f32 v[192:193], v[192:193], 1.0 op_sel_hi:[1,0]
  v_pk_add_f32 v[194:195], v[194:195], 1.0 op_sel_hi:[1,0]
  v_rcp_f32 v192, v192
  v_rcp_f32 v193, v193
  v_rcp_f32 v194, v194
  v_rcp_f32 v195, v195
  v_pk_mul_f32 v[52:53], v[192:193], v[52:53]
  v_pk_mul_f32 v[54:55], v[194:195], v[54:55]
  v_cvt_pk_bf16_f32 v166, v52, v53
  v_cvt_pk_bf16_f32 v167, v54, v55
  v_cmp_lt_i32 vcc, 128, v198
  s_nop 1
  v_permlane16_swap_b32 v164, v166
  v_permlane16_swap_b32 v165, v167
  v_cndmask_b32 v200, v201, v196, vcc
  s_cmp_lg_u32 s25, 0
  s_cbranch_scc1 .dp_72
  buffer_store_dwordx4 v[164:167], v200, s[4:7], s32 offen offset:128 sc1
  s_branch .de_73
.dp_72:
  buffer_store_dwordx4 v[164:167], v200, s[4:7], s32 offen offset:128
.de_73:
  v_pk_fma_f32 v[56:57], v[124:125], v[86:87], v[56:57] op_sel_hi:[1,0,1]
  v_pk_fma_f32 v[58:59], v[126:127], v[86:87], v[58:59] op_sel_hi:[1,0,1]
  v_pk_mul_f32 v[56:57], v[56:57], v[86:87] op_sel:[0,1] op_sel_hi:[1,1]
  v_pk_mul_f32 v[58:59], v[58:59], v[86:87] op_sel:[0,1] op_sel_hi:[1,1]
  v_pk_mul_f32 v[188:189], v[56:57], v[56:57]
  v_pk_mul_f32 v[190:191], v[58:59], v[58:59]
  v_pk_fma_f32 v[188:189], v[188:189], s[28:29], s[28:29] op_sel:[0,1,0] op_sel_hi:[1,1,0]
  v_pk_fma_f32 v[190:191], v[190:191], s[28:29], s[28:29] op_sel:[0,1,0] op_sel_hi:[1,1,0]
  v_pk_mul_f32 v[188:189], v[188:189], v[56:57]
  v_pk_mul_f32 v[190:191], v[190:191], v[58:59]
  v_exp_f32 v188, v188
  v_exp_f32 v189, v189
  v_exp_f32 v190, v190
  v_exp_f32 v191, v191
  v_pk_add_f32 v[188:189], v[188:189], 1.0 op_sel_hi:[1,0]
  v_pk_add_f32 v[190:191], v[190:191], 1.0 op_sel_hi:[1,0]
  v_rcp_f32 v188, v188
  v_rcp_f32 v189, v189
  v_rcp_f32 v190, v190
  v_rcp_f32 v191, v191
  v_pk_mul_f32 v[56:57], v[188:189], v[56:57]
  v_pk_mul_f32 v[58:59], v[190:191], v[58:59]
  v_cvt_pk_bf16_f32 v168, v56, v57
  v_cvt_pk_bf16_f32 v169, v58, v59
  v_cmp_lt_i32 vcc, 192, v199
  s_nop 1
  v_cndmask_b32 v200, v201, v197, vcc
  s_cmp_lg_u32 s25, 0
  s_cbranch_scc1 .dp_74
  buffer_store_dwordx2 v[168:169], v200, s[4:7], s32 offen offset:192 sc1
  s_branch .de_75
.dp_74:
  buffer_store_dwordx2 v[168:169], v200, s[4:7], s32 offen offset:192
.de_75:
  v_mul_u32_u24 v184, 160, v208
  v_add_u32 v184, v184, v209
  v_add_u32 v185, 73728, v184
  s_lshl_b32 s30, s21, 11
  s_add_u32 s30, s30, 20480
  v_add_u32 v180, s30, v211
  v_xor_b32 v182, 64, v180
  v_add_u32 v181, 73728, v180
  v_add_u32 v183, 73728, v182
  v_lshlrev_b32 v192, 2, v204
  v_add_u32 v192, 0x1b08000, v192
  s_waitcnt vmcnt(0)
  v_mov_b32 v188, 162896
  v_mov_b32 v189, 1
  s_mov_b64 exec, 1
  ds_add_rtn_u32 v190, v188, v189
  s_mov_b64 exec, -1
  s_lshl_b32 s30, s24, 3
  s_add_u32 s30, s30, 0x1b60000
  s_waitcnt lgkmcnt(0)
  v_readfirstlane_b32 s31, v190
  v_mov_b32 v188, s30
  v_mov_b32 v190, s26
  v_mov_b32 v191, s27
  s_cmp_lg_u32 s31, 3
  s_cbranch_scc1 .sg_76
  s_mov_b64 exec, 1
  s_mov_b32 s30, 32768
  s_cmp_lg_u32 s25, 0
  s_cbranch_scc1 .dp_77
  buffer_store_dwordx2 v[190:191], v188, s[4:7], s30 offen sc1
  s_branch .de_78
.dp_77:
  buffer_store_dwordx2 v[190:191], v188, s[4:7], s30 offen
.de_78:
  s_mov_b64 exec, -1
.sg_76:
  buffer_load_dword v222, v192, s[4:7], 0 offen sc1
  s_barrier
  ds_read_b64_tr_b16 v[100:101], v184 offset:0
  ds_read_b64_tr_b16 v[102:103], v184 offset:1280
  ds_read_b128 v[84:87], v180 offset:0
  ds_read_b64_tr_b16 v[104:105], v184 offset:32
  ds_read_b64_tr_b16 v[106:107], v184 offset:1312
  ds_read_b64_tr_b16 v[108:109], v184 offset:64
  ds_read_b64_tr_b16 v[110:111], v184 offset:1344
  ds_read_b64_tr_b16 v[112:113], v184 offset:96
  ds_read_b64_tr_b16 v[114:115], v184 offset:1376
  ds_read_b64_tr_b16 v[116:117], v184 offset:128
  ds_read_b64_tr_b16 v[118:119], v184 offset:1408
  ds_read_b64_tr_b16 v[120:121], v184 offset:5120
  ds_read_b64_tr_b16 v[122:123], v184 offset:6400
  ds_read_b128 v[88:91], v182 offset:0
  ds_read_b64_tr_b16 v[124:125], v184 offset:5152
  ds_read_b64_tr_b16 v[126:127], v184 offset:6432
  ds_read_b64_tr_b16 v[128:129], v184 offset:5184
  ds_read_b64_tr_b16 v[130:131], v184 offset:6464
  ds_read_b64_tr_b16 v[132:133], v184 offset:5216
  ds_read_b64_tr_b16 v[134:135], v184 offset:6496
  ds_read_b64_tr_b16 v[136:137], v184 offset:5248
  ds_read_b64_tr_b16 v[138:139], v184 offset:6528
  s_waitcnt lgkmcnt(11)
  v_mfma_f32_16x16x32_bf16 v[224:227], v[100:103], v[84:87], 0
  ds_read_b64_tr_b16 v[140:141], v184 offset:10240
  ds_read_b64_tr_b16 v[142:143], v184 offset:11520
  ds_read_b128 v[92:95], v180 offset:8192
  v_mfma_f32_16x16x32_bf16 v[228:231], v[104:107], v[84:87], 0
  ds_read_b64_tr_b16 v[144:145], v184 offset:10272
  ds_read_b64_tr_b16 v[146:147], v184 offset:11552
  v_mfma_f32_16x16x32_bf16 v[232:235], v[108:111], v[84:87], 0
  ds_read_b64_tr_b16 v[148:149], v184 offset:10304
  ds_read_b64_tr_b16 v[150:151], v184 offset:11584
  v_mfma_f32_16x16x32_bf16 v[236:239], v[112:115], v[84:87], 0
  ds_read_b64_tr_b16 v[152:153], v184 offset:10336
  ds_read_b64_tr_b16 v[154:155], v184 offset:11616
  v_mfma_f32_16x16x32_bf16 v[240:243], v[116:119], v[84:87], 0
  ds_read_b64_tr_b16 v[156:157], v184 offset:10368
  ds_read_b64_tr_b16 v[158:159], v184 offset:11648
  s_waitcnt lgkmcnt(11)
  v_mfma_f32_16x16x32_bf16 v[224:227], v[120:123], v[88:91], v[224:227]
  ds_read_b64_tr_b16 v[100:101], v184 offset:15360
  ds_read_b64_tr_b16 v[102:103], v184 offset:16640
  ds_read_b128 v[84:87], v182 offset:8192
  v_mfma_f32_16x16x32_bf16 v[228:231], v[124:127], v[88:91], v[228:231]
  ds_read_b64_tr_b16 v[104:105], v184 offset:15392
  ds_read_b64_tr_b16 v[106:107], v184 offset:16672
  v_mfma_f32_16x16x32_bf16 v[232:235], v[128:131], v[88:91], v[232:235]
  ds_read_b64_tr_b16 v[108:109], v184 offset:15424
  ds_read_b64_tr_b16 v[110:111], v184 offset:16704
  v_mfma_f32_16x16x32_bf16 v[236:239], v[132:135], v[88:91], v[236:239]
  ds_read_b64_tr_b16 v[112:113], v184 offset:15456
  ds_read_b64_tr_b16 v[114:115], v184 offset:16736
  v_mfma_f32_16x16x32_bf16 v[240:243], v[136:139], v[88:91], v[240:243]
  ds_read_b64_tr_b16 v[116:117], v184 offset:15488
  ds_read_b64_tr_b16 v[118:119], v184 offset:16768
  s_waitcnt lgkmcnt(11)
  s_barrier
  v_mfma_f32_16x16x32_bf16 v[224:227], v[140:143], v[92:95], v[224:227]
  ds_read_b64_tr_b16 v[120:121], v184 offset:36864
  ds_read_b64_tr_b16 v[122:123], v184 offset:38144
  ds_read_b128 v[88:91], v180 offset:36864
  v_mfma_f32_16x16x32_bf16 v[228:231], v[144:147], v[92:95], v[228:231]
  ds_read_b64_tr_b16 v[124:125], v184 offset:36896
  ds_read_b64_tr_b16 v[126:127], v184 offset:38176
  v_mfma_f32_16x16x32_bf16 v[232:235], v[148:151], v[92:95], v[232:235]
  ds_read_b64_tr_b16 v[128:129], v184 offset:36928
  ds_read_b64_tr_b16 v[130:131], v184 offset:38208
  v_mfma_f32_16x16x32_bf16 v[236:239], v[152:155], v[92:95], v[236:239]
  ds_read_b64_tr_b16 v[132:133], v184 offset:36960
  ds_read_b64_tr_b16 v[134:135], v184 offset:38240
  v_mfma_f32_16x16x32_bf16 v[240:243], v[156:159], v[92:95], v[240:243]
  ds_read_b64_tr_b16 v[136:137], v184 offset:36992
  ds_read_b64_tr_b16 v[138:139], v184 offset:38272
  s_waitcnt lgkmcnt(11)
  v_mfma_f32_16x16x32_bf16 v[224:227], v[100:103], v[84:87], v[224:227]
  ds_read_b64_tr_b16 v[140:141], v184 offset:41984
  ds_read_b64_tr_b16 v[142:143], v184 offset:43264
  ds_read_b128 v[92:95], v182 offset:36864
  v_mfma_f32_16x16x32_bf16 v[228:231], v[104:107], v[84:87], v[228:231]
  ds_read_b64_tr_b16 v[144:145], v184 offset:42016
  ds_read_b64_tr_b16 v[146:147], v184 offset:43296
  v_mfma_f32_16x16x32_bf16 v[232:235], v[108:111], v[84:87], v[232:235]
  ds_read_b64_tr_b16 v[148:149], v184 offset:42048
  ds_read_b64_tr_b16 v[150:151], v184 offset:43328
  v_mfma_f32_16x16x32_bf16 v[236:239], v[112:115], v[84:87], v[236:239]
  ds_read_b64_tr_b16 v[152:153], v184 offset:42080
  ds_read_b64_tr_b16 v[154:155], v184 offset:43360
  v_mfma_f32_16x16x32_bf16 v[240:243], v[116:119], v[84:87], v[240:243]
  ds_read_b64_tr_b16 v[156:157], v184 offset:42112
  ds_read_b64_tr_b16 v[158:159], v184 offset:43392
  s_waitcnt lgkmcnt(11)
  v_mfma_f32_16x16x32_bf16 v[224:227], v[120:123], v[88:91], v[224:227]
  ds_read_b64_tr_b16 v[100:101], v184 offset:47104
  ds_read_b64_tr_b16 v[102:103], v184 offset:48384
  ds_read_b128 v[84:87], v180 offset:45056
  v_mfma_f32_16x16x32_bf16 v[228:231], v[124:127], v[88:91], v[228:231]
  ds_read_b64_tr_b16 v[104:105], v184 offset:47136
  ds_read_b64_tr_b16 v[106:107], v184 offset:48416
  v_mfma_f32_16x16x32_bf16 v[232:235], v[128:131], v[88:91], v[232:235]
  ds_read_b64_tr_b16 v[108:109], v184 offset:47168
  ds_read_b64_tr_b16 v[110:111], v184 offset:48448
  v_mfma_f32_16x16x32_bf16 v[236:239], v[132:135], v[88:91], v[236:239]
  ds_read_b64_tr_b16 v[112:113], v184 offset:47200
  ds_read_b64_tr_b16 v[114:115], v184 offset:48480
  v_mfma_f32_16x16x32_bf16 v[240:243], v[136:139], v[88:91], v[240:243]
  ds_read_b64_tr_b16 v[116:117], v184 offset:47232
  ds_read_b64_tr_b16 v[118:119], v184 offset:48512
  s_waitcnt lgkmcnt(11)
  v_mfma_f32_16x16x32_bf16 v[224:227], v[140:143], v[92:95], v[224:227]
  ds_read_b64_tr_b16 v[120:121], v184 offset:52224
  ds_read_b64_tr_b16 v[122:123], v184 offset:53504
  ds_read_b128 v[88:91], v182 offset:45056
  v_mfma_f32_16x16x32_bf16 v[228:231], v[144:147], v[92:95], v[228:231]
  ds_read_b64_tr_b16 v[124:125], v184 offset:52256
  ds_read_b64_tr_b16 v[126:127], v184 offset:53536
  v_mfma_f32_16x16x32_bf16 v[232:235], v[148:151], v[92:95], v[232:235]
  ds_read_b64_tr_b16 v[128:129], v184 offset:52288
  ds_read_b64_tr_b16 v[130:131], v184 offset:53568
  v_mfma_f32_16x16x32_bf16 v[236:239], v[152:155], v[92:95], v[236:239]
  ds_read_b64_tr_b16 v[132:133], v184 offset:52320
  ds_read_b64_tr_b16 v[134:135], v184 offset:53600
  v_mfma_f32_16x16x32_bf16 v[240:243], v[156:159], v[92:95], v[240:243]
  ds_read_b64_tr_b16 v[136:137], v184 offset:52352
  ds_read_b64_tr_b16 v[138:139], v184 offset:53632
  s_waitcnt lgkmcnt(11)
  s_barrier
  v_mfma_f32_16x16x32_bf16 v[224:227], v[100:103], v[84:87], v[224:227]
  ds_read_b64_tr_b16 v[140:141], v185 offset:0
  ds_read_b64_tr_b16 v[142:143], v185 offset:1280
  ds_read_b128 v[92:95], v181 offset:0
  v_mfma_f32_16x16x32_bf16 v[228:231], v[104:107], v[84:87], v[228:231]
  ds_read_b64_tr_b16 v[144:145], v185 offset:32
  ds_read_b64_tr_b16 v[146:147], v185 offset:1312
  v_mfma_f32_16x16x32_bf16 v[232:235], v[108:111], v[84:87], v[232:235]
  ds_read_b64_tr_b16 v[148:149], v185 offset:64
  ds_read_b64_tr_b16 v[150:151], v185 offset:1344
  v_mfma_f32_16x16x32_bf16 v[236:239], v[112:115], v[84:87], v[236:239]
  ds_read_b64_tr_b16 v[152:153], v185 offset:96
  ds_read_b64_tr_b16 v[154:155], v185 offset:1376
  v_mfma_f32_16x16x32_bf16 v[240:243], v[116:119], v[84:87], v[240:243]
  ds_read_b64_tr_b16 v[156:157], v185 offset:128
  ds_read_b64_tr_b16 v[158:159], v185 offset:1408
  s_waitcnt lgkmcnt(11)
  v_mfma_f32_16x16x32_bf16 v[224:227], v[120:123], v[88:91], v[224:227]
  ds_read_b64_tr_b16 v[100:101], v185 offset:5120
  ds_read_b64_tr_b16 v[102:103], v185 offset:6400
  ds_read_b128 v[84:87], v183 offset:0
  v_mfma_f32_16x16x32_bf16 v[228:231], v[124:127], v[88:91], v[228:231]
  ds_read_b64_tr_b16 v[104:105], v185 offset:5152
  ds_read_b64_tr_b16 v[106:107], v185 offset:6432
  v_mfma_f32_16x16x32_bf16 v[232:235], v[128:131], v[88:91], v[232:235]
  ds_read_b64_tr_b16 v[108:109], v185 offset:5184
  ds_read_b64_tr_b16 v[110:111], v185 offset:6464
  v_mfma_f32_16x16x32_bf16 v[236:239], v[132:135], v[88:91], v[236:239]
  ds_read_b64_tr_b16 v[112:113], v185 offset:5216
  ds_read_b64_tr_b16 v[114:115], v185 offset:6496
  v_mfma_f32_16x16x32_bf16 v[240:243], v[136:139], v[88:91], v[240:243]
  ds_read_b64_tr_b16 v[116:117], v185 offset:5248
  ds_read_b64_tr_b16 v[118:119], v185 offset:6528
  s_waitcnt lgkmcnt(11)
  v_mfma_f32_16x16x32_bf16 v[224:227], v[140:143], v[92:95], v[224:227]
  ds_read_b64_tr_b16 v[120:121], v185 offset:10240
  ds_read_b64_tr_b16 v[122:123], v185 offset:11520
  ds_read_b128 v[88:91], v181 offset:8192
  v_mfma_f32_16x16x32_bf16 v[228:231], v[144:147], v[92:95], v[228:231]
  ds_read_b64_tr_b16 v[124:125], v185 offset:10272
  ds_read_b64_tr_b16 v[126:127], v185 offset:11552
  v_mfma_f32_16x16x32_bf16 v[232:235], v[148:151], v[92:95], v[232:235]
  ds_read_b64_tr_b16 v[128:129], v185 offset:10304
  ds_read_b64_tr_b16 v[130:131], v185 offset:11584
  v_mfma_f32_16x16x32_bf16 v[236:239], v[152:155], v[92:95], v[236:239]
  ds_read_b64_tr_b16 v[132:133], v185 offset:10336
  ds_read_b64_tr_b16 v[134:135], v185 offset:11616
  v_mfma_f32_16x16x32_bf16 v[240:243], v[156:159], v[92:95], v[240:243]
  ds_read_b64_tr_b16 v[136:137], v185 offset:10368
  ds_read_b64_tr_b16 v[138:139], v185 offset:11648
  s_waitcnt lgkmcnt(11)
  v_mfma_f32_16x16x32_bf16 v[224:227], v[100:103], v[84:87], v[224:227]
  ds_read_b64_tr_b16 v[140:141], v185 offset:15360
  ds_read_b64_tr_b16 v[142:143], v185 offset:16640
  ds_read_b128 v[92:95], v183 offset:8192
  v_mfma_f32_16x16x32_bf16 v[228:231], v[104:107], v[84:87], v[228:231]
  ds_read_b64_tr_b16 v[144:145], v185 offset:15392
  ds_read_b64_tr_b16 v[146:147], v185 offset:16672
  v_mfma_f32_16x16x32_bf16 v[232:235], v[108:111], v[84:87], v[232:235]
  ds_read_b64_tr_b16 v[148:149], v185 offset:15424
  ds_read_b64_tr_b16 v[150:151], v185 offset:16704
  v_mfma_f32_16x16x32_bf16 v[236:239], v[112:115], v[84:87], v[236:239]
  ds_read_b64_tr_b16 v[152:153], v185 offset:15456
  ds_read_b64_tr_b16 v[154:155], v185 offset:16736
  v_mfma_f32_16x16x32_bf16 v[240:243], v[116:119], v[84:87], v[240:243]
  ds_read_b64_tr_b16 v[156:157], v185 offset:15488
  ds_read_b64_tr_b16 v[158:159], v185 offset:16768
  s_waitcnt lgkmcnt(11)
  s_barrier
  v_mfma_f32_16x16x32_bf16 v[224:227], v[120:123], v[88:91], v[224:227]
  ds_read_b64_tr_b16 v[100:101], v185 offset:36864
  ds_read_b64_tr_b16 v[102:103], v185 offset:38144
  ds_read_b128 v[84:87], v181 offset:36864
  v_mfma_f32_16x16x32_bf16 v[228:231], v[124:127], v[88:91], v[228:231]
  ds_read_b64_tr_b16 v[104:105], v185 offset:36896
  ds_read_b64_tr_b16 v[106:107], v185 offset:38176
  v_mfma_f32_16x16x32_bf16 v[232:235], v[128:131], v[88:91], v[232:235]
  ds_read_b64_tr_b16 v[108:109], v185 offset:36928
  ds_read_b64_tr_b16 v[110:111], v185 offset:38208
  v_mfma_f32_16x16x32_bf16 v[236:239], v[132:135], v[88:91], v[236:239]
  ds_read_b64_tr_b16 v[112:113], v185 offset:36960
  ds_read_b64_tr_b16 v[114:115], v185 offset:38240
  v_mfma_f32_16x16x32_bf16 v[240:243], v[136:139], v[88:91], v[240:243]
  ds_read_b64_tr_b16 v[116:117], v185 offset:36992
  ds_read_b64_tr_b16 v[118:119], v185 offset:38272
  s_waitcnt lgkmcnt(11)
  v_mfma_f32_16x16x32_bf16 v[224:227], v[140:143], v[92:95], v[224:227]
  ds_read_b64_tr_b16 v[120:121], v185 offset:41984
  ds_read_b64_tr_b16 v[122:123], v185 offset:43264
  ds_read_b128 v[88:91], v183 offset:36864
  v_mfma_f32_16x16x32_bf16 v[228:231], v[144:147], v[92:95], v[228:231]
  ds_read_b64_tr_b16 v[124:125], v185 offset:42016
  ds_read_b64_tr_b16 v[126:127], v185 offset:43296
  v_mfma_f32_16x16x32_bf16 v[232:235], v[148:151], v[92:95], v[232:235]
  ds_read_b64_tr_b16 v[128:129], v185 offset:42048
  ds_read_b64_tr_b16 v[130:131], v185 offset:43328
  v_mfma_f32_16x16x32_bf16 v[236:239], v[152:155], v[92:95], v[236:239]
  ds_read_b64_tr_b16 v[132:133], v185 offset:42080
  ds_read_b64_tr_b16 v[134:135], v185 offset:43360
  v_mfma_f32_16x16x32_bf16 v[240:243], v[156:159], v[92:95], v[240:243]
  ds_read_b64_tr_b16 v[136:137], v185 offset:42112
  ds_read_b64_tr_b16 v[138:139], v185 offset:43392
  s_waitcnt lgkmcnt(11)
  v_mfma_f32_16x16x32_bf16 v[224:227], v[100:103], v[84:87], v[224:227]
  ds_read_b64_tr_b16 v[140:141], v185 offset:47104
  ds_read_b64_tr_b16 v[142:143], v185 offset:48384
  ds_read_b128 v[92:95], v181 offset:45056
  v_mfma_f32_16x16x32_bf16 v[228:231], v[104:107], v[84:87], v[228:231]
  ds_read_b64_tr_b16 v[144:145], v185 offset:47136
  ds_read_b64_tr_b16 v[146:147], v185 offset:48416
  v_mfma_f32_16x16x32_bf16 v[232:235], v[108:111], v[84:87], v[232:235]
  ds_read_b64_tr_b16 v[148:149], v185 offset:47168
  ds_read_b64_tr_b16 v[150:151], v185 offset:48448
  v_mfma_f32_16x16x32_bf16 v[236:239], v[112:115], v[84:87], v[236:239]
  ds_read_b64_tr_b16 v[152:153], v185 offset:47200
  ds_read_b64_tr_b16 v[154:155], v185 offset:48480
  v_mfma_f32_16x16x32_bf16 v[240:243], v[116:119], v[84:87], v[240:243]
  ds_read_b64_tr_b16 v[156:157], v185 offset:47232
  ds_read_b64_tr_b16 v[158:159], v185 offset:48512
  s_waitcnt lgkmcnt(11)
  v_mfma_f32_16x16x32_bf16 v[224:227], v[120:123], v[88:91], v[224:227]
  ds_read_b64_tr_b16 v[100:101], v185 offset:52224
  ds_read_b64_tr_b16 v[102:103], v185 offset:53504
  ds_read_b128 v[84:87], v183 offset:45056
  v_mfma_f32_16x16x32_bf16 v[228:231], v[124:127], v[88:91], v[228:231]
  ds_read_b64_tr_b16 v[104:105], v185 offset:52256
  ds_read_b64_tr_b16 v[106:107], v185 offset:53536
  v_mfma_f32_16x16x32_bf16 v[232:235], v[128:131], v[88:91], v[232:235]
  ds_read_b64_tr_b16 v[108:109], v185 offset:52288
  ds_read_b64_tr_b16 v[110:111], v185 offset:53568
  v_mfma_f32_16x16x32_bf16 v[236:239], v[132:135], v[88:91], v[236:239]
  ds_read_b64_tr_b16 v[112:113], v185 offset:52320
  ds_read_b64_tr_b16 v[114:115], v185 offset:53600
  v_mfma_f32_16x16x32_bf16 v[240:243], v[136:139], v[88:91], v[240:243]
  ds_read_b64_tr_b16 v[116:117], v185 offset:52352
  ds_read_b64_tr_b16 v[118:119], v185 offset:53632
  s_waitcnt lgkmcnt(11)
  s_barrier
  v_mfma_f32_16x16x32_bf16 v[224:227], v[140:143], v[92:95], v[224:227]
  ds_read_b64_tr_b16 v[120:121], v184 offset:0
  ds_read_b64_tr_b16 v[122:123], v184 offset:1280
  ds_read_b128 v[88:91], v180 offset:0
  v_mfma_f32_16x16x32_bf16 v[228:231], v[144:147], v[92:95], v[228:231]
  ds_read_b64_tr_b16 v[124:125], v184 offset:32
  ds_read_b64_tr_b16 v[126:127], v184 offset:1312
  v_mfma_f32_16x16x32_bf16 v[232:235], v[148:151], v[92:95], v[232:235]
  ds_read_b64_tr_b16 v[128:129], v184 offset:64
  ds_read_b64_tr_b16 v[130:131], v184 offset:1344
  v_mfma_f32_16x16x32_bf16 v[236:239], v[152:155], v[92:95], v[236:239]
  ds_read_b64_tr_b16 v[132:133], v184 offset:96
  ds_read_b64_tr_b16 v[134:135], v184 offset:1376
  v_mfma_f32_16x16x32_bf16 v[240:243], v[156:159], v[92:95], v[240:243]
  ds_read_b64_tr_b16 v[136:137], v184 offset:128
  ds_read_b64_tr_b16 v[138:139], v184 offset:1408
  s_waitcnt lgkmcnt(11)
  v_mfma_f32_16x16x32_bf16 v[224:227], v[100:103], v[84:87], v[224:227]
  ds_read_b64_tr_b16 v[140:141], v184 offset:5120
  ds_read_b64_tr_b16 v[142:143], v184 offset:6400
  ds_read_b128 v[92:95], v182 offset:0
  v_mfma_f32_16x16x32_bf16 v[228:231], v[104:107], v[84:87], v[228:231]
  ds_read_b64_tr_b16 v[144:145], v184 offset:5152
  ds_read_b64_tr_b16 v[146:147], v184 offset:6432
  v_mfma_f32_16x16x32_bf16 v[232:235], v[108:111], v[84:87], v[232:235]
  ds_read_b64_tr_b16 v[148:149], v184 offset:5184
  ds_read_b64_tr_b16 v[150:151], v184 offset:6464
  v_mfma_f32_16x16x32_bf16 v[236:239], v[112:115], v[84:87], v[236:239]
  ds_read_b64_tr_b16 v[152:153], v184 offset:5216
  ds_read_b64_tr_b16 v[154:155], v184 offset:6496
  v_mfma_f32_16x16x32_bf16 v[240:243], v[116:119], v[84:87], v[240:243]
  ds_read_b64_tr_b16 v[156:157], v184 offset:5248
  ds_read_b64_tr_b16 v[158:159], v184 offset:6528
  s_waitcnt lgkmcnt(11)
  v_mfma_f32_16x16x32_bf16 v[224:227], v[120:123], v[88:91], v[224:227]
  ds_read_b64_tr_b16 v[100:101], v184 offset:10240
  ds_read_b64_tr_b16 v[102:103], v184 offset:11520
  ds_read_b128 v[84:87], v180 offset:8192
  v_mfma_f32_16x16x32_bf16 v[228:231], v[124:127], v[88:91], v[228:231]
  ds_read_b64_tr_b16 v[104:105], v184 offset:10272
  ds_read_b64_tr_b16 v[106:107], v184 offset:11552
  v_mfma_f32_16x16x32_bf16 v[232:235], v[128:131], v[88:91], v[232:235]
  ds_read_b64_tr_b16 v[108:109], v184 offset:10304
  ds_read_b64_tr_b16 v[110:111], v184 offset:11584
  v_mfma_f32_16x16x32_bf16 v[236:239], v[132:135], v[88:91], v[236:239]
  ds_read_b64_tr_b16 v[112:113], v184 offset:10336
  ds_read_b64_tr_b16 v[114:115], v184 offset:11616
  v_mfma_f32_16x16x32_bf16 v[240:243], v[136:139], v[88:91], v[240:243]
  ds_read_b64_tr_b16 v[116:117], v184 offset:10368
  ds_read_b64_tr_b16 v[118:119], v184 offset:11648
  s_waitcnt lgkmcnt(11)
  v_mfma_f32_16x16x32_bf16 v[224:227], v[140:143], v[92:95], v[224:227]
  ds_read_b64_tr_b16 v[120:121], v184 offset:15360
  ds_read_b64_tr_b16 v[122:123], v184 offset:16640
  ds_read_b128 v[88:91], v182 offset:8192
  v_mfma_f32_16x16x32_bf16 v[228:231], v[144:147], v[92:95], v[228:231]
  ds_read_b64_tr_b16 v[124:125], v184 offset:15392
  ds_read_b64_tr_b16 v[126:127], v184 offset:16672
  v_mfma_f32_16x16x32_bf16 v[232:235], v[148:151], v[92:95], v[232:235]
  ds_read_b64_tr_b16 v[128:129], v184 offset:15424
  ds_read_b64_tr_b16 v[130:131], v184 offset:16704
  v_mfma_f32_16x16x32_bf16 v[236:239], v[152:155], v[92:95], v[236:239]
  ds_read_b64_tr_b16 v[132:133], v184 offset:15456
  ds_read_b64_tr_b16 v[134:135], v184 offset:16736
  v_mfma_f32_16x16x32_bf16 v[240:243], v[156:159], v[92:95], v[240:243]
  ds_read_b64_tr_b16 v[136:137], v184 offset:15488
  ds_read_b64_tr_b16 v[138:139], v184 offset:16768
  s_waitcnt lgkmcnt(11)
  s_barrier
  v_mfma_f32_16x16x32_bf16 v[224:227], v[100:103], v[84:87], v[224:227]
  ds_read_b64_tr_b16 v[140:141], v184 offset:36864
  ds_read_b64_tr_b16 v[142:143], v184 offset:38144
  ds_read_b128 v[92:95], v180 offset:36864
  v_mfma_f32_16x16x32_bf16 v[228:231], v[104:107], v[84:87], v[228:231]
  ds_read_b64_tr_b16 v[144:145], v184 offset:36896
  ds_read_b64_tr_b16 v[146:147], v184 offset:38176
  v_mfma_f32_16x16x32_bf16 v[232:235], v[108:111], v[84:87], v[232:235]
  ds_read_b64_tr_b16 v[148:149], v184 offset:36928
  ds_read_b64_tr_b16 v[150:151], v184 offset:38208
  v_mfma_f32_16x16x32_bf16 v[236:239], v[112:115], v[84:87], v[236:239]
  ds_read_b64_tr_b16 v[152:153], v184 offset:36960
  ds_read_b64_tr_b16 v[154:155], v184 offset:38240
  v_mfma_f32_16x16x32_bf16 v[240:243], v[116:119], v[84:87], v[240:243]
  ds_read_b64_tr_b16 v[156:157], v184 offset:36992
  ds_read_b64_tr_b16 v[158:159], v184 offset:38272
  s_waitcnt lgkmcnt(11)
  v_mfma_f32_16x16x32_bf16 v[224:227], v[120:123], v[88:91], v[224:227]
  ds_read_b64_tr_b16 v[100:101], v184 offset:41984
  ds_read_b64_tr_b16 v[102:103], v184 offset:43264
  ds_read_b128 v[84:87], v182 offset:36864
  v_mfma_f32_16x16x32_bf16 v[228:231], v[124:127], v[88:91], v[228:231]
  ds_read_b64_tr_b16 v[104:105], v184 offset:42016
  ds_read_b64_tr_b16 v[106:107], v184 offset:43296
  v_mfma_f32_16x16x32_bf16 v[232:235], v[128:131], v[88:91], v[232:235]
  ds_read_b64_tr_b16 v[108:109], v184 offset:42048
  ds_read_b64_tr_b16 v[110:111], v184 offset:43328
  v_mfma_f32_16x16x32_bf16 v[236:239], v[132:135], v[88:91], v[236:239]
  ds_read_b64_tr_b16 v[112:113], v184 offset:42080
  ds_read_b64_tr_b16 v[114:115], v184 offset:43360
  v_mfma_f32_16x16x32_bf16 v[240:243], v[136:139], v[88:91], v[240:243]
  ds_read_b64_tr_b16 v[116:117], v184 offset:42112
  ds_read_b64_tr_b16 v[118:119], v184 offset:43392
  s_waitcnt lgkmcnt(11)
  v_mfma_f32_16x16x32_bf16 v[160:163], v[140:143], v[92:95], 0
  ds_read_b64_tr_b16 v[120:121], v184 offset:47104
  ds_read_b64_tr_b16 v[122:123], v184 offset:48384
  ds_read_b128 v[88:91], v180 offset:45056
  v_mfma_f32_16x16x32_bf16 v[164:167], v[144:147], v[92:95], 0
  ds_read_b64_tr_b16 v[124:125], v184 offset:47136
  ds_read_b64_tr_b16 v[126:127], v184 offset:48416
  v_mfma_f32_16x16x32_bf16 v[168:171], v[148:151], v[92:95], 0
  ds_read_b64_tr_b16 v[128:129], v184 offset:47168
  ds_read_b64_tr_b16 v[130:131], v184 offset:48448
  v_mfma_f32_16x16x32_bf16 v[172:175], v[152:155], v[92:95], 0
  ds_read_b64_tr_b16 v[132:133], v184 offset:47200
  ds_read_b64_tr_b16 v[134:135], v184 offset:48480
  v_mfma_f32_16x16x32_bf16 v[176:179], v[156:159], v[92:95], 0
  ds_read_b64_tr_b16 v[136:137], v184 offset:47232
  ds_read_b64_tr_b16 v[138:139], v184 offset:48512
  s_waitcnt lgkmcnt(11)
  v_mfma_f32_16x16x32_bf16 v[160:163], v[100:103], v[84:87], v[160:163]
  ds_read_b64_tr_b16 v[140:141], v184 offset:52224
  ds_read_b64_tr_b16 v[142:143], v184 offset:53504
  ds_read_b128 v[92:95], v182 offset:45056
  v_mfma_f32_16x16x32_bf16 v[164:167], v[104:107], v[84:87], v[164:167]
  ds_read_b64_tr_b16 v[144:145], v184 offset:52256
  ds_read_b64_tr_b16 v[146:147], v184 offset:53536
  v_mfma_f32_16x16x32_bf16 v[168:171], v[108:111], v[84:87], v[168:171]
  ds_read_b64_tr_b16 v[148:149], v184 offset:52288
  ds_read_b64_tr_b16 v[150:151], v184 offset:53568
  v_mfma_f32_16x16x32_bf16 v[172:175], v[112:115], v[84:87], v[172:175]
  ds_read_b64_tr_b16 v[152:153], v184 offset:52320
  ds_read_b64_tr_b16 v[154:155], v184 offset:53600
  v_mfma_f32_16x16x32_bf16 v[176:179], v[116:119], v[84:87], v[176:179]
  ds_read_b64_tr_b16 v[156:157], v184 offset:52352
  ds_read_b64_tr_b16 v[158:159], v184 offset:53632
  s_waitcnt lgkmcnt(11)
  s_barrier
  v_mfma_f32_16x16x32_bf16 v[160:163], v[120:123], v[88:91], v[160:163]
  ds_read_b64_tr_b16 v[100:101], v185 offset:0
  ds_read_b64_tr_b16 v[102:103], v185 offset:1280
  ds_read_b128 v[84:87], v181 offset:0
  v_mfma_f32_16x16x32_bf16 v[164:167], v[124:127], v[88:91], v[164:167]
  ds_read_b64_tr_b16 v[104:105], v185 offset:32
  ds_read_b64_tr_b16 v[106:107], v185 offset:1312
  v_mfma_f32_16x16x32_bf16 v[168:171], v[128:131], v[88:91], v[168:171]
  ds_read_b64_tr_b16 v[108:109], v185 offset:64
  ds_read_b64_tr_b16 v[110:111], v185 offset:1344
  v_mfma_f32_16x16x32_bf16 v[172:175], v[132:135], v[88:91], v[172:175]
  ds_read_b64_tr_b16 v[112:113], v185 offset:96
  ds_read_b64_tr_b16 v[114:115], v185 offset:1376
  v_mfma_f32_16x16x32_bf16 v[176:179], v[136:139], v[88:91], v[176:179]
  ds_read_b64_tr_b16 v[116:117], v185 offset:128
  ds_read_b64_tr_b16 v[118:119], v185 offset:1408
  s_waitcnt lgkmcnt(11)
  v_mfma_f32_16x16x32_bf16 v[160:163], v[140:143], v[92:95], v[160:163]
  ds_read_b64_tr_b16 v[120:121], v185 offset:5120
  ds_read_b64_tr_b16 v[122:123], v185 offset:6400
  ds_read_b128 v[88:91], v183 offset:0
  v_mfma_f32_16x16x32_bf16 v[164:167], v[144:147], v[92:95], v[164:167]
  ds_read_b64_tr_b16 v[124:125], v185 offset:5152
  ds_read_b64_tr_b16 v[126:127], v185 offset:6432
  v_mfma_f32_16x16x32_bf16 v[168:171], v[148:151], v[92:95], v[168:171]
  ds_read_b64_tr_b16 v[128:129], v185 offset:5184
  ds_read_b64_tr_b16 v[130:131], v185 offset:6464
  v_mfma_f32_16x16x32_bf16 v[172:175], v[152:155], v[92:95], v[172:175]
  ds_read_b64_tr_b16 v[132:133], v185 offset:5216
  ds_read_b64_tr_b16 v[134:135], v185 offset:6496
  v_mfma_f32_16x16x32_bf16 v[176:179], v[156:159], v[92:95], v[176:179]
  ds_read_b64_tr_b16 v[136:137], v185 offset:5248
  ds_read_b64_tr_b16 v[138:139], v185 offset:6528
  s_waitcnt lgkmcnt(11)
  s_waitcnt vmcnt(0)
  v_sub_f32 v223, 1.0, v222
  v_cvt_pk_bf16_f32 v188, v223, v223
  v_lshlrev_b32 v223, 16, v188
  v_mfma_f32_16x16x32_bf16 v[160:163], v[100:103], v[84:87], v[160:163]
  ds_read_b64_tr_b16 v[140:141], v185 offset:10240
  ds_read_b64_tr_b16 v[142:143], v185 offset:11520
  ds_read_b128 v[92:95], v181 offset:8192
  v_mfma_f32_16x16x32_bf16 v[164:167], v[104:107], v[84:87], v[164:167]
  ds_read_b64_tr_b16 v[144:145], v185 offset:10272
  ds_read_b64_tr_b16 v[146:147], v185 offset:11552
  v_mfma_f32_16x16x32_bf16 v[168:171], v[108:111], v[84:87], v[168:171]
  ds_read_b64_tr_b16 v[148:149], v185 offset:10304
  ds_read_b64_tr_b16 v[150:151], v185 offset:11584
  v_mfma_f32_16x16x32_bf16 v[172:175], v[112:115], v[84:87], v[172:175]
  ds_read_b64_tr_b16 v[152:153], v185 offset:10336
  ds_read_b64_tr_b16 v[154:155], v185 offset:11616
  v_mfma_f32_16x16x32_bf16 v[176:179], v[116:119], v[84:87], v[176:179]
  ds_read_b64_tr_b16 v[156:157], v185 offset:10368
  ds_read_b64_tr_b16 v[158:159], v185 offset:11648
  s_waitcnt lgkmcnt(11)
  v_mfma_f32_16x16x32_bf16 v[160:163], v[120:123], v[88:91], v[160:163]
  ds_read_b64_tr_b16 v[100:101], v185 offset:15360
  ds_read_b64_tr_b16 v[102:103], v185 offset:16640
  ds_read_b128 v[84:87], v183 offset:8192
  v_mfma_f32_16x16x32_bf16 v[164:167], v[124:127], v[88:91], v[164:167]
  ds_read_b64_tr_b16 v[104:105], v185 offset:15392
  ds_read_b64_tr_b16 v[106:107], v185 offset:16672
  v_mfma_f32_16x16x32_bf16 v[168:171], v[128:131], v[88:91], v[168:171]
  ds_read_b64_tr_b16 v[108:109], v185 offset:15424
  ds_read_b64_tr_b16 v[110:111], v185 offset:16704
  v_mfma_f32_16x16x32_bf16 v[172:175], v[132:135], v[88:91], v[172:175]
  ds_read_b64_tr_b16 v[112:113], v185 offset:15456
  ds_read_b64_tr_b16 v[114:115], v185 offset:16736
  v_mfma_f32_16x16x32_bf16 v[176:179], v[136:139], v[88:91], v[176:179]
  ds_read_b64_tr_b16 v[116:117], v185 offset:15488
  ds_read_b64_tr_b16 v[118:119], v185 offset:16768
  s_waitcnt lgkmcnt(11)
  v_cvt_pk_bf16_f32 v188, v224, v225
  v_lshlrev_b32 v224, 16, v188
  v_and_b32 v225, 0xffff0000, v188
  v_cvt_pk_bf16_f32 v188, v226, v227
  v_lshlrev_b32 v226, 16, v188
  v_and_b32 v227, 0xffff0000, v188
  v_mul_f32 v224, v224, v222
  v_mul_f32 v225, v225, v222
  v_mul_f32 v226, v226, v222
  v_mul_f32 v227, v227, v222
  v_cvt_pk_bf16_f32 v188, v224, v225
  v_lshlrev_b32 v224, 16, v188
  v_and_b32 v225, 0xffff0000, v188
  v_cvt_pk_bf16_f32 v188, v226, v227
  v_lshlrev_b32 v226, 16, v188
  v_and_b32 v227, 0xffff0000, v188
  v_lshlrev_b32 v4, 16, v212
  v_and_b32 v5, 0xffff0000, v212
  v_lshlrev_b32 v6, 16, v213
  v_and_b32 v7, 0xffff0000, v213
  s_barrier
  v_mfma_f32_16x16x32_bf16 v[160:163], v[140:143], v[92:95], v[160:163]
  ds_read_b64_tr_b16 v[120:121], v185 offset:36864
  ds_read_b64_tr_b16 v[122:123], v185 offset:38144
  ds_read_b128 v[88:91], v181 offset:36864
  v_mfma_f32_16x16x32_bf16 v[164:167], v[144:147], v[92:95], v[164:167]
  ds_read_b64_tr_b16 v[124:125], v185 offset:36896
  ds_read_b64_tr_b16 v[126:127], v185 offset:38176
  v_mfma_f32_16x16x32_bf16 v[168:171], v[148:151], v[92:95], v[168:171]
  ds_read_b64_tr_b16 v[128:129], v185 offset:36928
  ds_read_b64_tr_b16 v[130:131], v185 offset:38208
  v_mfma_f32_16x16x32_bf16 v[172:175], v[152:155], v[92:95], v[172:175]
  ds_read_b64_tr_b16 v[132:133], v185 offset:36960
  ds_read_b64_tr_b16 v[134:135], v185 offset:38240
  v_mfma_f32_16x16x32_bf16 v[176:179], v[156:159], v[92:95], v[176:179]
  ds_read_b64_tr_b16 v[136:137], v185 offset:36992
  ds_read_b64_tr_b16 v[138:139], v185 offset:38272
  s_waitcnt lgkmcnt(11)
  v_mfma_f32_16x16x32_bf16 v[160:163], v[100:103], v[84:87], v[160:163]
  ds_read_b64_tr_b16 v[140:141], v185 offset:41984
  ds_read_b64_tr_b16 v[142:143], v185 offset:43264
  ds_read_b128 v[92:95], v183 offset:36864
  v_mfma_f32_16x16x32_bf16 v[164:167], v[104:107], v[84:87], v[164:167]
  ds_read_b64_tr_b16 v[144:145], v185 offset:42016
  ds_read_b64_tr_b16 v[146:147], v185 offset:43296
  v_mfma_f32_16x16x32_bf16 v[168:171], v[108:111], v[84:87], v[168:171]
  ds_read_b64_tr_b16 v[148:149], v185 offset:42048
  ds_read_b64_tr_b16 v[150:151], v185 offset:43328
  v_mfma_f32_16x16x32_bf16 v[172:175], v[112:115], v[84:87], v[172:175]
  ds_read_b64_tr_b16 v[152:153], v185 offset:42080
  ds_read_b64_tr_b16 v[154:155], v185 offset:43360
  v_mfma_f32_16x16x32_bf16 v[176:179], v[116:119], v[84:87], v[176:179]
  ds_read_b64_tr_b16 v[156:157], v185 offset:42112
  ds_read_b64_tr_b16 v[158:159], v185 offset:43392
  s_waitcnt lgkmcnt(11)
  v_cvt_pk_bf16_f32 v188, v228, v229
  v_lshlrev_b32 v228, 16, v188
  v_and_b32 v229, 0xffff0000, v188
  v_cvt_pk_bf16_f32 v188, v230, v231
  v_lshlrev_b32 v230, 16, v188
  v_and_b32 v231, 0xffff0000, v188
  v_mul_f32 v228, v228, v222
  v_mul_f32 v229, v229, v222
  v_mul_f32 v230, v230, v222
  v_mul_f32 v231, v231, v222
  v_cvt_pk_bf16_f32 v188, v228, v229
  v_lshlrev_b32 v228, 16, v188
  v_and_b32 v229, 0xffff0000, v188
  v_cvt_pk_bf16_f32 v188, v230, v231
  v_lshlrev_b32 v230, 16, v188
  v_and_b32 v231, 0xffff0000, v188
  v_lshlrev_b32 v8, 16, v214
  v_and_b32 v9, 0xffff0000, v214
  v_lshlrev_b32 v10, 16, v215
  v_and_b32 v11, 0xffff0000, v215
  v_mfma_f32_16x16x32_bf16 v[160:163], v[120:123], v[88:91], v[160:163]
  ds_read_b64_tr_b16 v[100:101], v185 offset:47104
  ds_read_b64_tr_b16 v[102:103], v185 offset:48384
  ds_read_b128 v[84:87], v181 offset:45056
  v_mfma_f32_16x16x32_bf16 v[164:167], v[124:127], v[88:91], v[164:167]
  ds_read_b64_tr_b16 v[104:105], v185 offset:47136
  ds_read_b64_tr_b16 v[106:107], v185 offset:48416
  v_mfma_f32_16x16x32_bf16 v[168:171], v[128:131], v[88:91], v[168:171]
  ds_read_b64_tr_b16 v[108:109], v185 offset:47168
  ds_read_b64_tr_b16 v[110:111], v185 offset:48448
  v_mfma_f32_16x16x32_bf16 v[172:175], v[132:135], v[88:91], v[172:175]
  ds_read_b64_tr_b16 v[112:113], v185 offset:47200
  ds_read_b64_tr_b16 v[114:115], v185 offset:48480
  v_mfma_f32_16x16x32_bf16 v[176:179], v[136:139], v[88:91], v[176:179]
  ds_read_b64_tr_b16 v[116:117], v185 offset:47232
  ds_read_b64_tr_b16 v[118:119], v185 offset:48512
  s_waitcnt lgkmcnt(11)
  v_mfma_f32_16x16x32_bf16 v[160:163], v[140:143], v[92:95], v[160:163]
  ds_read_b64_tr_b16 v[120:121], v185 offset:52224
  ds_read_b64_tr_b16 v[122:123], v185 offset:53504
  ds_read_b128 v[88:91], v183 offset:45056
  v_mfma_f32_16x16x32_bf16 v[164:167], v[144:147], v[92:95], v[164:167]
  ds_read_b64_tr_b16 v[124:125], v185 offset:52256
  ds_read_b64_tr_b16 v[126:127], v185 offset:53536
  v_mfma_f32_16x16x32_bf16 v[168:171], v[148:151], v[92:95], v[168:171]
  ds_read_b64_tr_b16 v[128:129], v185 offset:52288
  ds_read_b64_tr_b16 v[130:131], v185 offset:53568
  v_mfma_f32_16x16x32_bf16 v[172:175], v[152:155], v[92:95], v[172:175]
  ds_read_b64_tr_b16 v[132:133], v185 offset:52320
  ds_read_b64_tr_b16 v[134:135], v185 offset:53600
  v_mfma_f32_16x16x32_bf16 v[176:179], v[156:159], v[92:95], v[176:179]
  ds_read_b64_tr_b16 v[136:137], v185 offset:52352
  ds_read_b64_tr_b16 v[138:139], v185 offset:53632
  s_waitcnt lgkmcnt(11)
  v_cvt_pk_bf16_f32 v188, v232, v233
  v_lshlrev_b32 v232, 16, v188
  v_and_b32 v233, 0xffff0000, v188
  v_cvt_pk_bf16_f32 v188, v234, v235
  v_lshlrev_b32 v234, 16, v188
  v_and_b32 v235, 0xffff0000, v188
  v_mul_f32 v232, v232, v222
  v_mul_f32 v233, v233, v222
  v_mul_f32 v234, v234, v222
  v_mul_f32 v235, v235, v222
  v_cvt_pk_bf16_f32 v188, v232, v233
  v_lshlrev_b32 v232, 16, v188
  v_and_b32 v233, 0xffff0000, v188
  v_cvt_pk_bf16_f32 v188, v234, v235
  v_lshlrev_b32 v234, 16, v188
  v_and_b32 v235, 0xffff0000, v188
  v_lshlrev_b32 v12, 16, v216
  v_and_b32 v13, 0xffff0000, v216
  v_lshlrev_b32 v14, 16, v217
  v_and_b32 v15, 0xffff0000, v217
  s_barrier
  v_mfma_f32_16x16x32_bf16 v[160:163], v[100:103], v[84:87], v[160:163]
  ds_read_b64_tr_b16 v[140:141], v184 offset:0
  ds_read_b64_tr_b16 v[142:143], v184 offset:1280
  ds_read_b128 v[92:95], v180 offset:0
  v_mfma_f32_16x16x32_bf16 v[164:167], v[104:107], v[84:87], v[164:167]
  ds_read_b64_tr_b16 v[144:145], v184 offset:32
  ds_read_b64_tr_b16 v[146:147], v184 offset:1312
  v_mfma_f32_16x16x32_bf16 v[168:171], v[108:111], v[84:87], v[168:171]
  ds_read_b64_tr_b16 v[148:149], v184 offset:64
  ds_read_b64_tr_b16 v[150:151], v184 offset:1344
  v_mfma_f32_16x16x32_bf16 v[172:175], v[112:115], v[84:87], v[172:175]
  ds_read_b64_tr_b16 v[152:153], v184 offset:96
  ds_read_b64_tr_b16 v[154:155], v184 offset:1376
  v_mfma_f32_16x16x32_bf16 v[176:179], v[116:119], v[84:87], v[176:179]
  ds_read_b64_tr_b16 v[156:157], v184 offset:128
  ds_read_b64_tr_b16 v[158:159], v184 offset:1408
  s_waitcnt lgkmcnt(11)
  v_mfma_f32_16x16x32_bf16 v[160:163], v[120:123], v[88:91], v[160:163]
  ds_read_b64_tr_b16 v[100:101], v184 offset:5120
  ds_read_b64_tr_b16 v[102:103], v184 offset:6400
  ds_read_b128 v[84:87], v182 offset:0
  v_mfma_f32_16x16x32_bf16 v[164:167], v[124:127], v[88:91], v[164:167]
  ds_read_b64_tr_b16 v[104:105], v184 offset:5152
  ds_read_b64_tr_b16 v[106:107], v184 offset:6432
  v_mfma_f32_16x16x32_bf16 v[168:171], v[128:131], v[88:91], v[168:171]
  ds_read_b64_tr_b16 v[108:109], v184 offset:5184
  ds_read_b64_tr_b16 v[110:111], v184 offset:6464
  v_mfma_f32_16x16x32_bf16 v[172:175], v[132:135], v[88:91], v[172:175]
  ds_read_b64_tr_b16 v[112:113], v184 offset:5216
  ds_read_b64_tr_b16 v[114:115], v184 offset:6496
  v_mfma_f32_16x16x32_bf16 v[176:179], v[136:139], v[88:91], v[176:179]
  ds_read_b64_tr_b16 v[116:117], v184 offset:5248
  ds_read_b64_tr_b16 v[118:119], v184 offset:6528
  s_waitcnt lgkmcnt(11)
  v_cvt_pk_bf16_f32 v188, v236, v237
  v_lshlrev_b32 v236, 16, v188
  v_and_b32 v237, 0xffff0000, v188
  v_cvt_pk_bf16_f32 v188, v238, v239
  v_lshlrev_b32 v238, 16, v188
  v_and_b32 v239, 0xffff0000, v188
  v_mul_f32 v236, v236, v222
  v_mul_f32 v237, v237, v222
  v_mul_f32 v238, v238, v222
  v_mul_f32 v239, v239, v222
  v_cvt_pk_bf16_f32 v188, v236, v237
  v_lshlrev_b32 v236, 16, v188
  v_and_b32 v237, 0xffff0000, v188
  v_cvt_pk_bf16_f32 v188, v238, v239
  v_lshlrev_b32 v238, 16, v188
  v_and_b32 v239, 0xffff0000, v188
  v_lshlrev_b32 v16, 16, v218
  v_and_b32 v17, 0xffff0000, v218
  v_lshlrev_b32 v18, 16, v219
  v_and_b32 v19, 0xffff0000, v219
  v_mfma_f32_16x16x32_bf16 v[160:163], v[140:143], v[92:95], v[160:163]
  ds_read_b64_tr_b16 v[120:121], v184 offset:10240
  ds_read_b64_tr_b16 v[122:123], v184 offset:11520
  ds_read_b128 v[88:91], v180 offset:8192
  v_mfma_f32_16x16x32_bf16 v[164:167], v[144:147], v[92:95], v[164:167]
  ds_read_b64_tr_b16 v[124:125], v184 offset:10272
  ds_read_b64_tr_b16 v[126:127], v184 offset:11552
  v_mfma_f32_16x16x32_bf16 v[168:171], v[148:151], v[92:95], v[168:171]
  ds_read_b64_tr_b16 v[128:129], v184 offset:10304
  ds_read_b64_tr_b16 v[130:131], v184 offset:11584
  v_mfma_f32_16x16x32_bf16 v[172:175], v[152:155], v[92:95], v[172:175]
  ds_read_b64_tr_b16 v[132:133], v184 offset:10336
  ds_read_b64_tr_b16 v[134:135], v184 offset:11616
  v_mfma_f32_16x16x32_bf16 v[176:179], v[156:159], v[92:95], v[176:179]
  ds_read_b64_tr_b16 v[136:137], v184 offset:10368
  ds_read_b64_tr_b16 v[138:139], v184 offset:11648
  s_waitcnt lgkmcnt(11)
  v_mfma_f32_16x16x32_bf16 v[160:163], v[100:103], v[84:87], v[160:163]
  ds_read_b64_tr_b16 v[140:141], v184 offset:15360
  ds_read_b64_tr_b16 v[142:143], v184 offset:16640
  ds_read_b128 v[92:95], v182 offset:8192
  v_mfma_f32_16x16x32_bf16 v[164:167], v[104:107], v[84:87], v[164:167]
  ds_read_b64_tr_b16 v[144:145], v184 offset:15392
  ds_read_b64_tr_b16 v[146:147], v184 offset:16672
  v_mfma_f32_16x16x32_bf16 v[168:171], v[108:111], v[84:87], v[168:171]
  ds_read_b64_tr_b16 v[148:149], v184 offset:15424
  ds_read_b64_tr_b16 v[150:151], v184 offset:16704
  v_mfma_f32_16x16x32_bf16 v[172:175], v[112:115], v[84:87], v[172:175]
  ds_read_b64_tr_b16 v[152:153], v184 offset:15456
  ds_read_b64_tr_b16 v[154:155], v184 offset:16736
  v_mfma_f32_16x16x32_bf16 v[176:179], v[116:119], v[84:87], v[176:179]
  ds_read_b64_tr_b16 v[156:157], v184 offset:15488
  ds_read_b64_tr_b16 v[158:159], v184 offset:16768
  s_waitcnt lgkmcnt(11)
  v_cvt_pk_bf16_f32 v188, v240, v241
  v_lshlrev_b32 v240, 16, v188
  v_and_b32 v241, 0xffff0000, v188
  v_cvt_pk_bf16_f32 v188, v242, v243
  v_lshlrev_b32 v242, 16, v188
  v_and_b32 v243, 0xffff0000, v188
  v_mul_f32 v240, v240, v222
  v_mul_f32 v241, v241, v222
  v_mul_f32 v242, v242, v222
  v_mul_f32 v243, v243, v222
  v_cvt_pk_bf16_f32 v188, v240, v241
  v_lshlrev_b32 v240, 16, v188
  v_and_b32 v241, 0xffff0000, v188
  v_cvt_pk_bf16_f32 v188, v242, v243
  v_lshlrev_b32 v242, 16, v188
  v_and_b32 v243, 0xffff0000, v188
  v_lshlrev_b32 v20, 16, v220
  v_and_b32 v21, 0xffff0000, v220
  v_lshlrev_b32 v22, 16, v221
  v_and_b32 v23, 0xffff0000, v221
  s_barrier
  v_mfma_f32_16x16x32_bf16 v[160:163], v[120:123], v[88:91], v[160:163]
  ds_read_b64_tr_b16 v[100:101], v184 offset:36864
  ds_read_b64_tr_b16 v[102:103], v184 offset:38144
  ds_read_b128 v[84:87], v180 offset:36864
  v_mfma_f32_16x16x32_bf16 v[164:167], v[124:127], v[88:91], v[164:167]
  ds_read_b64_tr_b16 v[104:105], v184 offset:36896
  ds_read_b64_tr_b16 v[106:107], v184 offset:38176
  v_mfma_f32_16x16x32_bf16 v[168:171], v[128:131], v[88:91], v[168:171]
  ds_read_b64_tr_b16 v[108:109], v184 offset:36928
  ds_read_b64_tr_b16 v[110:111], v184 offset:38208
  v_mfma_f32_16x16x32_bf16 v[172:175], v[132:135], v[88:91], v[172:175]
  ds_read_b64_tr_b16 v[112:113], v184 offset:36960
  ds_read_b64_tr_b16 v[114:115], v184 offset:38240
  v_mfma_f32_16x16x32_bf16 v[176:179], v[136:139], v[88:91], v[176:179]
  ds_read_b64_tr_b16 v[116:117], v184 offset:36992
  ds_read_b64_tr_b16 v[118:119], v184 offset:38272
  s_waitcnt lgkmcnt(11)
  v_mfma_f32_16x16x32_bf16 v[160:163], v[140:143], v[92:95], v[160:163]
  ds_read_b64_tr_b16 v[120:121], v184 offset:41984
  ds_read_b64_tr_b16 v[122:123], v184 offset:43264
  ds_read_b128 v[88:91], v182 offset:36864
  v_mfma_f32_16x16x32_bf16 v[164:167], v[144:147], v[92:95], v[164:167]
  ds_read_b64_tr_b16 v[124:125], v184 offset:42016
  ds_read_b64_tr_b16 v[126:127], v184 offset:43296
  v_mfma_f32_16x16x32_bf16 v[168:171], v[148:151], v[92:95], v[168:171]
  ds_read_b64_tr_b16 v[128:129], v184 offset:42048
  ds_read_b64_tr_b16 v[130:131], v184 offset:43328
  v_mfma_f32_16x16x32_bf16 v[172:175], v[152:155], v[92:95], v[172:175]
  ds_read_b64_tr_b16 v[132:133], v184 offset:42080
  ds_read_b64_tr_b16 v[134:135], v184 offset:43360
  v_mfma_f32_16x16x32_bf16 v[176:179], v[156:159], v[92:95], v[176:179]
  ds_read_b64_tr_b16 v[136:137], v184 offset:42112
  ds_read_b64_tr_b16 v[138:139], v184 offset:43392
  s_waitcnt lgkmcnt(11)
  v_mfma_f32_16x16x32_bf16 v[160:163], v[100:103], v[84:87], v[160:163]
  ds_read_b64_tr_b16 v[140:141], v184 offset:47104
  ds_read_b64_tr_b16 v[142:143], v184 offset:48384
  ds_read_b128 v[92:95], v180 offset:45056
  v_mfma_f32_16x16x32_bf16 v[164:167], v[104:107], v[84:87], v[164:167]
  ds_read_b64_tr_b16 v[144:145], v184 offset:47136
  ds_read_b64_tr_b16 v[146:147], v184 offset:48416
  v_mfma_f32_16x16x32_bf16 v[168:171], v[108:111], v[84:87], v[168:171]
  ds_read_b64_tr_b16 v[148:149], v184 offset:47168
  ds_read_b64_tr_b16 v[150:151], v184 offset:48448
  v_mfma_f32_16x16x32_bf16 v[172:175], v[112:115], v[84:87], v[172:175]
  ds_read_b64_tr_b16 v[152:153], v184 offset:47200
  ds_read_b64_tr_b16 v[154:155], v184 offset:48480
  v_mfma_f32_16x16x32_bf16 v[176:179], v[116:119], v[84:87], v[176:179]
  ds_read_b64_tr_b16 v[156:157], v184 offset:47232
  ds_read_b64_tr_b16 v[158:159], v184 offset:48512
  s_waitcnt lgkmcnt(11)
  v_mfma_f32_16x16x32_bf16 v[160:163], v[120:123], v[88:91], v[160:163]
  ds_read_b64_tr_b16 v[100:101], v184 offset:52224
  ds_read_b64_tr_b16 v[102:103], v184 offset:53504
  ds_read_b128 v[84:87], v182 offset:45056
  v_mfma_f32_16x16x32_bf16 v[164:167], v[124:127], v[88:91], v[164:167]
  ds_read_b64_tr_b16 v[104:105], v184 offset:52256
  ds_read_b64_tr_b16 v[106:107], v184 offset:53536
  v_mfma_f32_16x16x32_bf16 v[168:171], v[128:131], v[88:91], v[168:171]
  ds_read_b64_tr_b16 v[108:109], v184 offset:52288
  ds_read_b64_tr_b16 v[110:111], v184 offset:53568
  v_mfma_f32_16x16x32_bf16 v[172:175], v[132:135], v[88:91], v[172:175]
  ds_read_b64_tr_b16 v[112:113], v184 offset:52320
  ds_read_b64_tr_b16 v[114:115], v184 offset:53600
  v_mfma_f32_16x16x32_bf16 v[176:179], v[136:139], v[88:91], v[176:179]
  ds_read_b64_tr_b16 v[116:117], v184 offset:52352
  ds_read_b64_tr_b16 v[118:119], v184 offset:53632
  s_waitcnt lgkmcnt(11)
  s_barrier
  v_mfma_f32_16x16x32_bf16 v[160:163], v[140:143], v[92:95], v[160:163]
  ds_read_b64_tr_b16 v[120:121], v185 offset:0
  ds_read_b64_tr_b16 v[122:123], v185 offset:1280
  ds_read_b128 v[88:91], v181 offset:0
  v_mfma_f32_16x16x32_bf16 v[164:167], v[144:147], v[92:95], v[164:167]
  ds_read_b64_tr_b16 v[124:125], v185 offset:32
  ds_read_b64_tr_b16 v[126:127], v185 offset:1312
  v_mfma_f32_16x16x32_bf16 v[168:171], v[148:151], v[92:95], v[168:171]
  ds_read_b64_tr_b16 v[128:129], v185 offset:64
  ds_read_b64_tr_b16 v[130:131], v185 offset:1344
  v_mfma_f32_16x16x32_bf16 v[172:175], v[152:155], v[92:95], v[172:175]
  ds_read_b64_tr_b16 v[132:133], v185 offset:96
  ds_read_b64_tr_b16 v[134:135], v185 offset:1376
  v_mfma_f32_16x16x32_bf16 v[176:179], v[156:159], v[92:95], v[176:179]
  ds_read_b64_tr_b16 v[136:137], v185 offset:128
  ds_read_b64_tr_b16 v[138:139], v185 offset:1408
  s_waitcnt lgkmcnt(11)
  v_mfma_f32_16x16x32_bf16 v[160:163], v[100:103], v[84:87], v[160:163]
  ds_read_b64_tr_b16 v[140:141], v185 offset:5120
  ds_read_b64_tr_b16 v[142:143], v185 offset:6400
  ds_read_b128 v[92:95], v183 offset:0
  v_mfma_f32_16x16x32_bf16 v[164:167], v[104:107], v[84:87], v[164:167]
  ds_read_b64_tr_b16 v[144:145], v185 offset:5152
  ds_read_b64_tr_b16 v[146:147], v185 offset:6432
  v_mfma_f32_16x16x32_bf16 v[168:171], v[108:111], v[84:87], v[168:171]
  ds_read_b64_tr_b16 v[148:149], v185 offset:5184
  ds_read_b64_tr_b16 v[150:151], v185 offset:6464
  v_mfma_f32_16x16x32_bf16 v[172:175], v[112:115], v[84:87], v[172:175]
  ds_read_b64_tr_b16 v[152:153], v185 offset:5216
  ds_read_b64_tr_b16 v[154:155], v185 offset:6496
  v_mfma_f32_16x16x32_bf16 v[176:179], v[116:119], v[84:87], v[176:179]
  ds_read_b64_tr_b16 v[156:157], v185 offset:5248
  ds_read_b64_tr_b16 v[158:159], v185 offset:6528
  s_waitcnt lgkmcnt(11)
  s_mov_b32 s8, s58
  s_mov_b32 s9, s59
  s_mov_b32 s10, 0x280000
  s_mov_b32 s11, 0x20000
  v_lshrrev_b32 v201, 4, v1
  v_and_b32 v190, 1, v201
  v_mul_u32_u24 v190, 24, v190
  v_add_u32 v190, v190, v206
  v_mfma_f32_16x16x32_bf16 v[160:163], v[120:123], v[88:91], v[160:163]
  ds_read_b64_tr_b16 v[100:101], v185 offset:10240
  ds_read_b64_tr_b16 v[102:103], v185 offset:11520
  ds_read_b128 v[84:87], v181 offset:8192
  v_mfma_f32_16x16x32_bf16 v[164:167], v[124:127], v[88:91], v[164:167]
  ds_read_b64_tr_b16 v[104:105], v185 offset:10272
  ds_read_b64_tr_b16 v[106:107], v185 offset:11552
  v_mfma_f32_16x16x32_bf16 v[168:171], v[128:131], v[88:91], v[168:171]
  ds_read_b64_tr_b16 v[108:109], v185 offset:10304
  ds_read_b64_tr_b16 v[110:111], v185 offset:11584
  v_mfma_f32_16x16x32_bf16 v[172:175], v[132:135], v[88:91], v[172:175]
  ds_read_b64_tr_b16 v[112:113], v185 offset:10336
  ds_read_b64_tr_b16 v[114:115], v185 offset:11616
  v_mfma_f32_16x16x32_bf16 v[176:179], v[136:139], v[88:91], v[176:179]
  ds_read_b64_tr_b16 v[116:117], v185 offset:10368
  ds_read_b64_tr_b16 v[118:119], v185 offset:11648
  s_waitcnt lgkmcnt(11)
  v_mfma_f32_16x16x32_bf16 v[160:163], v[140:143], v[92:95], v[160:163]
  ds_read_b64_tr_b16 v[120:121], v185 offset:15360
  ds_read_b64_tr_b16 v[122:123], v185 offset:16640
  ds_read_b128 v[88:91], v183 offset:8192
  v_mfma_f32_16x16x32_bf16 v[164:167], v[144:147], v[92:95], v[164:167]
  ds_read_b64_tr_b16 v[124:125], v185 offset:15392
  ds_read_b64_tr_b16 v[126:127], v185 offset:16672
  v_mfma_f32_16x16x32_bf16 v[168:171], v[148:151], v[92:95], v[168:171]
  ds_read_b64_tr_b16 v[128:129], v185 offset:15424
  ds_read_b64_tr_b16 v[130:131], v185 offset:16704
  v_mfma_f32_16x16x32_bf16 v[172:175], v[152:155], v[92:95], v[172:175]
  ds_read_b64_tr_b16 v[132:133], v185 offset:15456
  ds_read_b64_tr_b16 v[134:135], v185 offset:16736
  v_mfma_f32_16x16x32_bf16 v[176:179], v[156:159], v[92:95], v[176:179]
  ds_read_b64_tr_b16 v[136:137], v185 offset:15488
  ds_read_b64_tr_b16 v[138:139], v185 offset:16768
  s_waitcnt lgkmcnt(11)
  s_barrier
  v_mfma_f32_16x16x32_bf16 v[160:163], v[100:103], v[84:87], v[160:163]
  ds_read_b64_tr_b16 v[140:141], v185 offset:36864
  ds_read_b64_tr_b16 v[142:143], v185 offset:38144
  ds_read_b128 v[92:95], v181 offset:36864
  v_mfma_f32_16x16x32_bf16 v[164:167], v[104:107], v[84:87], v[164:167]
  ds_read_b64_tr_b16 v[144:145], v185 offset:36896
  ds_read_b64_tr_b16 v[146:147], v185 offset:38176
  v_mfma_f32_16x16x32_bf16 v[168:171], v[108:111], v[84:87], v[168:171]
  ds_read_b64_tr_b16 v[148:149], v185 offset:36928
  ds_read_b64_tr_b16 v[150:151], v185 offset:38208
  v_mfma_f32_16x16x32_bf16 v[172:175], v[112:115], v[84:87], v[172:175]
  ds_read_b64_tr_b16 v[152:153], v185 offset:36960
  ds_read_b64_tr_b16 v[154:155], v185 offset:38240
  v_mfma_f32_16x16x32_bf16 v[176:179], v[116:119], v[84:87], v[176:179]
  ds_read_b64_tr_b16 v[156:157], v185 offset:36992
  ds_read_b64_tr_b16 v[158:159], v185 offset:38272
  s_waitcnt lgkmcnt(11)
  v_mfma_f32_16x16x32_bf16 v[160:163], v[120:123], v[88:91], v[160:163]
  ds_read_b64_tr_b16 v[100:101], v185 offset:41984
  ds_read_b64_tr_b16 v[102:103], v185 offset:43264
  ds_read_b128 v[84:87], v183 offset:36864
  v_mfma_f32_16x16x32_bf16 v[164:167], v[124:127], v[88:91], v[164:167]
  ds_read_b64_tr_b16 v[104:105], v185 offset:42016
  ds_read_b64_tr_b16 v[106:107], v185 offset:43296
  v_mfma_f32_16x16x32_bf16 v[168:171], v[128:131], v[88:91], v[168:171]
  ds_read_b64_tr_b16 v[108:109], v185 offset:42048
  ds_read_b64_tr_b16 v[110:111], v185 offset:43328
  v_mfma_f32_16x16x32_bf16 v[172:175], v[132:135], v[88:91], v[172:175]
  ds_read_b64_tr_b16 v[112:113], v185 offset:42080
  ds_read_b64_tr_b16 v[114:115], v185 offset:43360
  v_mfma_f32_16x16x32_bf16 v[176:179], v[136:139], v[88:91], v[176:179]
  ds_read_b64_tr_b16 v[116:117], v185 offset:42112
  ds_read_b64_tr_b16 v[118:119], v185 offset:43392
  s_waitcnt lgkmcnt(11)
  v_mfma_f32_16x16x32_bf16 v[160:163], v[140:143], v[92:95], v[160:163]
  ds_read_b64_tr_b16 v[120:121], v185 offset:47104
  ds_read_b64_tr_b16 v[122:123], v185 offset:48384
  ds_read_b128 v[88:91], v181 offset:45056
  v_mfma_f32_16x16x32_bf16 v[164:167], v[144:147], v[92:95], v[164:167]
  ds_read_b64_tr_b16 v[124:125], v185 offset:47136
  ds_read_b64_tr_b16 v[126:127], v185 offset:48416
  v_mfma_f32_16x16x32_bf16 v[168:171], v[148:151], v[92:95], v[168:171]
  ds_read_b64_tr_b16 v[128:129], v185 offset:47168
  ds_read_b64_tr_b16 v[130:131], v185 offset:48448
  v_mfma_f32_16x16x32_bf16 v[172:175], v[152:155], v[92:95], v[172:175]
  ds_read_b64_tr_b16 v[132:133], v185 offset:47200
  ds_read_b64_tr_b16 v[134:135], v185 offset:48480
  v_mfma_f32_16x16x32_bf16 v[176:179], v[156:159], v[92:95], v[176:179]
  ds_read_b64_tr_b16 v[136:137], v185 offset:47232
  ds_read_b64_tr_b16 v[138:139], v185 offset:48512
  s_waitcnt lgkmcnt(11)
  v_mfma_f32_16x16x32_bf16 v[160:163], v[100:103], v[84:87], v[160:163]
  ds_read_b64_tr_b16 v[140:141], v185 offset:52224
  ds_read_b64_tr_b16 v[142:143], v185 offset:53504
  ds_read_b128 v[92:95], v183 offset:45056
  v_mfma_f32_16x16x32_bf16 v[164:167], v[104:107], v[84:87], v[164:167]
  ds_read_b64_tr_b16 v[144:145], v185 offset:52256
  ds_read_b64_tr_b16 v[146:147], v185 offset:53536
  v_mfma_f32_16x16x32_bf16 v[168:171], v[108:111], v[84:87], v[168:171]
  ds_read_b64_tr_b16 v[148:149], v185 offset:52288
  ds_read_b64_tr_b16 v[150:151], v185 offset:53568
  v_mfma_f32_16x16x32_bf16 v[172:175], v[112:115], v[84:87], v[172:175]
  ds_read_b64_tr_b16 v[152:153], v185 offset:52320
  ds_read_b64_tr_b16 v[154:155], v185 offset:53600
  v_mfma_f32_16x16x32_bf16 v[176:179], v[116:119], v[84:87], v[176:179]
  ds_read_b64_tr_b16 v[156:157], v185 offset:52352
  ds_read_b64_tr_b16 v[158:159], v185 offset:53632
  s_waitcnt lgkmcnt(11)
  s_barrier
  v_mfma_f32_16x16x32_bf16 v[160:163], v[120:123], v[88:91], v[160:163]
  ds_read_b64_tr_b16 v[100:101], v184 offset:0
  ds_read_b64_tr_b16 v[102:103], v184 offset:1280
  ds_read_b128 v[84:87], v180 offset:0
  v_mfma_f32_16x16x32_bf16 v[164:167], v[124:127], v[88:91], v[164:167]
  ds_read_b64_tr_b16 v[104:105], v184 offset:32
  ds_read_b64_tr_b16 v[106:107], v184 offset:1312
  v_mfma_f32_16x16x32_bf16 v[168:171], v[128:131], v[88:91], v[168:171]
  ds_read_b64_tr_b16 v[108:109], v184 offset:64
  ds_read_b64_tr_b16 v[110:111], v184 offset:1344
  v_mfma_f32_16x16x32_bf16 v[172:175], v[132:135], v[88:91], v[172:175]
  ds_read_b64_tr_b16 v[112:113], v184 offset:96
  ds_read_b64_tr_b16 v[114:115], v184 offset:1376
  v_mfma_f32_16x16x32_bf16 v[176:179], v[136:139], v[88:91], v[176:179]
  ds_read_b64_tr_b16 v[116:117], v184 offset:128
  ds_read_b64_tr_b16 v[118:119], v184 offset:1408
  s_waitcnt lgkmcnt(11)
  v_mfma_f32_16x16x32_bf16 v[160:163], v[140:143], v[92:95], v[160:163]
  ds_read_b64_tr_b16 v[120:121], v184 offset:5120
  ds_read_b64_tr_b16 v[122:123], v184 offset:6400
  ds_read_b128 v[88:91], v182 offset:0
  v_mfma_f32_16x16x32_bf16 v[164:167], v[144:147], v[92:95], v[164:167]
  ds_read_b64_tr_b16 v[124:125], v184 offset:5152
  ds_read_b64_tr_b16 v[126:127], v184 offset:6432
  v_mfma_f32_16x16x32_bf16 v[168:171], v[148:151], v[92:95], v[168:171]
  ds_read_b64_tr_b16 v[128:129], v184 offset:5184
  ds_read_b64_tr_b16 v[130:131], v184 offset:6464
  v_mfma_f32_16x16x32_bf16 v[172:175], v[152:155], v[92:95], v[172:175]
  ds_read_b64_tr_b16 v[132:133], v184 offset:5216
  ds_read_b64_tr_b16 v[134:135], v184 offset:6496
  v_mfma_f32_16x16x32_bf16 v[176:179], v[156:159], v[92:95], v[176:179]
  ds_read_b64_tr_b16 v[136:137], v184 offset:5248
  ds_read_b64_tr_b16 v[138:139], v184 offset:6528
  s_waitcnt lgkmcnt(11)
  v_mfma_f32_16x16x32_bf16 v[160:163], v[100:103], v[84:87], v[160:163]
  ds_read_b64_tr_b16 v[140:141], v184 offset:10240
  ds_read_b64_tr_b16 v[142:143], v184 offset:11520
  ds_read_b128 v[92:95], v180 offset:8192
  v_mfma_f32_16x16x32_bf16 v[164:167], v[104:107], v[84:87], v[164:167]
  ds_read_b64_tr_b16 v[144:145], v184 offset:10272
  ds_read_b64_tr_b16 v[146:147], v184 offset:11552
  v_mfma_f32_16x16x32_bf16 v[168:171], v[108:111], v[84:87], v[168:171]
  ds_read_b64_tr_b16 v[148:149], v184 offset:10304
  ds_read_b64_tr_b16 v[150:151], v184 offset:11584
  v_mfma_f32_16x16x32_bf16 v[172:175], v[112:115], v[84:87], v[172:175]
  ds_read_b64_tr_b16 v[152:153], v184 offset:10336
  ds_read_b64_tr_b16 v[154:155], v184 offset:11616
  v_mfma_f32_16x16x32_bf16 v[176:179], v[116:119], v[84:87], v[176:179]
  ds_read_b64_tr_b16 v[156:157], v184 offset:10368
  ds_read_b64_tr_b16 v[158:159], v184 offset:11648
  s_waitcnt lgkmcnt(11)
  v_mfma_f32_16x16x32_bf16 v[160:163], v[120:123], v[88:91], v[160:163]
  ds_read_b64_tr_b16 v[100:101], v184 offset:15360
  ds_read_b64_tr_b16 v[102:103], v184 offset:16640
  ds_read_b128 v[84:87], v182 offset:8192
  v_mfma_f32_16x16x32_bf16 v[164:167], v[124:127], v[88:91], v[164:167]
  ds_read_b64_tr_b16 v[104:105], v184 offset:15392
  ds_read_b64_tr_b16 v[106:107], v184 offset:16672
  v_mfma_f32_16x16x32_bf16 v[168:171], v[128:131], v[88:91], v[168:171]
  ds_read_b64_tr_b16 v[108:109], v184 offset:15424
  ds_read_b64_tr_b16 v[110:111], v184 offset:16704
  v_mfma_f32_16x16x32_bf16 v[172:175], v[132:135], v[88:91], v[172:175]
  ds_read_b64_tr_b16 v[112:113], v184 offset:15456
  ds_read_b64_tr_b16 v[114:115], v184 offset:16736
  v_mfma_f32_16x16x32_bf16 v[176:179], v[136:139], v[88:91], v[176:179]
  ds_read_b64_tr_b16 v[116:117], v184 offset:15488
  ds_read_b64_tr_b16 v[118:119], v184 offset:16768
  s_waitcnt lgkmcnt(11)
  s_barrier
  v_mfma_f32_16x16x32_bf16 v[160:163], v[140:143], v[92:95], v[160:163]
  ds_read_b64_tr_b16 v[120:121], v184 offset:36864
  ds_read_b64_tr_b16 v[122:123], v184 offset:38144
  ds_read_b128 v[88:91], v180 offset:36864
  v_mfma_f32_16x16x32_bf16 v[164:167], v[144:147], v[92:95], v[164:167]
  ds_read_b64_tr_b16 v[124:125], v184 offset:36896
  ds_read_b64_tr_b16 v[126:127], v184 offset:38176
  v_mfma_f32_16x16x32_bf16 v[168:171], v[148:151], v[92:95], v[168:171]
  ds_read_b64_tr_b16 v[128:129], v184 offset:36928
  ds_read_b64_tr_b16 v[130:131], v184 offset:38208
  v_mfma_f32_16x16x32_bf16 v[172:175], v[152:155], v[92:95], v[172:175]
  ds_read_b64_tr_b16 v[132:133], v184 offset:36960
  ds_read_b64_tr_b16 v[134:135], v184 offset:38240
  v_mfma_f32_16x16x32_bf16 v[176:179], v[156:159], v[92:95], v[176:179]
  ds_read_b64_tr_b16 v[136:137], v184 offset:36992
  ds_read_b64_tr_b16 v[138:139], v184 offset:38272
  s_waitcnt lgkmcnt(11)
  v_mfma_f32_16x16x32_bf16 v[160:163], v[100:103], v[84:87], v[160:163]
  ds_read_b64_tr_b16 v[140:141], v184 offset:41984
  ds_read_b64_tr_b16 v[142:143], v184 offset:43264
  ds_read_b128 v[92:95], v182 offset:36864
  v_mfma_f32_16x16x32_bf16 v[164:167], v[104:107], v[84:87], v[164:167]
  ds_read_b64_tr_b16 v[144:145], v184 offset:42016
  ds_read_b64_tr_b16 v[146:147], v184 offset:43296
  v_mfma_f32_16x16x32_bf16 v[168:171], v[108:111], v[84:87], v[168:171]
  ds_read_b64_tr_b16 v[148:149], v184 offset:42048
  ds_read_b64_tr_b16 v[150:151], v184 offset:43328
  v_mfma_f32_16x16x32_bf16 v[172:175], v[112:115], v[84:87], v[172:175]
  ds_read_b64_tr_b16 v[152:153], v184 offset:42080
  ds_read_b64_tr_b16 v[154:155], v184 offset:43360
  v_mfma_f32_16x16x32_bf16 v[176:179], v[116:119], v[84:87], v[176:179]
  ds_read_b64_tr_b16 v[156:157], v184 offset:42112
  ds_read_b64_tr_b16 v[158:159], v184 offset:43392
  s_waitcnt lgkmcnt(11)
  v_mfma_f32_16x16x32_bf16 v[160:163], v[120:123], v[88:91], v[160:163]
  ds_read_b64_tr_b16 v[100:101], v184 offset:47104
  ds_read_b64_tr_b16 v[102:103], v184 offset:48384
  ds_read_b128 v[84:87], v180 offset:45056
  v_mfma_f32_16x16x32_bf16 v[164:167], v[124:127], v[88:91], v[164:167]
  ds_read_b64_tr_b16 v[104:105], v184 offset:47136
  ds_read_b64_tr_b16 v[106:107], v184 offset:48416
  v_mfma_f32_16x16x32_bf16 v[168:171], v[128:131], v[88:91], v[168:171]
  ds_read_b64_tr_b16 v[108:109], v184 offset:47168
  ds_read_b64_tr_b16 v[110:111], v184 offset:48448
  v_mfma_f32_16x16x32_bf16 v[172:175], v[132:135], v[88:91], v[172:175]
  ds_read_b64_tr_b16 v[112:113], v184 offset:47200
  ds_read_b64_tr_b16 v[114:115], v184 offset:48480
  v_mfma_f32_16x16x32_bf16 v[176:179], v[136:139], v[88:91], v[176:179]
  ds_read_b64_tr_b16 v[116:117], v184 offset:47232
  ds_read_b64_tr_b16 v[118:119], v184 offset:48512
  s_waitcnt lgkmcnt(11)
  v_mfma_f32_16x16x32_bf16 v[160:163], v[140:143], v[92:95], v[160:163]
  ds_read_b64_tr_b16 v[120:121], v184 offset:52224
  ds_read_b64_tr_b16 v[122:123], v184 offset:53504
  ds_read_b128 v[88:91], v182 offset:45056
  v_mfma_f32_16x16x32_bf16 v[164:167], v[144:147], v[92:95], v[164:167]
  ds_read_b64_tr_b16 v[124:125], v184 offset:52256
  ds_read_b64_tr_b16 v[126:127], v184 offset:53536
  v_mfma_f32_16x16x32_bf16 v[168:171], v[148:151], v[92:95], v[168:171]
  ds_read_b64_tr_b16 v[128:129], v184 offset:52288
  ds_read_b64_tr_b16 v[130:131], v184 offset:53568
  v_mfma_f32_16x16x32_bf16 v[172:175], v[152:155], v[92:95], v[172:175]
  ds_read_b64_tr_b16 v[132:133], v184 offset:52320
  ds_read_b64_tr_b16 v[134:135], v184 offset:53600
  v_mfma_f32_16x16x32_bf16 v[176:179], v[156:159], v[92:95], v[176:179]
  ds_read_b64_tr_b16 v[136:137], v184 offset:52352
  ds_read_b64_tr_b16 v[138:139], v184 offset:53632
  s_waitcnt lgkmcnt(11)
  s_barrier
  v_mfma_f32_16x16x32_bf16 v[160:163], v[100:103], v[84:87], v[160:163]
  ds_read_b64_tr_b16 v[140:141], v185 offset:0
  ds_read_b64_tr_b16 v[142:143], v185 offset:1280
  ds_read_b128 v[92:95], v181 offset:0
  v_mfma_f32_16x16x32_bf16 v[164:167], v[104:107], v[84:87], v[164:167]
  ds_read_b64_tr_b16 v[144:145], v185 offset:32
  ds_read_b64_tr_b16 v[146:147], v185 offset:1312
  v_mfma_f32_16x16x32_bf16 v[168:171], v[108:111], v[84:87], v[168:171]
  ds_read_b64_tr_b16 v[148:149], v185 offset:64
  ds_read_b64_tr_b16 v[150:151], v185 offset:1344
  v_mfma_f32_16x16x32_bf16 v[172:175], v[112:115], v[84:87], v[172:175]
  ds_read_b64_tr_b16 v[152:153], v185 offset:96
  ds_read_b64_tr_b16 v[154:155], v185 offset:1376
  v_mfma_f32_16x16x32_bf16 v[176:179], v[116:119], v[84:87], v[176:179]
  ds_read_b64_tr_b16 v[156:157], v185 offset:128
  ds_read_b64_tr_b16 v[158:159], v185 offset:1408
  s_waitcnt lgkmcnt(11)
  v_mfma_f32_16x16x32_bf16 v[160:163], v[120:123], v[88:91], v[160:163]
  ds_read_b64_tr_b16 v[100:101], v185 offset:5120
  ds_read_b64_tr_b16 v[102:103], v185 offset:6400
  ds_read_b128 v[84:87], v183 offset:0
  v_mfma_f32_16x16x32_bf16 v[164:167], v[124:127], v[88:91], v[164:167]
  ds_read_b64_tr_b16 v[104:105], v185 offset:5152
  ds_read_b64_tr_b16 v[106:107], v185 offset:6432
  v_mfma_f32_16x16x32_bf16 v[168:171], v[128:131], v[88:91], v[168:171]
  ds_read_b64_tr_b16 v[108:109], v185 offset:5184
  ds_read_b64_tr_b16 v[110:111], v185 offset:6464
  v_mfma_f32_16x16x32_bf16 v[172:175], v[132:135], v[88:91], v[172:175]
  ds_read_b64_tr_b16 v[112:113], v185 offset:5216
  ds_read_b64_tr_b16 v[114:115], v185 offset:6496
  v_mfma_f32_16x16x32_bf16 v[176:179], v[136:139], v[88:91], v[176:179]
  ds_read_b64_tr_b16 v[116:117], v185 offset:5248
  ds_read_b64_tr_b16 v[118:119], v185 offset:6528
  s_waitcnt lgkmcnt(11)
  v_mfma_f32_16x16x32_bf16 v[160:163], v[140:143], v[92:95], v[160:163]
  ds_read_b64_tr_b16 v[120:121], v185 offset:10240
  ds_read_b64_tr_b16 v[122:123], v185 offset:11520
  ds_read_b128 v[88:91], v181 offset:8192
  v_mfma_f32_16x16x32_bf16 v[164:167], v[144:147], v[92:95], v[164:167]
  ds_read_b64_tr_b16 v[124:125], v185 offset:10272
  ds_read_b64_tr_b16 v[126:127], v185 offset:11552
  v_mfma_f32_16x16x32_bf16 v[168:171], v[148:151], v[92:95], v[168:171]
  ds_read_b64_tr_b16 v[128:129], v185 offset:10304
  ds_read_b64_tr_b16 v[130:131], v185 offset:11584
  v_mfma_f32_16x16x32_bf16 v[172:175], v[152:155], v[92:95], v[172:175]
  ds_read_b64_tr_b16 v[132:133], v185 offset:10336
  ds_read_b64_tr_b16 v[134:135], v185 offset:11616
  v_mfma_f32_16x16x32_bf16 v[176:179], v[156:159], v[92:95], v[176:179]
  ds_read_b64_tr_b16 v[136:137], v185 offset:10368
  ds_read_b64_tr_b16 v[138:139], v185 offset:11648
  s_waitcnt lgkmcnt(11)
  v_mfma_f32_16x16x32_bf16 v[160:163], v[100:103], v[84:87], v[160:163]
  ds_read_b64_tr_b16 v[140:141], v185 offset:15360
  ds_read_b64_tr_b16 v[142:143], v185 offset:16640
  ds_read_b128 v[92:95], v183 offset:8192
  v_mfma_f32_16x16x32_bf16 v[164:167], v[104:107], v[84:87], v[164:167]
  ds_read_b64_tr_b16 v[144:145], v185 offset:15392
  ds_read_b64_tr_b16 v[146:147], v185 offset:16672
  v_mfma_f32_16x16x32_bf16 v[168:171], v[108:111], v[84:87], v[168:171]
  ds_read_b64_tr_b16 v[148:149], v185 offset:15424
  ds_read_b64_tr_b16 v[150:151], v185 offset:16704
  v_mfma_f32_16x16x32_bf16 v[172:175], v[112:115], v[84:87], v[172:175]
  ds_read_b64_tr_b16 v[152:153], v185 offset:15456
  ds_read_b64_tr_b16 v[154:155], v185 offset:16736
  v_mfma_f32_16x16x32_bf16 v[176:179], v[116:119], v[84:87], v[176:179]
  ds_read_b64_tr_b16 v[156:157], v185 offset:15488
  ds_read_b64_tr_b16 v[158:159], v185 offset:16768
  s_waitcnt lgkmcnt(11)
  s_barrier
  v_mfma_f32_16x16x32_bf16 v[160:163], v[120:123], v[88:91], v[160:163]
  ds_read_b64_tr_b16 v[100:101], v185 offset:36864
  ds_read_b64_tr_b16 v[102:103], v185 offset:38144
  ds_read_b128 v[84:87], v181 offset:36864
  v_mfma_f32_16x16x32_bf16 v[164:167], v[124:127], v[88:91], v[164:167]
  ds_read_b64_tr_b16 v[104:105], v185 offset:36896
  ds_read_b64_tr_b16 v[106:107], v185 offset:38176
  v_mfma_f32_16x16x32_bf16 v[168:171], v[128:131], v[88:91], v[168:171]
  ds_read_b64_tr_b16 v[108:109], v185 offset:36928
  ds_read_b64_tr_b16 v[110:111], v185 offset:38208
  v_mfma_f32_16x16x32_bf16 v[172:175], v[132:135], v[88:91], v[172:175]
  ds_read_b64_tr_b16 v[112:113], v185 offset:36960
  ds_read_b64_tr_b16 v[114:115], v185 offset:38240
  v_mfma_f32_16x16x32_bf16 v[176:179], v[136:139], v[88:91], v[176:179]
  ds_read_b64_tr_b16 v[116:117], v185 offset:36992
  ds_read_b64_tr_b16 v[118:119], v185 offset:38272
  s_waitcnt lgkmcnt(11)
  v_mfma_f32_16x16x32_bf16 v[160:163], v[140:143], v[92:95], v[160:163]
  ds_read_b64_tr_b16 v[120:121], v185 offset:41984
  ds_read_b64_tr_b16 v[122:123], v185 offset:43264
  ds_read_b128 v[88:91], v183 offset:36864
  v_mfma_f32_16x16x32_bf16 v[164:167], v[144:147], v[92:95], v[164:167]
  ds_read_b64_tr_b16 v[124:125], v185 offset:42016
  ds_read_b64_tr_b16 v[126:127], v185 offset:43296
  v_mfma_f32_16x16x32_bf16 v[168:171], v[148:151], v[92:95], v[168:171]
  ds_read_b64_tr_b16 v[128:129], v185 offset:42048
  ds_read_b64_tr_b16 v[130:131], v185 offset:43328
  v_mfma_f32_16x16x32_bf16 v[172:175], v[152:155], v[92:95], v[172:175]
  ds_read_b64_tr_b16 v[132:133], v185 offset:42080
  ds_read_b64_tr_b16 v[134:135], v185 offset:43360
  v_mfma_f32_16x16x32_bf16 v[176:179], v[156:159], v[92:95], v[176:179]
  ds_read_b64_tr_b16 v[136:137], v185 offset:42112
  ds_read_b64_tr_b16 v[138:139], v185 offset:43392
  s_waitcnt lgkmcnt(11)
  v_mfma_f32_16x16x32_bf16 v[160:163], v[100:103], v[84:87], v[160:163]
  ds_read_b64_tr_b16 v[140:141], v185 offset:47104
  ds_read_b64_tr_b16 v[142:143], v185 offset:48384
  ds_read_b128 v[92:95], v181 offset:45056
  v_mfma_f32_16x16x32_bf16 v[164:167], v[104:107], v[84:87], v[164:167]
  ds_read_b64_tr_b16 v[144:145], v185 offset:47136
  ds_read_b64_tr_b16 v[146:147], v185 offset:48416
  v_mfma_f32_16x16x32_bf16 v[168:171], v[108:111], v[84:87], v[168:171]
  ds_read_b64_tr_b16 v[148:149], v185 offset:47168
  ds_read_b64_tr_b16 v[150:151], v185 offset:48448
  v_mfma_f32_16x16x32_bf16 v[172:175], v[112:115], v[84:87], v[172:175]
  ds_read_b64_tr_b16 v[152:153], v185 offset:47200
  ds_read_b64_tr_b16 v[154:155], v185 offset:48480
  v_mfma_f32_16x16x32_bf16 v[176:179], v[116:119], v[84:87], v[176:179]
  ds_read_b64_tr_b16 v[156:157], v185 offset:47232
  ds_read_b64_tr_b16 v[158:159], v185 offset:48512
  s_waitcnt lgkmcnt(11)
  v_mfma_f32_16x16x32_bf16 v[160:163], v[120:123], v[88:91], v[160:163]
  ds_read_b64_tr_b16 v[100:101], v185 offset:52224
  ds_read_b64_tr_b16 v[102:103], v185 offset:53504
  ds_read_b128 v[84:87], v183 offset:45056
  v_mfma_f32_16x16x32_bf16 v[164:167], v[124:127], v[88:91], v[164:167]
  ds_read_b64_tr_b16 v[104:105], v185 offset:52256
  ds_read_b64_tr_b16 v[106:107], v185 offset:53536
  v_mfma_f32_16x16x32_bf16 v[168:171], v[128:131], v[88:91], v[168:171]
  ds_read_b64_tr_b16 v[108:109], v185 offset:52288
  ds_read_b64_tr_b16 v[110:111], v185 offset:53568
  v_mfma_f32_16x16x32_bf16 v[172:175], v[132:135], v[88:91], v[172:175]
  ds_read_b64_tr_b16 v[112:113], v185 offset:52320
  ds_read_b64_tr_b16 v[114:115], v185 offset:53600
  v_mfma_f32_16x16x32_bf16 v[176:179], v[136:139], v[88:91], v[176:179]
  ds_read_b64_tr_b16 v[116:117], v185 offset:52352
  ds_read_b64_tr_b16 v[118:119], v185 offset:53632
  s_waitcnt lgkmcnt(11)
  s_barrier
  v_mfma_f32_16x16x32_bf16 v[160:163], v[140:143], v[92:95], v[160:163]
  ds_read_b64_tr_b16 v[120:121], v184 offset:0
  ds_read_b64_tr_b16 v[122:123], v184 offset:1280
  ds_read_b128 v[88:91], v180 offset:0
  v_mfma_f32_16x16x32_bf16 v[164:167], v[144:147], v[92:95], v[164:167]
  ds_read_b64_tr_b16 v[124:125], v184 offset:32
  ds_read_b64_tr_b16 v[126:127], v184 offset:1312
  v_mfma_f32_16x16x32_bf16 v[168:171], v[148:151], v[92:95], v[168:171]
  ds_read_b64_tr_b16 v[128:129], v184 offset:64
  ds_read_b64_tr_b16 v[130:131], v184 offset:1344
  v_mfma_f32_16x16x32_bf16 v[172:175], v[152:155], v[92:95], v[172:175]
  ds_read_b64_tr_b16 v[132:133], v184 offset:96
  ds_read_b64_tr_b16 v[134:135], v184 offset:1376
  v_mfma_f32_16x16x32_bf16 v[176:179], v[156:159], v[92:95], v[176:179]
  ds_read_b64_tr_b16 v[136:137], v184 offset:128
  ds_read_b64_tr_b16 v[138:139], v184 offset:1408
  s_waitcnt lgkmcnt(11)
  v_mfma_f32_16x16x32_bf16 v[160:163], v[100:103], v[84:87], v[160:163]
  ds_read_b64_tr_b16 v[140:141], v184 offset:5120
  ds_read_b64_tr_b16 v[142:143], v184 offset:6400
  ds_read_b128 v[92:95], v182 offset:0
  v_mfma_f32_16x16x32_bf16 v[164:167], v[104:107], v[84:87], v[164:167]
  ds_read_b64_tr_b16 v[144:145], v184 offset:5152
  ds_read_b64_tr_b16 v[146:147], v184 offset:6432
  v_mfma_f32_16x16x32_bf16 v[168:171], v[108:111], v[84:87], v[168:171]
  ds_read_b64_tr_b16 v[148:149], v184 offset:5184
  ds_read_b64_tr_b16 v[150:151], v184 offset:6464
  v_mfma_f32_16x16x32_bf16 v[172:175], v[112:115], v[84:87], v[172:175]
  ds_read_b64_tr_b16 v[152:153], v184 offset:5216
  ds_read_b64_tr_b16 v[154:155], v184 offset:6496
  v_mfma_f32_16x16x32_bf16 v[176:179], v[116:119], v[84:87], v[176:179]
  ds_read_b64_tr_b16 v[156:157], v184 offset:5248
  ds_read_b64_tr_b16 v[158:159], v184 offset:6528
  s_waitcnt lgkmcnt(11)
  v_mfma_f32_16x16x32_bf16 v[160:163], v[120:123], v[88:91], v[160:163]
  ds_read_b64_tr_b16 v[100:101], v184 offset:10240
  ds_read_b64_tr_b16 v[102:103], v184 offset:11520
  ds_read_b128 v[84:87], v180 offset:8192
  v_mfma_f32_16x16x32_bf16 v[164:167], v[124:127], v[88:91], v[164:167]
  ds_read_b64_tr_b16 v[104:105], v184 offset:10272
  ds_read_b64_tr_b16 v[106:107], v184 offset:11552
  v_mfma_f32_16x16x32_bf16 v[168:171], v[128:131], v[88:91], v[168:171]
  ds_read_b64_tr_b16 v[108:109], v184 offset:10304
  ds_read_b64_tr_b16 v[110:111], v184 offset:11584
  v_mfma_f32_16x16x32_bf16 v[172:175], v[132:135], v[88:91], v[172:175]
  ds_read_b64_tr_b16 v[112:113], v184 offset:10336
  ds_read_b64_tr_b16 v[114:115], v184 offset:11616
  v_mfma_f32_16x16x32_bf16 v[176:179], v[136:139], v[88:91], v[176:179]
  ds_read_b64_tr_b16 v[116:117], v184 offset:10368
  ds_read_b64_tr_b16 v[118:119], v184 offset:11648
  s_waitcnt lgkmcnt(11)
  v_mfma_f32_16x16x32_bf16 v[160:163], v[140:143], v[92:95], v[160:163]
  ds_read_b64_tr_b16 v[120:121], v184 offset:15360
  ds_read_b64_tr_b16 v[122:123], v184 offset:16640
  ds_read_b128 v[88:91], v182 offset:8192
  v_mfma_f32_16x16x32_bf16 v[164:167], v[144:147], v[92:95], v[164:167]
  ds_read_b64_tr_b16 v[124:125], v184 offset:15392
  ds_read_b64_tr_b16 v[126:127], v184 offset:16672
  v_mfma_f32_16x16x32_bf16 v[168:171], v[148:151], v[92:95], v[168:171]
  ds_read_b64_tr_b16 v[128:129], v184 offset:15424
  ds_read_b64_tr_b16 v[130:131], v184 offset:16704
  v_mfma_f32_16x16x32_bf16 v[172:175], v[152:155], v[92:95], v[172:175]
  ds_read_b64_tr_b16 v[132:133], v184 offset:15456
  ds_read_b64_tr_b16 v[134:135], v184 offset:16736
  v_mfma_f32_16x16x32_bf16 v[176:179], v[156:159], v[92:95], v[176:179]
  ds_read_b64_tr_b16 v[136:137], v184 offset:15488
  ds_read_b64_tr_b16 v[138:139], v184 offset:16768
  s_waitcnt lgkmcnt(11)
  s_barrier
  v_mfma_f32_16x16x32_bf16 v[160:163], v[100:103], v[84:87], v[160:163]
  ds_read_b64_tr_b16 v[140:141], v184 offset:36864
  ds_read_b64_tr_b16 v[142:143], v184 offset:38144
  ds_read_b128 v[92:95], v180 offset:36864
  v_mfma_f32_16x16x32_bf16 v[164:167], v[104:107], v[84:87], v[164:167]
  ds_read_b64_tr_b16 v[144:145], v184 offset:36896
  ds_read_b64_tr_b16 v[146:147], v184 offset:38176
  v_mfma_f32_16x16x32_bf16 v[168:171], v[108:111], v[84:87], v[168:171]
  ds_read_b64_tr_b16 v[148:149], v184 offset:36928
  ds_read_b64_tr_b16 v[150:151], v184 offset:38208
  v_mfma_f32_16x16x32_bf16 v[172:175], v[112:115], v[84:87], v[172:175]
  ds_read_b64_tr_b16 v[152:153], v184 offset:36960
  ds_read_b64_tr_b16 v[154:155], v184 offset:38240
  v_mfma_f32_16x16x32_bf16 v[176:179], v[116:119], v[84:87], v[176:179]
  ds_read_b64_tr_b16 v[156:157], v184 offset:36992
  ds_read_b64_tr_b16 v[158:159], v184 offset:38272
  s_waitcnt lgkmcnt(11)
  v_mfma_f32_16x16x32_bf16 v[160:163], v[120:123], v[88:91], v[160:163]
  ds_read_b64_tr_b16 v[100:101], v184 offset:41984
  ds_read_b64_tr_b16 v[102:103], v184 offset:43264
  ds_read_b128 v[84:87], v182 offset:36864
  v_mfma_f32_16x16x32_bf16 v[164:167], v[124:127], v[88:91], v[164:167]
  ds_read_b64_tr_b16 v[104:105], v184 offset:42016
  ds_read_b64_tr_b16 v[106:107], v184 offset:43296
  v_mfma_f32_16x16x32_bf16 v[168:171], v[128:131], v[88:91], v[168:171]
  ds_read_b64_tr_b16 v[108:109], v184 offset:42048
  ds_read_b64_tr_b16 v[110:111], v184 offset:43328
  v_mfma_f32_16x16x32_bf16 v[172:175], v[132:135], v[88:91], v[172:175]
  ds_read_b64_tr_b16 v[112:113], v184 offset:42080
  ds_read_b64_tr_b16 v[114:115], v184 offset:43360
  v_mfma_f32_16x16x32_bf16 v[176:179], v[136:139], v[88:91], v[176:179]
  ds_read_b64_tr_b16 v[116:117], v184 offset:42112
  ds_read_b64_tr_b16 v[118:119], v184 offset:43392
  s_waitcnt lgkmcnt(11)
  v_mfma_f32_16x16x32_bf16 v[160:163], v[140:143], v[92:95], v[160:163]
  ds_read_b64_tr_b16 v[120:121], v184 offset:47104
  ds_read_b64_tr_b16 v[122:123], v184 offset:48384
  ds_read_b128 v[88:91], v180 offset:45056
  v_mfma_f32_16x16x32_bf16 v[164:167], v[144:147], v[92:95], v[164:167]
  ds_read_b64_tr_b16 v[124:125], v184 offset:47136
  ds_read_b64_tr_b16 v[126:127], v184 offset:48416
  v_mfma_f32_16x16x32_bf16 v[168:171], v[148:151], v[92:95], v[168:171]
  ds_read_b64_tr_b16 v[128:129], v184 offset:47168
  ds_read_b64_tr_b16 v[130:131], v184 offset:48448
  v_mfma_f32_16x16x32_bf16 v[172:175], v[152:155], v[92:95], v[172:175]
  ds_read_b64_tr_b16 v[132:133], v184 offset:47200
  ds_read_b64_tr_b16 v[134:135], v184 offset:48480
  v_mfma_f32_16x16x32_bf16 v[176:179], v[156:159], v[92:95], v[176:179]
  ds_read_b64_tr_b16 v[136:137], v184 offset:47232
  ds_read_b64_tr_b16 v[138:139], v184 offset:48512
  s_waitcnt lgkmcnt(11)
  v_mfma_f32_16x16x32_bf16 v[160:163], v[100:103], v[84:87], v[160:163]
  ds_read_b64_tr_b16 v[140:141], v184 offset:52224
  ds_read_b64_tr_b16 v[142:143], v184 offset:53504
  ds_read_b128 v[92:95], v182 offset:45056
  v_mfma_f32_16x16x32_bf16 v[164:167], v[104:107], v[84:87], v[164:167]
  ds_read_b64_tr_b16 v[144:145], v184 offset:52256
  ds_read_b64_tr_b16 v[146:147], v184 offset:53536
  v_mfma_f32_16x16x32_bf16 v[168:171], v[108:111], v[84:87], v[168:171]
  ds_read_b64_tr_b16 v[148:149], v184 offset:52288
  ds_read_b64_tr_b16 v[150:151], v184 offset:53568
  v_mfma_f32_16x16x32_bf16 v[172:175], v[112:115], v[84:87], v[172:175]
  ds_read_b64_tr_b16 v[152:153], v184 offset:52320
  ds_read_b64_tr_b16 v[154:155], v184 offset:53600
  v_mfma_f32_16x16x32_bf16 v[176:179], v[116:119], v[84:87], v[176:179]
  ds_read_b64_tr_b16 v[156:157], v184 offset:52352
  ds_read_b64_tr_b16 v[158:159], v184 offset:53632
  s_waitcnt lgkmcnt(11)
  s_barrier
  v_mfma_f32_16x16x32_bf16 v[160:163], v[120:123], v[88:91], v[160:163]
  ds_read_b64_tr_b16 v[100:101], v185 offset:0
  ds_read_b64_tr_b16 v[102:103], v185 offset:1280
  ds_read_b128 v[84:87], v181 offset:0
  v_mfma_f32_16x16x32_bf16 v[164:167], v[124:127], v[88:91], v[164:167]
  ds_read_b64_tr_b16 v[104:105], v185 offset:32
  ds_read_b64_tr_b16 v[106:107], v185 offset:1312
  v_mfma_f32_16x16x32_bf16 v[168:171], v[128:131], v[88:91], v[168:171]
  ds_read_b64_tr_b16 v[108:109], v185 offset:64
  ds_read_b64_tr_b16 v[110:111], v185 offset:1344
  v_mfma_f32_16x16x32_bf16 v[172:175], v[132:135], v[88:91], v[172:175]
  ds_read_b64_tr_b16 v[112:113], v185 offset:96
  ds_read_b64_tr_b16 v[114:115], v185 offset:1376
  v_mfma_f32_16x16x32_bf16 v[176:179], v[136:139], v[88:91], v[176:179]
  ds_read_b64_tr_b16 v[116:117], v185 offset:128
  ds_read_b64_tr_b16 v[118:119], v185 offset:1408
  s_waitcnt lgkmcnt(11)
  v_mfma_f32_16x16x32_bf16 v[160:163], v[140:143], v[92:95], v[160:163]
  ds_read_b64_tr_b16 v[120:121], v185 offset:5120
  ds_read_b64_tr_b16 v[122:123], v185 offset:6400
  ds_read_b128 v[88:91], v183 offset:0
  v_mfma_f32_16x16x32_bf16 v[164:167], v[144:147], v[92:95], v[164:167]
  ds_read_b64_tr_b16 v[124:125], v185 offset:5152
  ds_read_b64_tr_b16 v[126:127], v185 offset:6432
  v_mfma_f32_16x16x32_bf16 v[168:171], v[148:151], v[92:95], v[168:171]
  ds_read_b64_tr_b16 v[128:129], v185 offset:5184
  ds_read_b64_tr_b16 v[130:131], v185 offset:6464
  v_mfma_f32_16x16x32_bf16 v[172:175], v[152:155], v[92:95], v[172:175]
  ds_read_b64_tr_b16 v[132:133], v185 offset:5216
  ds_read_b64_tr_b16 v[134:135], v185 offset:6496
  v_mfma_f32_16x16x32_bf16 v[176:179], v[156:159], v[92:95], v[176:179]
  ds_read_b64_tr_b16 v[136:137], v185 offset:5248
  ds_read_b64_tr_b16 v[138:139], v185 offset:6528
  s_waitcnt lgkmcnt(11)
  v_mfma_f32_16x16x32_bf16 v[160:163], v[100:103], v[84:87], v[160:163]
  v_mfma_f32_16x16x32_bf16 v[164:167], v[104:107], v[84:87], v[164:167]
  v_mfma_f32_16x16x32_bf16 v[168:171], v[108:111], v[84:87], v[168:171]
  v_mfma_f32_16x16x32_bf16 v[172:175], v[112:115], v[84:87], v[172:175]
  v_mfma_f32_16x16x32_bf16 v[176:179], v[116:119], v[84:87], v[176:179]
  s_waitcnt lgkmcnt(0)
  v_mfma_f32_16x16x32_bf16 v[160:163], v[120:123], v[88:91], v[160:163]
  v_mfma_f32_16x16x32_bf16 v[164:167], v[124:127], v[88:91], v[164:167]
  v_mfma_f32_16x16x32_bf16 v[168:171], v[128:131], v[88:91], v[168:171]
  v_mfma_f32_16x16x32_bf16 v[172:175], v[132:135], v[88:91], v[172:175]
  v_mfma_f32_16x16x32_bf16 v[176:179], v[136:139], v[88:91], v[176:179]
  s_nop 7
  v_pk_add_f32 v[4:5], v[4:5], v[160:161]
  v_pk_add_f32 v[6:7], v[6:7], v[162:163]
  v_pk_fma_f32 v[4:5], v[4:5], v[222:223], v[224:225] op_sel:[0,1,0] op_sel_hi:[1,1,1]
  v_pk_fma_f32 v[6:7], v[6:7], v[222:223], v[226:227] op_sel:[0,1,0] op_sel_hi:[1,1,1]
  v_cvt_pk_bf16_f32 v100, v4, v5
  v_cvt_pk_bf16_f32 v101, v6, v7
  v_pk_add_f32 v[8:9], v[8:9], v[164:165]
  v_pk_add_f32 v[10:11], v[10:11], v[166:167]
  v_pk_fma_f32 v[8:9], v[8:9], v[222:223], v[228:229] op_sel:[0,1,0] op_sel_hi:[1,1,1]
  v_pk_fma_f32 v[10:11], v[10:11], v[222:223], v[230:231] op_sel:[0,1,0] op_sel_hi:[1,1,1]
  v_cvt_pk_bf16_f32 v102, v8, v9
  v_cvt_pk_bf16_f32 v103, v10, v11
  v_pk_add_f32 v[12:13], v[12:13], v[168:169]
  v_pk_add_f32 v[14:15], v[14:15], v[170:171]
  v_pk_fma_f32 v[12:13], v[12:13], v[222:223], v[232:233] op_sel:[0,1,0] op_sel_hi:[1,1,1]
  v_pk_fma_f32 v[14:15], v[14:15], v[222:223], v[234:235] op_sel:[0,1,0] op_sel_hi:[1,1,1]
  v_cvt_pk_bf16_f32 v104, v12, v13
  v_cvt_pk_bf16_f32 v105, v14, v15
  v_pk_add_f32 v[16:17], v[16:17], v[172:173]
  v_pk_add_f32 v[18:19], v[18:19], v[174:175]
  v_pk_fma_f32 v[16:17], v[16:17], v[222:223], v[236:237] op_sel:[0,1,0] op_sel_hi:[1,1,1]
  v_pk_fma_f32 v[18:19], v[18:19], v[222:223], v[238:239] op_sel:[0,1,0] op_sel_hi:[1,1,1]
  v_cvt_pk_bf16_f32 v106, v16, v17
  v_cvt_pk_bf16_f32 v107, v18, v19
  v_pk_add_f32 v[20:21], v[20:21], v[176:177]
  v_pk_add_f32 v[22:23], v[22:23], v[178:179]
  v_pk_fma_f32 v[20:21], v[20:21], v[222:223], v[240:241] op_sel:[0,1,0] op_sel_hi:[1,1,1]
  v_pk_fma_f32 v[22:23], v[22:23], v[222:223], v[242:243] op_sel:[0,1,0] op_sel_hi:[1,1,1]
  v_cvt_pk_bf16_f32 v108, v20, v21
  v_cvt_pk_bf16_f32 v109, v22, v23
  s_nop 1
  v_permlane16_swap_b32 v100, v102
  v_permlane16_swap_b32 v101, v103
  buffer_store_dwordx4 v[100:103], v190, s[8:11], 0 offen offset:0
  v_permlane16_swap_b32 v104, v106
  v_permlane16_swap_b32 v105, v107
  buffer_store_dwordx4 v[104:107], v190, s[8:11], 0 offen offset:64
  buffer_store_dwordx2 v[108:109], v206, s[8:11], 0 offen offset:128
  s_endpgm
.Lloader:
  s_mov_b32 s8, s40
  s_mov_b32 s9, s41
  s_mov_b32 s10, 0x280000
  s_mov_b32 s11, 0x20000
  s_lshl_b32 s30, s22, 7
  s_lshl_b32 s31, s21, 5
  s_add_u32 s30, s30, s31
  s_mul_i32 s30, s30, 1280
  v_lshrrev_b32 v50, 3, v1
  v_and_b32 v51, 7, v1
  v_xor_b32 v51, v51, v50
  v_lshlrev_b32 v51, 4, v51
  v_mul_u32_u24 v28, 1280, v50
  v_add3_u32 v4, v28, v51, s30
  v_add_u32 v5, 9216, v4
  v_add_u32 v6, 18432, v4
  v_add_u32 v7, 27648, v4
  s_lshl_b32 s70, s21, 12
  s_mul_i32 s71, s21, 5120
  s_mov_b32 s68, 0
  s_add_u32 m0, s70, 20480
  s_nop 0
  buffer_load_dwordx4 v4, s[8:11], s68 offen lds
  buffer_load_dwordx4 v5, s[8:11], s68 offen offset:1024 lds
  buffer_load_dwordx4 v6, s[8:11], s68 offen offset:2048 lds
  buffer_load_dwordx4 v7, s[8:11], s68 offen offset:3072 lds
  s_add_u32 s68, s68, 128
  s_lshl_b32 s30, s23, 8
  s_mul_i32 s31, s23, 192
  s_add_u32 s31, s31, 768
  s_lshl_b32 s32, s23, 6
  s_lshl_b32 s33, s23, 7
  s_sub_u32 s33, s33, 704
  s_cmp_eq_u32 s64, 0
  s_cselect_b32 s30, s30, s31
  s_cselect_b32 s32, s32, s33
  s_cselect_b32 s33, 16, 12
  s_add_u32 s34, s42, s30
  s_addc_u32 s35, s43, 0
  s_add_u32 s36, s48, s32
  s_addc_u32 s37, s49, 0
  s_sub_u32 s36, s36, 256
  s_subb_u32 s37, s37, 0
  s_mul_i32 s30, s21, 320
  v_mov_b32 v36, s34
  v_mov_b32 v37, s35
  v_mov_b32 v38, s36
  v_mov_b32 v39, s37
  v_mov_b32 v40, 3840
  v_mov_b32 v41, 1280
  v_add_u32 v28, s30, v1
  v_mul_u32_u24 v29, 3277, v28
  v_lshrrev_b32 v29, 16, v29
  v_mul_u32_u24 v30, 20, v29
  v_sub_u32 v30, v28, v30
  v_lshrrev_b32 v31, 1, v29
  v_and_b32 v31, 2, v31
  v_xor_b32 v31, v30, v31
  v_cmp_gt_u32 vcc, s33, v31
  v_and_b32 v32, 0x73, v29
  v_and_b32 v28, 4, v29
  v_lshl_or_b32 v32, v28, 1, v32
  v_and_b32 v28, 8, v29
  v_lshrrev_b32 v28, 1, v28
  v_or_b32 v32, v32, v28
  v_cndmask_b32 v33, v41, v40, vcc
  v_cndmask_b32 v8, v38, v36, vcc
  v_cndmask_b32 v9, v39, v37, vcc
  v_mul_u32_u24 v32, v32, v33
  v_lshl_add_u32 v34, v31, 4, v32
  v_mov_b32 v35, 0
  v_lshl_add_u64 v[8:9], v[34:35], 0, v[8:9]
  v_lshlrev_b32 v18, 6, v33
  v_mov_b32 v19, 0
  s_add_u32 m0, s71, 0
  s_nop 0
  global_load_lds_dwordx4 v[8:9], off
  v_lshl_add_u64 v[8:9], v[18:19], 0, v[8:9]
  v_add_u32 v28, s30, v1
  v_add_u32 v28, 64, v28
  v_mul_u32_u24 v29, 3277, v28
  v_lshrrev_b32 v29, 16, v29
  v_mul_u32_u24 v30, 20, v29
  v_sub_u32 v30, v28, v30
  v_lshrrev_b32 v31, 1, v29
  v_and_b32 v31, 2, v31
  v_xor_b32 v31, v30, v31
  v_cmp_gt_u32 vcc, s33, v31
  v_and_b32 v32, 0x73, v29
  v_and_b32 v28, 4, v29
  v_lshl_or_b32 v32, v28, 1, v32
  v_and_b32 v28, 8, v29
  v_lshrrev_b32 v28, 1, v28
  v_or_b32 v32, v32, v28
  v_cndmask_b32 v33, v41, v40, vcc
  v_cndmask_b32 v10, v38, v36, vcc
  v_cndmask_b32 v11, v39, v37, vcc
  v_mul_u32_u24 v32, v32, v33
  v_lshl_add_u32 v34, v31, 4, v32
  v_mov_b32 v35, 0
  v_lshl_add_u64 v[10:11], v[34:35], 0, v[10:11]
  v_lshlrev_b32 v20, 6, v33
  v_mov_b32 v21, 0
  s_add_u32 m0, s71, 1024
  s_nop 0
  global_load_lds_dwordx4 v[10:11], off
  v_lshl_add_u64 v[10:11], v[20:21], 0, v[10:11]
  v_add_u32 v28, s30, v1
  v_add_u32 v28, 128, v28
  v_mul_u32_u24 v29, 3277, v28
  v_lshrrev_b32 v29, 16, v29
  v_mul_u32_u24 v30, 20, v29
  v_sub_u32 v30, v28, v30
  v_lshrrev_b32 v31, 1, v29
  v_and_b32 v31, 2, v31
  v_xor_b32 v31, v30, v31
  v_cmp_gt_u32 vcc, s33, v31
  v_and_b32 v32, 0x73, v29
  v_and_b32 v28, 4, v29
  v_lshl_or_b32 v32, v28, 1, v32
  v_and_b32 v28, 8, v29
  v_lshrrev_b32 v28, 1, v28
  v_or_b32 v32, v32, v28
  v_cndmask_b32 v33, v41, v40, vcc
  v_cndmask_b32 v12, v38, v36, vcc
  v_cndmask_b32 v13, v39, v37, vcc
  v_mul_u32_u24 v32, v32, v33
  v_lshl_add_u32 v34, v31, 4, v32
  v_mov_b32 v35, 0
  v_lshl_add_u64 v[12:13], v[34:35], 0, v[12:13]
  v_lshlrev_b32 v22, 6, v33
  v_mov_b32 v23, 0
  s_add_u32 m0, s71, 2048
  s_nop 0
  global_load_lds_dwordx4 v[12:13], off
  v_lshl_add_u64 v[12:13], v[22:23], 0, v[12:13]
  v_add_u32 v28, s30, v1
  v_add_u32 v28, 192, v28
  v_mul_u32_u24 v29, 3277, v28
  v_lshrrev_b32 v29, 16, v29
  v_mul_u32_u24 v30, 20, v29
  v_sub_u32 v30, v28, v30
  v_lshrrev_b32 v31, 1, v29
  v_and_b32 v31, 2, v31
  v_xor_b32 v31, v30, v31
  v_cmp_gt_u32 vcc, s33, v31
  v_and_b32 v32, 0x73, v29
  v_and_b32 v28, 4, v29
  v_lshl_or_b32 v32, v28, 1, v32
  v_and_b32 v28, 8, v29
  v_lshrrev_b32 v28, 1, v28
  v_or_b32 v32, v32, v28
  v_cndmask_b32 v33, v41, v40, vcc
  v_cndmask_b32 v14, v38, v36, vcc
  v_cndmask_b32 v15, v39, v37, vcc
  v_mul_u32_u24 v32, v32, v33
  v_lshl_add_u32 v34, v31, 4, v32
  v_mov_b32 v35, 0
  v_lshl_add_u64 v[14:15], v[34:35], 0, v[14:15]
  v_lshlrev_b32 v24, 6, v33
  v_mov_b32 v25, 0
  s_add_u32 m0, s71, 3072
  s_nop 0
  global_load_lds_dwordx4 v[14:15], off
  v_lshl_add_u64 v[14:15], v[24:25], 0, v[14:15]
  v_add_u32 v28, s30, v1
  v_add_u32 v28, 256, v28
  v_mul_u32_u24 v29, 3277, v28
  v_lshrrev_b32 v29, 16, v29
  v_mul_u32_u24 v30, 20, v29
  v_sub_u32 v30, v28, v30
  v_lshrrev_b32 v31, 1, v29
  v_and_b32 v31, 2, v31
  v_xor_b32 v31, v30, v31
  v_cmp_gt_u32 vcc, s33, v31
  v_and_b32 v32, 0x73, v29
  v_and_b32 v28, 4, v29
  v_lshl_or_b32 v32, v28, 1, v32
  v_and_b32 v28, 8, v29
  v_lshrrev_b32 v28, 1, v28
  v_or_b32 v32, v32, v28
  v_cndmask_b32 v33, v41, v40, vcc
  v_cndmask_b32 v16, v38, v36, vcc
  v_cndmask_b32 v17, v39, v37, vcc
  v_mul_u32_u24 v32, v32, v33
  v_lshl_add_u32 v34, v31, 4, v32
  v_mov_b32 v35, 0
  v_lshl_add_u64 v[16:17], v[34:35], 0, v[16:17]
  v_lshlrev_b32 v26, 6, v33
  v_mov_b32 v27, 0
  s_add_u32 m0, s71, 4096
  s_nop 0
  global_load_lds_dwordx4 v[16:17], off
  v_lshl_add_u64 v[16:17], v[26:27], 0, v[16:17]
  s_add_u32 m0, s70, 57344
  s_nop 0
  buffer_load_dwordx4 v4, s[8:11], s68 offen lds
  buffer_load_dwordx4 v5, s[8:11], s68 offen offset:1024 lds
  buffer_load_dwordx4 v6, s[8:11], s68 offen offset:2048 lds
  buffer_load_dwordx4 v7, s[8:11], s68 offen offset:3072 lds
  s_add_u32 s68, s68, 128
  s_add_u32 m0, s71, 36864
  s_nop 0
  global_load_lds_dwordx4 v[8:9], off
  v_lshl_add_u64 v[8:9], v[18:19], 0, v[8:9]
  s_add_u32 m0, s71, 37888
  s_nop 0
  global_load_lds_dwordx4 v[10:11], off
  v_lshl_add_u64 v[10:11], v[20:21], 0, v[10:11]
  s_add_u32 m0, s71, 38912
  s_nop 0
  global_load_lds_dwordx4 v[12:13], off
  v_lshl_add_u64 v[12:13], v[22:23], 0, v[12:13]
  s_add_u32 m0, s71, 39936
  s_nop 0
  global_load_lds_dwordx4 v[14:15], off
  v_lshl_add_u64 v[14:15], v[24:25], 0, v[14:15]
  s_add_u32 m0, s71, 40960
  s_nop 0
  global_load_lds_dwordx4 v[16:17], off
  v_lshl_add_u64 v[16:17], v[26:27], 0, v[16:17]
  s_add_u32 m0, s70, 94208
  s_nop 0
  buffer_load_dwordx4 v4, s[8:11], s68 offen lds
  buffer_load_dwordx4 v5, s[8:11], s68 offen offset:1024 lds
  buffer_load_dwordx4 v6, s[8:11], s68 offen offset:2048 lds
  buffer_load_dwordx4 v7, s[8:11], s68 offen offset:3072 lds
  s_add_u32 s68, s68, 128
  s_add_u32 m0, s71, 73728
  s_nop 0
  global_load_lds_dwordx4 v[8:9], off
  v_lshl_add_u64 v[8:9], v[18:19], 0, v[8:9]
  s_add_u32 m0, s71, 74752
  s_nop 0
  global_load_lds_dwordx4 v[10:11], off
  v_lshl_add_u64 v[10:11], v[20:21], 0, v[10:11]
  s_add_u32 m0, s71, 75776
  s_nop 0
  global_load_lds_dwordx4 v[12:13], off
  v_lshl_add_u64 v[12:13], v[22:23], 0, v[12:13]
  s_add_u32 m0, s71, 76800
  s_nop 0
  global_load_lds_dwordx4 v[14:15], off
  v_lshl_add_u64 v[14:15], v[24:25], 0, v[14:15]
  s_add_u32 m0, s71, 77824
  s_nop 0
  global_load_lds_dwordx4 v[16:17], off
  v_lshl_add_u64 v[16:17], v[26:27], 0, v[16:17]
  s_waitcnt vmcnt(18)
  s_barrier
  s_add_u32 m0, s70, 131072
  s_nop 0
  buffer_load_dwordx4 v4, s[8:11], s68 offen lds
  buffer_load_dwordx4 v5, s[8:11], s68 offen offset:1024 lds
  buffer_load_dwordx4 v6, s[8:11], s68 offen offset:2048 lds
  buffer_load_dwordx4 v7, s[8:11], s68 offen offset:3072 lds
  s_add_u32 s68, s68, 128
  s_add_u32 m0, s71, 110592
  s_nop 0
  global_load_lds_dwordx4 v[8:9], off
  v_lshl_add_u64 v[8:9], v[18:19], 0, v[8:9]
  s_add_u32 m0, s71, 111616
  s_nop 0
  global_load_lds_dwordx4 v[10:11], off
  v_lshl_add_u64 v[10:11], v[20:21], 0, v[10:11]
  s_add_u32 m0, s71, 112640
  s_nop 0
  global_load_lds_dwordx4 v[12:13], off
  v_lshl_add_u64 v[12:13], v[22:23], 0, v[12:13]
  s_add_u32 m0, s71, 113664
  s_nop 0
  global_load_lds_dwordx4 v[14:15], off
  v_lshl_add_u64 v[14:15], v[24:25], 0, v[14:15]
  s_add_u32 m0, s71, 114688
  s_nop 0
  global_load_lds_dwordx4 v[16:17], off
  v_lshl_add_u64 v[16:17], v[26:27], 0, v[16:17]
  s_mov_b32 s16, s60
  s_mov_b32 s17, s61
  s_mov_b32 s18, 0x100
  s_mov_b32 s19, 0x20000
  v_mov_b32 v48, 0
  buffer_load_dwordx2 v[64:65], v48, s[16:19], 0 offen sc1
  v_lshlrev_b32 v66, 4, v1
  s_mul_i32 s69, s66, 102400
  s_add_u32 s69, s69, s71
  s_add_u32 s69, s69, 0x1c00000
  s_lshl_b32 s39, s21, 11
  s_waitcnt vmcnt(19)
  s_barrier
  s_add_u32 m0, s70, 20480
  s_nop 0
  buffer_load_dwordx4 v4, s[8:11], s68 offen lds
  buffer_load_dwordx4 v5, s[8:11], s68 offen offset:1024 lds
  buffer_load_dwordx4 v6, s[8:11], s68 offen offset:2048 lds
  buffer_load_dwordx4 v7, s[8:11], s68 offen offset:3072 lds
  s_add_u32 s68, s68, 128
  s_add_u32 m0, s71, 0
  s_nop 0
  global_load_lds_dwordx4 v[8:9], off
  v_lshl_add_u64 v[8:9], v[18:19], 0, v[8:9]
  s_add_u32 m0, s71, 1024
  s_nop 0
  global_load_lds_dwordx4 v[10:11], off
  v_lshl_add_u64 v[10:11], v[20:21], 0, v[10:11]
  s_add_u32 m0, s71, 2048
  s_nop 0
  global_load_lds_dwordx4 v[12:13], off
  v_lshl_add_u64 v[12:13], v[22:23], 0, v[12:13]
  s_add_u32 m0, s71, 3072
  s_nop 0
  global_load_lds_dwordx4 v[14:15], off
  v_lshl_add_u64 v[14:15], v[24:25], 0, v[14:15]
  s_add_u32 m0, s71, 4096
  s_nop 0
  global_load_lds_dwordx4 v[16:17], off
  v_lshl_add_u64 v[16:17], v[26:27], 0, v[16:17]
  s_waitcnt vmcnt(19)
  s_barrier
  s_add_u32 m0, s70, 57344
  s_nop 0
  buffer_load_dwordx4 v4, s[8:11], s68 offen lds
  buffer_load_dwordx4 v5, s[8:11], s68 offen offset:1024 lds
  buffer_load_dwordx4 v6, s[8:11], s68 offen offset:2048 lds
  buffer_load_dwordx4 v7, s[8:11], s68 offen offset:3072 lds
  s_add_u32 s68, s68, 128
  s_add_u32 m0, s71, 36864
  s_nop 0
  global_load_lds_dwordx4 v[8:9], off
  v_lshl_add_u64 v[8:9], v[18:19], 0, v[8:9]
  s_add_u32 m0, s71, 37888
  s_nop 0
  global_load_lds_dwordx4 v[10:11], off
  v_lshl_add_u64 v[10:11], v[20:21], 0, v[10:11]
  s_add_u32 m0, s71, 38912
  s_nop 0
  global_load_lds_dwordx4 v[12:13], off
  v_lshl_add_u64 v[12:13], v[22:23], 0, v[12:13]
  s_add_u32 m0, s71, 39936
  s_nop 0
  global_load_lds_dwordx4 v[14:15], off
  v_lshl_add_u64 v[14:15], v[24:25], 0, v[14:15]
  s_add_u32 m0, s71, 40960
  s_nop 0
  global_load_lds_dwordx4 v[16:17], off
  v_lshl_add_u64 v[16:17], v[26:27], 0, v[16:17]
  s_waitcnt vmcnt(19)
  s_barrier
  s_add_u32 m0, s70, 94208
  s_nop 0
  buffer_load_dwordx4 v4, s[8:11], s68 offen lds
  buffer_load_dwordx4 v5, s[8:11], s68 offen offset:1024 lds
  buffer_load_dwordx4 v6, s[8:11], s68 offen offset:2048 lds
  buffer_load_dwordx4 v7, s[8:11], s68 offen offset:3072 lds
  s_add_u32 s68, s68, 128
  s_add_u32 m0, s71, 73728
  s_nop 0
  global_load_lds_dwordx4 v[8:9], off
  v_lshl_add_u64 v[8:9], v[18:19], 0, v[8:9]
  s_add_u32 m0, s71, 74752
  s_nop 0
  global_load_lds_dwordx4 v[10:11], off
  v_lshl_add_u64 v[10:11], v[20:21], 0, v[10:11]
  s_add_u32 m0, s71, 75776
  s_nop 0
  global_load_lds_dwordx4 v[12:13], off
  v_lshl_add_u64 v[12:13], v[22:23], 0, v[12:13]
  s_add_u32 m0, s71, 76800
  s_nop 0
  global_load_lds_dwordx4 v[14:15], off
  v_lshl_add_u64 v[14:15], v[24:25], 0, v[14:15]
  s_add_u32 m0, s71, 77824
  s_nop 0
  global_load_lds_dwordx4 v[16:17], off
  v_lshl_add_u64 v[16:17], v[26:27], 0, v[16:17]
  s_waitcnt vmcnt(18)
  s_barrier
  v_readfirstlane_b32 s26, v64
  v_readfirstlane_b32 s27, v65
  s_nop 3
  s_cmp_lg_u32 s26, 0
  s_cselect_b32 s30, 1, 0
  s_cmp_lg_u32 s27, 0
  s_cselect_b32 s31, 1, 0
  s_and_b32 s30, s30, s31
  s_cbranch_scc1 .nok_79
  s_mov_b32 s16, s60
  s_mov_b32 s17, s61
  s_mov_b32 s18, 0x100
  s_mov_b32 s19, 0x20000
  v_mov_b32 v28, 0
  s_mov_b32 s72, 0x40000
.non_80:
  buffer_load_dwordx2 v[30:31], v28, s[16:19], 0 offen sc1
  s_waitcnt vmcnt(0)
  v_readfirstlane_b32 s26, v30
  v_readfirstlane_b32 s27, v31
  s_nop 3
  s_cmp_lg_u32 s26, 0
  s_cselect_b32 s30, 1, 0
  s_cmp_lg_u32 s27, 0
  s_cselect_b32 s31, 1, 0
  s_and_b32 s30, s30, s31
  s_cbranch_scc1 .nond_81
  s_sleep 1
  s_sub_u32 s72, s72, 1
  s_cmp_lg_u32 s72, 0
  s_cbranch_scc1 .non_80
.nond_81:
.nok_79:
  v_mov_b32 v28, 162880
  v_mov_b32 v29, 1
  s_mov_b64 exec, 1
  ds_add_rtn_u32 v30, v28, v29
  s_mov_b64 exec, -1
  s_lshl_b32 s30, s24, 3
  s_add_u32 s30, s30, 0x1b60000
  s_waitcnt lgkmcnt(0)
  v_readfirstlane_b32 s31, v30
  v_mov_b32 v28, s30
  v_mov_b32 v30, s26
  v_mov_b32 v31, s27
  s_cmp_lg_u32 s31, 3
  s_cbranch_scc1 .sg_82
  s_mov_b64 exec, 1
  s_mov_b32 s30, 0
  buffer_store_dwordx2 v[30:31], v28, s[4:7], s30 offen sc1
  s_mov_b64 exec, -1
.sg_82:
  v_mov_b32 v28, 162816
  ds_write_b64 v28, v[30:31]
  s_add_u32 m0, s70, 131072
  s_nop 0
  buffer_load_dwordx4 v4, s[8:11], s68 offen lds
  buffer_load_dwordx4 v5, s[8:11], s68 offen offset:1024 lds
  buffer_load_dwordx4 v6, s[8:11], s68 offen offset:2048 lds
  buffer_load_dwordx4 v7, s[8:11], s68 offen offset:3072 lds
  s_add_u32 s68, s68, 128
  s_add_u32 m0, s71, 110592
  s_nop 0
  global_load_lds_dwordx4 v[8:9], off
  v_lshl_add_u64 v[8:9], v[18:19], 0, v[8:9]
  s_add_u32 m0, s71, 111616
  s_nop 0
  global_load_lds_dwordx4 v[10:11], off
  v_lshl_add_u64 v[10:11], v[20:21], 0, v[10:11]
  s_add_u32 m0, s71, 112640
  s_nop 0
  global_load_lds_dwordx4 v[12:13], off
  v_lshl_add_u64 v[12:13], v[22:23], 0, v[12:13]
  s_add_u32 m0, s71, 113664
  s_nop 0
  global_load_lds_dwordx4 v[14:15], off
  v_lshl_add_u64 v[14:15], v[24:25], 0, v[14:15]
  s_add_u32 m0, s71, 114688
  s_nop 0
  global_load_lds_dwordx4 v[16:17], off
  v_lshl_add_u64 v[16:17], v[26:27], 0, v[16:17]
  s_waitcnt vmcnt(18)
  s_barrier
  s_add_u32 m0, s70, 20480
  s_nop 0
  buffer_load_dwordx4 v4, s[8:11], s68 offen lds
  buffer_load_dwordx4 v5, s[8:11], s68 offen offset:1024 lds
  buffer_load_dwordx4 v6, s[8:11], s68 offen offset:2048 lds
  buffer_load_dwordx4 v7, s[8:11], s68 offen offset:3072 lds
  s_add_u32 s68, s68, 128
  s_add_u32 m0, s71, 0
  s_nop 0
  global_load_lds_dwordx4 v[8:9], off
  v_lshl_add_u64 v[8:9], v[18:19], 0, v[8:9]
  s_add_u32 m0, s71, 1024
  s_nop 0
  global_load_lds_dwordx4 v[10:11], off
  v_lshl_add_u64 v[10:11], v[20:21], 0, v[10:11]
  s_add_u32 m0, s71, 2048
  s_nop 0
  global_load_lds_dwordx4 v[12:13], off
  v_lshl_add_u64 v[12:13], v[22:23], 0, v[12:13]
  s_add_u32 m0, s71, 3072
  s_nop 0
  global_load_lds_dwordx4 v[14:15], off
  v_lshl_add_u64 v[14:15], v[24:25], 0, v[14:15]
  s_add_u32 m0, s71, 4096
  s_nop 0
  global_load_lds_dwordx4 v[16:17], off
  v_lshl_add_u64 v[16:17], v[26:27], 0, v[16:17]
  s_waitcnt vmcnt(18)
  s_barrier
  s_add_u32 m0, s70, 57344
  s_nop 0
  buffer_load_dwordx4 v4, s[8:11], s68 offen lds
  buffer_load_dwordx4 v5, s[8:11], s68 offen offset:1024 lds
  buffer_load_dwordx4 v6, s[8:11], s68 offen offset:2048 lds
  buffer_load_dwordx4 v7, s[8:11], s68 offen offset:3072 lds
  s_add_u32 s68, s68, 128
  s_add_u32 m0, s71, 36864
  s_nop 0
  global_load_lds_dwordx4 v[8:9], off
  v_lshl_add_u64 v[8:9], v[18:19], 0, v[8:9]
  s_add_u32 m0, s71, 37888
  s_nop 0
  global_load_lds_dwordx4 v[10:11], off
  v_lshl_add_u64 v[10:11], v[20:21], 0, v[10:11]
  s_add_u32 m0, s71, 38912
  s_nop 0
  global_load_lds_dwordx4 v[12:13], off
  v_lshl_add_u64 v[12:13], v[22:23], 0, v[12:13]
  s_add_u32 m0, s71, 39936
  s_nop 0
  global_load_lds_dwordx4 v[14:15], off
  v_lshl_add_u64 v[14:15], v[24:25], 0, v[14:15]
  s_add_u32 m0, s71, 40960
  s_nop 0
  global_load_lds_dwordx4 v[16:17], off
  v_lshl_add_u64 v[16:17], v[26:27], 0, v[16:17]
  s_mov_b32 s12, s56
  s_mov_b32 s13, s57
  s_mov_b32 s14, 0x500
  s_mov_b32 s15, 0x20000
  s_lshl_b32 s30, s24, 3
  s_lshl_b32 s31, s21, 1
  s_add_u32 s30, s30, s31
  v_lshrrev_b32 v240, 5, v1
  v_add_u32 v240, s30, v240
  v_and_b32 v241, 31, v1
  v_mul_u32_u24 v241, 40, v241
  v_mul_u32_u24 v242, 1280, v240
  v_add_u32 v242, v242, v241
  buffer_load_dwordx4 v[92:95], v242, s[8:11], 0 offen
  buffer_load_dwordx4 v[96:99], v242, s[8:11], 0 offen offset:16
  buffer_load_dwordx2 v[100:101], v242, s[8:11], 0 offen offset:32
  buffer_load_dwordx4 v[104:107], v241, s[12:15], 0 offen
  buffer_load_dwordx4 v[108:111], v241, s[12:15], 0 offen offset:16
  buffer_load_dwordx2 v[112:113], v241, s[12:15], 0 offen offset:32
  s_waitcnt vmcnt(24)
  s_barrier
  s_lshl_b32 s30, s21, 9
  s_add_u32 s30, s30, 0x1b60000
  v_lshl_add_u32 v52, v1, 3, s30
  buffer_load_dwordx2 v[56:57], v52, s[4:7], 0 offen sc1
  s_sub_u32 s33, s24, 40
  s_min_u32 s33, s33, 107
  s_mov_b32 s16, s52
  s_mov_b32 s17, s53
  s_mov_b32 s18, 0x21c000
  s_mov_b32 s19, 0x20000
  s_lshl_b32 s33, s33, 5
  s_lshl_b32 s34, s21, 5
  v_and_b32 v244, 31, v1
  v_add_u32 v244, s34, v244
  v_mul_u32_u24 v244, 3456, v244
  v_lshrrev_b32 v245, 5, v1
  v_lshlrev_b32 v245, 4, v245
  v_add3_u32 v244, v244, v245, s33
  s_sub_u32 s33, s24, 40
  s_cmp_lt_u32 s33, 108
  s_cselect_b32 s33, 0, 0x40000000
  v_add_u32 v244, s33, v244
  s_mov_b32 s34, 0
  buffer_load_dwordx4 v[156:159], v244, s[16:19], s34 offen
  s_mov_b32 s34, 442368
  buffer_load_dwordx4 v[160:163], v244, s[16:19], s34 offen
  s_mov_b32 s34, 884736
  buffer_load_dwordx4 v[164:167], v244, s[16:19], s34 offen
  s_mov_b32 s34, 1327104
  buffer_load_dwordx4 v[168:171], v244, s[16:19], s34 offen
  s_mov_b32 s34, 1769472
  buffer_load_dwordx4 v[172:175], v244, s[16:19], s34 offen
  s_lshl_b32 s30, s24, 2
  s_add_u32 s30, s30, s21
  s_mov_b32 s16, s44
  s_mov_b32 s17, s45
  s_mov_b32 s18, 0xc8000
  s_mov_b32 s19, 0x20000
  s_mul_i32 s31, s30, 6554
  s_lshr_b32 s31, s31, 16
  s_mul_i32 s32, s31, 10
  s_sub_u32 s32, s30, s32
  s_mul_i32 s33, s31, 6554
  s_lshr_b32 s33, s33, 16
  s_mul_i32 s34, s33, 10
  s_sub_u32 s34, s31, s34
  s_mul_i32 s35, s33, 38
  s_add_u32 s35, s35, s34
  s_mul_i32 s35, s35, 10
  s_add_u32 s35, s35, s32
  s_lshl_b32 s35, s35, 10
  s_add_u32 s35, s35, 0x1d00000
  s_mul_i32 s34, s34, 81920
  s_mul_i32 s33, s33, 160
  s_add_u32 s34, s34, s33
  s_cmp_lt_u32 s30, 800
  s_cselect_b32 s35, s35, 0x80000000
  s_cselect_b32 s34, s34, 0x40000000
  s_lshl_b32 s32, s32, 6
  v_lshl_add_u32 v220, v1, 4, s35
  v_add_u32 v28, s32, v1
  v_mul_u32_u24 v29, 6554, v28
  v_lshrrev_b32 v29, 16, v29
  v_mul_u32_u24 v30, 10, v29
  v_sub_u32 v30, v28, v30
  v_and_b32 v31, 0x73, v29
  v_and_b32 v28, 4, v29
  v_lshl_or_b32 v31, v28, 1, v31
  v_and_b32 v28, 8, v29
  v_lshrrev_b32 v28, 1, v28
  v_or_b32 v31, v31, v28
  v_mul_u32_u24 v31, 1280, v31
  v_lshl_add_u32 v31, v30, 4, v31
  buffer_load_dwordx4 v[188:191], v31, s[16:19], s34 offen
  s_lshl_b32 s30, s24, 2
  s_add_u32 s30, s30, s21
  s_mov_b32 s16, s54
  s_mov_b32 s17, s55
  s_mov_b32 s18, 0x21c000
  s_mov_b32 s19, 0x20000
  s_mul_i32 s31, s30, 6554
  s_lshr_b32 s31, s31, 16
  s_mul_i32 s32, s31, 10
  s_sub_u32 s32, s30, s32
  s_mul_i32 s33, s31, 2428
  s_lshr_b32 s33, s33, 16
  s_mul_i32 s34, s33, 27
  s_sub_u32 s34, s31, s34
  s_mul_i32 s35, s33, 38
  s_add_u32 s35, s35, s34
  s_add_u32 s35, s35, 10
  s_mul_i32 s35, s35, 10
  s_add_u32 s35, s35, s32
  s_lshl_b32 s35, s35, 10
  s_add_u32 s35, s35, 0x1d00000
  s_mul_i32 s34, s34, 81920
  s_mul_i32 s33, s33, 160
  s_add_u32 s34, s34, s33
  s_lshl_b32 s32, s32, 6
  v_lshl_add_u32 v221, v1, 4, s35
  v_add_u32 v28, s32, v1
  v_mul_u32_u24 v29, 6554, v28
  v_lshrrev_b32 v29, 16, v29
  v_mul_u32_u24 v30, 10, v29
  v_sub_u32 v30, v28, v30
  v_and_b32 v31, 0x73, v29
  v_and_b32 v28, 4, v29
  v_lshl_or_b32 v31, v28, 1, v31
  v_and_b32 v28, 8, v29
  v_lshrrev_b32 v28, 1, v28
  v_or_b32 v31, v31, v28
  v_mul_u32_u24 v31, 1280, v31
  v_lshl_add_u32 v31, v30, 4, v31
  buffer_load_dwordx4 v[192:195], v31, s[16:19], s34 offen
  s_lshl_b32 s30, s21, 4
  s_add_u32 s30, s30, s67
  s_mul_i32 s31, s30, 1280
  v_mul_u32_u24 v28, 1280, v50
  v_add3_u32 v28, v28, v51, s31
  v_cmp_gt_u32 vcc, 64, v51
  v_add_u32 v67, -1280, v28
  v_add_u32 v69, 1280, v28
  v_add_u32 v70, -2560, v28
  v_add_u32 v72, 2560, v28
  v_cndmask_b32 v68, v69, v67, vcc
  v_cndmask_b32 v71, v72, v70, vcc
  v_add_u32 v73, 7936, v28
  v_add_u32 v75, 10496, v28
  v_add_u32 v76, 6656, v28
  v_add_u32 v78, 11776, v28
  v_cndmask_b32 v74, v75, v73, vcc
  v_cndmask_b32 v77, v78, v76, vcc
  v_add_u32 v90, 0xe00000, v28
  v_add_u32 v91, 9216, v90
  s_mul_i32 s31, s30, 3456
  s_add_u32 s31, s31, 0x1400000
  v_mul_u32_u24 v28, 3456, v50
  v_add3_u32 v88, v28, v51, s31
  v_add_u32 v89, 26624, v88
  s_waitcnt vmcnt(7)
  v_cmp_ne_u64 vcc, s[26:27], v[56:57]
  s_cbranch_vccz .pok_83
  s_mov_b32 s72, 0x40000
.pl_84:
  buffer_load_dwordx2 v[56:57], v52, s[4:7], 0 offen sc1
  s_waitcnt vmcnt(0)
  v_cmp_ne_u64 vcc, s[26:27], v[56:57]
  s_cbranch_vccz .pd_85
  s_sleep 2
  s_sub_u32 s72, s72, 1
  s_cmp_lg_u32 s72, 0
  s_cbranch_scc1 .pl_84
.pd_85:
.pok_83:
  s_barrier
  s_lshl_b32 s30, s22, 6
  s_add_u32 s30, s30, 0x1b0c000
  v_and_b32 v28, 15, v1
  v_lshl_add_u32 v28, v28, 2, s30
  buffer_load_dword v56, v28, s[4:7], 0 offen sc1
  s_and_b32 s31, s21, 1
  s_lshl_b32 s31, s31, 10
  s_lshl_b32 s30, s22, 11
  s_add_u32 s30, s30, s31
  s_add_u32 s30, s30, 0x1b00000
  s_add_u32 m0, s31, 159744
  s_nop 0
  buffer_load_dwordx4 v66, s[4:7], s30 offen sc1 lds
  s_add_u32 m0, s71, 73728
  s_nop 0
  buffer_load_dwordx4 v66, s[4:7], s69 offen sc1 lds
  buffer_load_dwordx4 v66, s[4:7], s69 offen offset:1024 sc1 lds
  buffer_load_dwordx4 v66, s[4:7], s69 offen offset:2048 sc1 lds
  buffer_load_dwordx4 v66, s[4:7], s69 offen offset:3072 sc1 lds
  s_add_u32 m0, s71, 77824
  s_add_u32 s38, s69, 4096
  buffer_load_dwordx4 v66, s[4:7], s38 offen sc1 lds
  s_add_u32 s69, s69, 20480
  s_lshl_b32 s30, s24, 2
  s_add_u32 s30, s30, s21
  s_add_u32 s30, s30, 1024
  s_mov_b32 s16, s54
  s_mov_b32 s17, s55
  s_mov_b32 s18, 0x21c000
  s_mov_b32 s19, 0x20000
  s_mul_i32 s31, s30, 6554
  s_lshr_b32 s31, s31, 16
  s_mul_i32 s32, s31, 10
  s_sub_u32 s32, s30, s32
  s_mul_i32 s33, s31, 2428
  s_lshr_b32 s33, s33, 16
  s_mul_i32 s34, s33, 27
  s_sub_u32 s34, s31, s34
  s_mul_i32 s35, s33, 38
  s_add_u32 s35, s35, s34
  s_add_u32 s35, s35, 10
  s_mul_i32 s35, s35, 10
  s_add_u32 s35, s35, s32
  s_lshl_b32 s35, s35, 10
  s_add_u32 s35, s35, 0x1d00000
  s_mul_i32 s34, s34, 81920
  s_mul_i32 s33, s33, 160
  s_add_u32 s34, s34, s33
  s_lshl_b32 s32, s32, 6
  v_lshl_add_u32 v222, v1, 4, s35
  v_add_u32 v28, s32, v1
  v_mul_u32_u24 v29, 6554, v28
  v_lshrrev_b32 v29, 16, v29
  v_mul_u32_u24 v30, 10, v29
  v_sub_u32 v30, v28, v30
  v_and_b32 v31, 0x73, v29
  v_and_b32 v28, 4, v29
  v_lshl_or_b32 v31, v28, 1, v31
  v_and_b32 v28, 8, v29
  v_lshrrev_b32 v28, 1, v28
  v_or_b32 v31, v31, v28
  v_mul_u32_u24 v31, 1280, v31
  v_lshl_add_u32 v31, v30, 4, v31
  buffer_load_dwordx4 v[196:199], v31, s[16:19], s34 offen
  s_lshl_b32 s30, s24, 2
  s_add_u32 s30, s30, s21
  s_add_u32 s30, s30, 2048
  s_mov_b32 s16, s54
  s_mov_b32 s17, s55
  s_mov_b32 s18, 0x21c000
  s_mov_b32 s19, 0x20000
  s_mul_i32 s31, s30, 6554
  s_lshr_b32 s31, s31, 16
  s_mul_i32 s32, s31, 10
  s_sub_u32 s32, s30, s32
  s_mul_i32 s33, s31, 2428
  s_lshr_b32 s33, s33, 16
  s_mul_i32 s34, s33, 27
  s_sub_u32 s34, s31, s34
  s_mul_i32 s35, s33, 38
  s_add_u32 s35, s35, s34
  s_add_u32 s35, s35, 10
  s_mul_i32 s35, s35, 10
  s_add_u32 s35, s35, s32
  s_lshl_b32 s35, s35, 10
  s_add_u32 s35, s35, 0x1d00000
  s_mul_i32 s34, s34, 81920
  s_mul_i32 s33, s33, 160
  s_add_u32 s34, s34, s33
  s_cmp_lt_u32 s30, 2160
  s_cselect_b32 s35, s35, 0x80000000
  s_cselect_b32 s34, s34, 0x40000000
  s_lshl_b32 s32, s32, 6
  v_lshl_add_u32 v223, v1, 4, s35
  v_add_u32 v28, s32, v1
  v_mul_u32_u24 v29, 6554, v28
  v_lshrrev_b32 v29, 16, v29
  v_mul_u32_u24 v30, 10, v29
  v_sub_u32 v30, v28, v30
  v_and_b32 v31, 0x73, v29
  v_and_b32 v28, 4, v29
  v_lshl_or_b32 v31, v28, 1, v31
  v_and_b32 v28, 8, v29
  v_lshrrev_b32 v28, 1, v28
  v_or_b32 v31, v31, v28
  v_mul_u32_u24 v31, 1280, v31
  v_lshl_add_u32 v31, v30, 4, v31
  buffer_load_dwordx4 v[200:203], v31, s[16:19], s34 offen
  s_barrier
  s_getreg_b32 s30, hwreg(HW_REG_XCC_ID)
  s_waitcnt vmcnt(8)
  v_cmp_ne_u32 vcc, s30, v56
  s_cmp_eq_u64 vcc, 0
  s_cselect_b32 s25, 1, 0
  v_mov_b32 v28, 162816
  v_mov_b32 v29, s25
  ds_write_b32 v28, v29 offset:8
  s_add_u32 m0, s71, 110592
  s_nop 0
  buffer_load_dwordx4 v66, s[4:7], s69 offen sc1 lds
  buffer_load_dwordx4 v66, s[4:7], s69 offen offset:1024 sc1 lds
  buffer_load_dwordx4 v66, s[4:7], s69 offen offset:2048 sc1 lds
  buffer_load_dwordx4 v66, s[4:7], s69 offen offset:3072 sc1 lds
  s_add_u32 m0, s71, 114688
  s_add_u32 s38, s69, 4096
  buffer_load_dwordx4 v66, s[4:7], s38 offen sc1 lds
  s_add_u32 s69, s69, 20480
  s_waitcnt vmcnt(12) lgkmcnt(0)
  s_barrier
  s_add_u32 m0, s71, 0
  s_nop 0
  buffer_load_dwordx4 v66, s[4:7], s69 offen sc1 lds
  buffer_load_dwordx4 v66, s[4:7], s69 offen offset:1024 sc1 lds
  buffer_load_dwordx4 v66, s[4:7], s69 offen offset:2048 sc1 lds
  buffer_load_dwordx4 v66, s[4:7], s69 offen offset:3072 sc1 lds
  s_add_u32 m0, s71, 4096
  s_add_u32 s38, s69, 4096
  buffer_load_dwordx4 v66, s[4:7], s38 offen sc1 lds
  s_add_u32 s69, s69, 20480
  s_add_u32 m0, s71, 36864
  s_nop 0
  buffer_load_dwordx4 v66, s[4:7], s69 offen sc1 lds
  buffer_load_dwordx4 v66, s[4:7], s69 offen offset:1024 sc1 lds
  buffer_load_dwordx4 v66, s[4:7], s69 offen offset:2048 sc1 lds
  buffer_load_dwordx4 v66, s[4:7], s69 offen offset:3072 sc1 lds
  s_add_u32 m0, s71, 40960
  s_add_u32 s38, s69, 4096
  buffer_load_dwordx4 v66, s[4:7], s38 offen sc1 lds
  s_add_u32 s69, s69, 20480
  buffer_store_dwordx4 v[188:191], v220, s[4:7], 0 offen sc1
  buffer_store_dwordx4 v[192:195], v221, s[4:7], 0 offen sc1
  v_lshlrev_b32 v116, 16, v92
  v_and_b32 v117, 0xffff0000, v92
  v_lshlrev_b32 v136, 16, v104
  v_and_b32 v137, 0xffff0000, v104
  v_lshlrev_b32 v118, 16, v93
  v_and_b32 v119, 0xffff0000, v93
  v_lshlrev_b32 v138, 16, v105
  v_and_b32 v139, 0xffff0000, v105
  v_lshlrev_b32 v120, 16, v94
  v_and_b32 v121, 0xffff0000, v94
  v_lshlrev_b32 v140, 16, v106
  v_and_b32 v141, 0xffff0000, v106
  v_lshlrev_b32 v122, 16, v95
  v_and_b32 v123, 0xffff0000, v95
  v_lshlrev_b32 v142, 16, v107
  v_and_b32 v143, 0xffff0000, v107
  v_lshlrev_b32 v124, 16, v96
  v_and_b32 v125, 0xffff0000, v96
  v_lshlrev_b32 v144, 16, v108
  v_and_b32 v145, 0xffff0000, v108
  v_lshlrev_b32 v126, 16, v97
  v_and_b32 v127, 0xffff0000, v97
  v_lshlrev_b32 v146, 16, v109
  v_and_b32 v147, 0xffff0000, v109
  v_lshlrev_b32 v128, 16, v98
  v_and_b32 v129, 0xffff0000, v98
  v_lshlrev_b32 v148, 16, v110
  v_and_b32 v149, 0xffff0000, v110
  v_lshlrev_b32 v130, 16, v99
  v_and_b32 v131, 0xffff0000, v99
  v_lshlrev_b32 v150, 16, v111
  v_and_b32 v151, 0xffff0000, v111
  v_lshlrev_b32 v132, 16, v100
  v_and_b32 v133, 0xffff0000, v100
  v_lshlrev_b32 v152, 16, v112
  v_and_b32 v153, 0xffff0000, v112
  v_lshlrev_b32 v134, 16, v101
  v_and_b32 v135, 0xffff0000, v101
  v_lshlrev_b32 v154, 16, v113
  v_and_b32 v155, 0xffff0000, v113
  v_pk_mul_f32 v[136:137], v[136:137], v[116:117]
  v_pk_mul_f32 v[138:139], v[138:139], v[118:119]
  v_pk_mul_f32 v[140:141], v[140:141], v[120:121]
  v_pk_mul_f32 v[142:143], v[142:143], v[122:123]
  v_pk_mul_f32 v[144:145], v[144:145], v[124:125]
  v_pk_mul_f32 v[146:147], v[146:147], v[126:127]
  v_pk_mul_f32 v[148:149], v[148:149], v[128:129]
  v_pk_mul_f32 v[150:151], v[150:151], v[130:131]
  v_pk_mul_f32 v[152:153], v[152:153], v[132:133]
  v_pk_mul_f32 v[154:155], v[154:155], v[134:135]
  v_cvt_pk_bf16_f32 v248, v136, v137
  v_lshlrev_b32 v136, 16, v248
  v_and_b32 v137, 0xffff0000, v248
  v_cvt_pk_bf16_f32 v248, v138, v139
  v_lshlrev_b32 v138, 16, v248
  v_and_b32 v139, 0xffff0000, v248
  v_cvt_pk_bf16_f32 v248, v140, v141
  v_lshlrev_b32 v140, 16, v248
  v_and_b32 v141, 0xffff0000, v248
  v_cvt_pk_bf16_f32 v248, v142, v143
  v_lshlrev_b32 v142, 16, v248
  v_and_b32 v143, 0xffff0000, v248
  v_cvt_pk_bf16_f32 v248, v144, v145
  v_lshlrev_b32 v144, 16, v248
  v_and_b32 v145, 0xffff0000, v248
  v_cvt_pk_bf16_f32 v248, v146, v147
  v_lshlrev_b32 v146, 16, v248
  v_and_b32 v147, 0xffff0000, v248
  v_cvt_pk_bf16_f32 v248, v148, v149
  v_lshlrev_b32 v148, 16, v248
  v_and_b32 v149, 0xffff0000, v248
  v_cvt_pk_bf16_f32 v248, v150, v151
  v_lshlrev_b32 v150, 16, v248
  v_and_b32 v151, 0xffff0000, v248
  v_cvt_pk_bf16_f32 v248, v152, v153
  v_lshlrev_b32 v152, 16, v248
  v_and_b32 v153, 0xffff0000, v248
  v_cvt_pk_bf16_f32 v248, v154, v155
  v_lshlrev_b32 v154, 16, v248
  v_and_b32 v155, 0xffff0000, v248
  v_pk_add_f32 v[250:251], v[136:137], v[138:139]
  v_pk_add_f32 v[250:251], v[250:251], v[140:141]
  v_pk_add_f32 v[250:251], v[250:251], v[142:143]
  v_pk_add_f32 v[250:251], v[250:251], v[144:145]
  v_pk_add_f32 v[250:251], v[250:251], v[146:147]
  v_pk_add_f32 v[250:251], v[250:251], v[148:149]
  v_pk_add_f32 v[250:251], v[250:251], v[150:151]
  v_pk_add_f32 v[250:251], v[250:251], v[152:153]
  v_pk_add_f32 v[250:251], v[250:251], v[154:155]
  v_add_f32 v246, v250, v251
  s_nop 1
  v_add_f32_dpp v246, v246, v246 quad_perm:[1,0,3,2] row_mask:0xf bank_mask:0xf
  s_nop 1
  v_add_f32_dpp v246, v246, v246 quad_perm:[2,3,0,1] row_mask:0xf bank_mask:0xf
  s_nop 1
  v_add_f32_dpp v246, v246, v246 row_half_mirror row_mask:0xf bank_mask:0xf
  s_nop 1
  v_add_f32_dpp v246, v246, v246 row_mirror row_mask:0xf bank_mask:0xf
  v_mov_b32 v248, v246
  s_nop 1
  v_permlane16_swap_b32 v246, v248
  v_add_f32 v246, v246, v248
  v_cvt_pk_bf16_f32 v248, v246, v246
  v_lshlrev_b32 v246, 16, v248
  v_mul_f32 v246, 0xbfb8aa3b, v246
  v_exp_f32 v246, v246
  s_nop 0
  v_add_f32 v246, 1.0, v246
  v_rcp_f32 v246, v246
  s_nop 0
  v_cvt_pk_bf16_f32 v248, v246, v246
  v_lshlrev_b32 v246, 16, v248
  v_lshlrev_b32 v247, 2, v240
  v_add_u32 v247, 0x1b08000, v247
  v_lshlrev_b32 v228, 16, v156
  v_and_b32 v229, 0xffff0000, v156
  v_lshlrev_b32 v230, 16, v157
  v_and_b32 v231, 0xffff0000, v157
  v_lshlrev_b32 v232, 16, v158
  v_and_b32 v233, 0xffff0000, v158
  v_lshlrev_b32 v234, 16, v159
  v_and_b32 v235, 0xffff0000, v159
  v_lshlrev_b32 v136, 16, v160
  v_and_b32 v137, 0xffff0000, v160
  v_lshlrev_b32 v138, 16, v161
  v_and_b32 v139, 0xffff0000, v161
  v_lshlrev_b32 v140, 16, v162
  v_and_b32 v141, 0xffff0000, v162
  v_lshlrev_b32 v142, 16, v163
  v_and_b32 v143, 0xffff0000, v163
  v_pk_add_f32 v[228:229], v[228:229], v[136:137]
  v_pk_add_f32 v[230:231], v[230:231], v[138:139]
  v_pk_add_f32 v[232:233], v[232:233], v[140:141]
  v_pk_add_f32 v[234:235], v[234:235], v[142:143]
  v_lshlrev_b32 v136, 16, v164
  v_and_b32 v137, 0xffff0000, v164
  v_lshlrev_b32 v138, 16, v165
  v_and_b32 v139, 0xffff0000, v165
  v_lshlrev_b32 v140, 16, v166
  v_and_b32 v141, 0xffff0000, v166
  v_lshlrev_b32 v142, 16, v167
  v_and_b32 v143, 0xffff0000, v167
  v_pk_add_f32 v[228:229], v[228:229], v[136:137]
  v_pk_add_f32 v[230:231], v[230:231], v[138:139]
  v_pk_add_f32 v[232:233], v[232:233], v[140:141]
  v_pk_add_f32 v[234:235], v[234:235], v[142:143]
  v_lshlrev_b32 v136, 16, v168
  v_and_b32 v137, 0xffff0000, v168
  v_lshlrev_b32 v138, 16, v169
  v_and_b32 v139, 0xffff0000, v169
  v_lshlrev_b32 v140, 16, v170
  v_and_b32 v141, 0xffff0000, v170
  v_lshlrev_b32 v142, 16, v171
  v_and_b32 v143, 0xffff0000, v171
  v_pk_add_f32 v[228:229], v[228:229], v[136:137]
  v_pk_add_f32 v[230:231], v[230:231], v[138:139]
  v_pk_add_f32 v[232:233], v[232:233], v[140:141]
  v_pk_add_f32 v[234:235], v[234:235], v[142:143]
  v_lshlrev_b32 v136, 16, v172
  v_and_b32 v137, 0xffff0000, v172
  v_lshlrev_b32 v138, 16, v173
  v_and_b32 v139, 0xffff0000, v173
  v_lshlrev_b32 v140, 16, v174
  v_and_b32 v141, 0xffff0000, v174
  v_lshlrev_b32 v142, 16, v175
  v_and_b32 v143, 0xffff0000, v175
  v_pk_add_f32 v[228:229], v[228:229], v[136:137]
  v_pk_add_f32 v[230:231], v[230:231], v[138:139]
  v_pk_add_f32 v[232:233], v[232:233], v[140:141]
  v_pk_add_f32 v[234:235], v[234:235], v[142:143]
  s_nop 1
  v_add_f32_dpp v228, v228, v228 quad_perm:[1,0,3,2] row_mask:0xf bank_mask:0xf
  v_add_f32_dpp v229, v229, v229 quad_perm:[1,0,3,2] row_mask:0xf bank_mask:0xf
  v_add_f32_dpp v230, v230, v230 quad_perm:[1,0,3,2] row_mask:0xf bank_mask:0xf
  v_add_f32_dpp v231, v231, v231 quad_perm:[1,0,3,2] row_mask:0xf bank_mask:0xf
  v_add_f32_dpp v232, v232, v232 quad_perm:[1,0,3,2] row_mask:0xf bank_mask:0xf
  v_add_f32_dpp v233, v233, v233 quad_perm:[1,0,3,2] row_mask:0xf bank_mask:0xf
  v_add_f32_dpp v234, v234, v234 quad_perm:[1,0,3,2] row_mask:0xf bank_mask:0xf
  v_add_f32_dpp v235, v235, v235 quad_perm:[1,0,3,2] row_mask:0xf bank_mask:0xf
  s_nop 1
  v_add_f32_dpp v228, v228, v228 quad_perm:[2,3,0,1] row_mask:0xf bank_mask:0xf
  v_add_f32_dpp v229, v229, v229 quad_perm:[2,3,0,1] row_mask:0xf bank_mask:0xf
  v_add_f32_dpp v230, v230, v230 quad_perm:[2,3,0,1] row_mask:0xf bank_mask:0xf
  v_add_f32_dpp v231, v231, v231 quad_perm:[2,3,0,1] row_mask:0xf bank_mask:0xf
  v_add_f32_dpp v232, v232, v232 quad_perm:[2,3,0,1] row_mask:0xf bank_mask:0xf
  v_add_f32_dpp v233, v233, v233 quad_perm:[2,3,0,1] row_mask:0xf bank_mask:0xf
  v_add_f32_dpp v234, v234, v234 quad_perm:[2,3,0,1] row_mask:0xf bank_mask:0xf
  v_add_f32_dpp v235, v235, v235 quad_perm:[2,3,0,1] row_mask:0xf bank_mask:0xf
  s_nop 1
  v_add_f32_dpp v228, v228, v228 row_half_mirror row_mask:0xf bank_mask:0xf
  v_add_f32_dpp v229, v229, v229 row_half_mirror row_mask:0xf bank_mask:0xf
  v_add_f32_dpp v230, v230, v230 row_half_mirror row_mask:0xf bank_mask:0xf
  v_add_f32_dpp v231, v231, v231 row_half_mirror row_mask:0xf bank_mask:0xf
  v_add_f32_dpp v232, v232, v232 row_half_mirror row_mask:0xf bank_mask:0xf
  v_add_f32_dpp v233, v233, v233 row_half_mirror row_mask:0xf bank_mask:0xf
  v_add_f32_dpp v234, v234, v234 row_half_mirror row_mask:0xf bank_mask:0xf
  v_add_f32_dpp v235, v235, v235 row_half_mirror row_mask:0xf bank_mask:0xf
  s_nop 1
  v_add_f32_dpp v228, v228, v228 row_mirror row_mask:0xf bank_mask:0xf
  v_add_f32_dpp v229, v229, v229 row_mirror row_mask:0xf bank_mask:0xf
  v_add_f32_dpp v230, v230, v230 row_mirror row_mask:0xf bank_mask:0xf
  v_add_f32_dpp v231, v231, v231 row_mirror row_mask:0xf bank_mask:0xf
  v_add_f32_dpp v232, v232, v232 row_mirror row_mask:0xf bank_mask:0xf
  v_add_f32_dpp v233, v233, v233 row_mirror row_mask:0xf bank_mask:0xf
  v_add_f32_dpp v234, v234, v234 row_mirror row_mask:0xf bank_mask:0xf
  v_add_f32_dpp v235, v235, v235 row_mirror row_mask:0xf bank_mask:0xf
  v_mov_b32 v136, v228
  v_mov_b32 v137, v229
  v_mov_b32 v138, v230
  v_mov_b32 v139, v231
  v_mov_b32 v140, v232
  v_mov_b32 v141, v233
  v_mov_b32 v142, v234
  v_mov_b32 v143, v235
  s_nop 1
  v_permlane16_swap_b32 v228, v136
  v_permlane16_swap_b32 v229, v137
  v_permlane16_swap_b32 v230, v138
  v_permlane16_swap_b32 v231, v139
  v_permlane16_swap_b32 v232, v140
  v_permlane16_swap_b32 v233, v141
  v_permlane16_swap_b32 v234, v142
  v_permlane16_swap_b32 v235, v143
  v_add_f32 v228, v228, v136
  v_add_f32 v229, v229, v137
  v_add_f32 v230, v230, v138
  v_add_f32 v231, v231, v139
  v_add_f32 v232, v232, v140
  v_add_f32 v233, v233, v141
  v_add_f32 v234, v234, v142
  v_add_f32 v235, v235, v143
  buffer_store_dword v246, v247, s[4:7], 0 offen sc1
  s_mul_i32 s30, s21, 9728
  s_lshl_b32 s31, s24, 6
  s_add_u32 s30, s30, s31
  s_add_u32 s30, s30, 0x1b40000
  s_sub_u32 s33, s24, 40
  s_cmp_lt_u32 s33, 108
  s_cselect_b32 s30, s30, 0x80000000
  v_lshrrev_b32 v253, 5, v1
  v_lshl_add_u32 v253, v253, 5, s30
  buffer_store_dwordx4 v[228:231], v253, s[4:7], 0 offen sc1
  buffer_store_dwordx4 v[232:235], v253, s[4:7], 0 offen offset:16 sc1
  s_waitcnt vmcnt(20)
  buffer_store_dwordx4 v[196:199], v222, s[4:7], 0 offen sc1
  buffer_store_dwordx4 v[200:203], v223, s[4:7], 0 offen sc1
  s_mul_i32 s30, s67, 3840
  s_mul_i32 s31, s66, 160
  s_add_u32 s30, s30, s31
  s_mul_i32 s31, s21, 576
  v_add_u32 v28, s31, v1
  v_mul_u32_u24 v29, 6554, v28
  v_lshrrev_b32 v29, 16, v29
  v_mul_u32_u24 v30, 10, v29
  v_sub_u32 v30, v28, v30
  v_mul_u32_u24 v28, 3840, v29
  v_lshl_add_u32 v28, v30, 4, v28
  v_add_u32 v28, s30, v28
  v_cmp_le_u32 vcc, 64, v29
  v_add_u32 v30, -298240, v28
  s_nop 0
  v_cndmask_b32 v28, v28, v30, vcc
  v_cmp_le_u32 vcc, 142, v29
  v_add_u32 v30, -298240, v28
  s_nop 0
  v_cndmask_b32 v28, v28, v30, vcc
  v_mov_b32 v79, v28
  v_add_u32 v28, s31, v1
  v_add_u32 v28, 64, v28
  v_mul_u32_u24 v29, 6554, v28
  v_lshrrev_b32 v29, 16, v29
  v_mul_u32_u24 v30, 10, v29
  v_sub_u32 v30, v28, v30
  v_mul_u32_u24 v28, 3840, v29
  v_lshl_add_u32 v28, v30, 4, v28
  v_add_u32 v28, s30, v28
  v_cmp_le_u32 vcc, 64, v29
  v_add_u32 v30, -298240, v28
  s_nop 0
  v_cndmask_b32 v28, v28, v30, vcc
  v_cmp_le_u32 vcc, 142, v29
  v_add_u32 v30, -298240, v28
  s_nop 0
  v_cndmask_b32 v28, v28, v30, vcc
  v_mov_b32 v80, v28
  v_add_u32 v28, s31, v1
  v_add_u32 v28, 128, v28
  v_mul_u32_u24 v29, 6554, v28
  v_lshrrev_b32 v29, 16, v29
  v_mul_u32_u24 v30, 10, v29
  v_sub_u32 v30, v28, v30
  v_mul_u32_u24 v28, 3840, v29
  v_lshl_add_u32 v28, v30, 4, v28
  v_add_u32 v28, s30, v28
  v_cmp_le_u32 vcc, 64, v29
  v_add_u32 v30, -298240, v28
  s_nop 0
  v_cndmask_b32 v28, v28, v30, vcc
  v_cmp_le_u32 vcc, 142, v29
  v_add_u32 v30, -298240, v28
  s_nop 0
  v_cndmask_b32 v28, v28, v30, vcc
  v_mov_b32 v81, v28
  v_add_u32 v28, s31, v1
  v_add_u32 v28, 192, v28
  v_mul_u32_u24 v29, 6554, v28
  v_lshrrev_b32 v29, 16, v29
  v_mul_u32_u24 v30, 10, v29
  v_sub_u32 v30, v28, v30
  v_mul_u32_u24 v28, 3840, v29
  v_lshl_add_u32 v28, v30, 4, v28
  v_add_u32 v28, s30, v28
  v_cmp_le_u32 vcc, 64, v29
  v_add_u32 v30, -298240, v28
  s_nop 0
  v_cndmask_b32 v28, v28, v30, vcc
  v_cmp_le_u32 vcc, 142, v29
  v_add_u32 v30, -298240, v28
  s_nop 0
  v_cndmask_b32 v28, v28, v30, vcc
  v_mov_b32 v82, v28
  v_add_u32 v28, s31, v1
  v_add_u32 v28, 256, v28
  v_mul_u32_u24 v29, 6554, v28
  v_lshrrev_b32 v29, 16, v29
  v_mul_u32_u24 v30, 10, v29
  v_sub_u32 v30, v28, v30
  v_mul_u32_u24 v28, 3840, v29
  v_lshl_add_u32 v28, v30, 4, v28
  v_add_u32 v28, s30, v28
  v_cmp_le_u32 vcc, 64, v29
  v_add_u32 v30, -298240, v28
  s_nop 0
  v_cndmask_b32 v28, v28, v30, vcc
  v_cmp_le_u32 vcc, 142, v29
  v_add_u32 v30, -298240, v28
  s_nop 0
  v_cndmask_b32 v28, v28, v30, vcc
  v_mov_b32 v83, v28
  v_add_u32 v28, s31, v1
  v_add_u32 v28, 320, v28
  v_mul_u32_u24 v29, 6554, v28
  v_lshrrev_b32 v29, 16, v29
  v_mul_u32_u24 v30, 10, v29
  v_sub_u32 v30, v28, v30
  v_mul_u32_u24 v28, 3840, v29
  v_lshl_add_u32 v28, v30, 4, v28
  v_add_u32 v28, s30, v28
  v_cmp_le_u32 vcc, 64, v29
  v_add_u32 v30, -298240, v28
  s_nop 0
  v_cndmask_b32 v28, v28, v30, vcc
  v_cmp_le_u32 vcc, 142, v29
  v_add_u32 v30, -298240, v28
  s_nop 0
  v_cndmask_b32 v28, v28, v30, vcc
  v_mov_b32 v84, v28
  v_add_u32 v28, s31, v1
  v_add_u32 v28, 384, v28
  v_mul_u32_u24 v29, 6554, v28
  v_lshrrev_b32 v29, 16, v29
  v_mul_u32_u24 v30, 10, v29
  v_sub_u32 v30, v28, v30
  v_mul_u32_u24 v28, 3840, v29
  v_lshl_add_u32 v28, v30, 4, v28
  v_add_u32 v28, s30, v28
  v_cmp_le_u32 vcc, 64, v29
  v_add_u32 v30, -298240, v28
  s_nop 0
  v_cndmask_b32 v28, v28, v30, vcc
  v_cmp_le_u32 vcc, 142, v29
  v_add_u32 v30, -298240, v28
  s_nop 0
  v_cndmask_b32 v28, v28, v30, vcc
  v_mov_b32 v85, v28
  v_add_u32 v28, s31, v1
  v_add_u32 v28, 448, v28
  v_mul_u32_u24 v29, 6554, v28
  v_lshrrev_b32 v29, 16, v29
  v_mul_u32_u24 v30, 10, v29
  v_sub_u32 v30, v28, v30
  v_mul_u32_u24 v28, 3840, v29
  v_lshl_add_u32 v28, v30, 4, v28
  v_add_u32 v28, s30, v28
  v_cmp_le_u32 vcc, 64, v29
  v_add_u32 v30, -298240, v28
  s_nop 0
  v_cndmask_b32 v28, v28, v30, vcc
  v_cmp_le_u32 vcc, 142, v29
  v_add_u32 v30, -298240, v28
  s_nop 0
  v_cndmask_b32 v28, v28, v30, vcc
  v_mov_b32 v86, v28
  v_add_u32 v28, s31, v1
  v_add_u32 v28, 512, v28
  v_mul_u32_u24 v29, 6554, v28
  v_lshrrev_b32 v29, 16, v29
  v_mul_u32_u24 v30, 10, v29
  v_sub_u32 v30, v28, v30
  v_mul_u32_u24 v28, 3840, v29
  v_lshl_add_u32 v28, v30, 4, v28
  v_add_u32 v28, s30, v28
  v_cmp_le_u32 vcc, 64, v29
  v_add_u32 v30, -298240, v28
  s_nop 0
  v_cndmask_b32 v28, v28, v30, vcc
  v_cmp_le_u32 vcc, 142, v29
  v_add_u32 v30, -298240, v28
  s_nop 0
  v_cndmask_b32 v28, v28, v30, vcc
  v_mov_b32 v87, v28
  s_add_u32 s8, s62, 0x800000
  s_addc_u32 s9, s63, 0
  s_mov_b32 s10, 0x280000
  s_mov_b32 s11, 0x20000
  s_lshl_b32 s36, s22, 4
  s_lshl_b32 s35, s65, 1
  s_add_u32 s35, s35, s22
  s_sub_u32 s35, s35, 1
  s_cmp_gt_u32 s35, 15
  s_cselect_b32 s35, s22, s35
  s_lshl_b32 s35, s35, 4
  v_mov_b32 v58, 162944
  s_cmp_lg_u32 s21, 0
  s_cbranch_scc1 .lw_86
  v_and_b32 v52, 15, v1
  v_lshlrev_b32 v52, 3, v52
  s_lshl_b32 s30, s36, 3
  s_add_u32 s30, s30, 0x1b6e000
  v_mov_b32 v53, s30
  s_lshl_b32 s30, s35, 3
  s_add_u32 s30, s30, 0x1b62000
  v_cmp_le_u32 vcc, 16, v1
  v_mov_b32 v54, s30
  s_nop 0
  v_cndmask_b32 v53, v53, v54, vcc
  v_add_u32 v52, v52, v53
  s_mov_b32 s72, 0x40000
.pl_89:
  buffer_load_dwordx2 v[56:57], v52, s[4:7], 0 offen sc1
  s_waitcnt vmcnt(0)
  v_cmp_ne_u64 vcc, s[26:27], v[56:57]
  s_cbranch_vccz .pd_90
  s_sleep 2
  s_sub_u32 s72, s72, 1
  s_cmp_lg_u32 s72, 0
  s_cbranch_scc1 .pl_89
.pd_90:
  v_mov_b32 v59, 1
  ds_write_b32 v58, v59
  s_branch .lwd_87
.lw_86:
  s_mov_b32 s72, 0x1000000
.lwl_88:
  ds_read_b32 v56, v58
  s_waitcnt lgkmcnt(0)
  v_readfirstlane_b32 s30, v56
  s_nop 3
  s_cmp_lg_u32 s30, 0
  s_cbranch_scc1 .lwd_87
  s_sleep 1
  s_sub_u32 s72, s72, 1
  s_cmp_lg_u32 s72, 0
  s_cbranch_scc1 .lwl_88
.lwd_87:
  s_add_u32 m0, s39, 94208
  s_movk_i32 s30, 0
  buffer_load_dwordx4 v67, s[8:11], s30 offen sc1 lds
  buffer_load_dwordx4 v73, s[8:11], s30 offen offset:1024 sc1 lds
  s_add_u32 m0, s39, 102400
  s_movk_i32 s30, 128
  buffer_load_dwordx4 v67, s[8:11], s30 offen sc1 lds
  buffer_load_dwordx4 v73, s[8:11], s30 offen offset:1024 sc1 lds
  s_add_u32 m0, s39, 131072
  s_movk_i32 s30, 256
  buffer_load_dwordx4 v68, s[8:11], s30 offen sc1 lds
  buffer_load_dwordx4 v74, s[8:11], s30 offen offset:1024 sc1 lds
  s_add_u32 m0, s39, 139264
  s_movk_i32 s30, 384
  buffer_load_dwordx4 v69, s[8:11], s30 offen sc1 lds
  buffer_load_dwordx4 v75, s[8:11], s30 offen offset:1024 sc1 lds
  s_add_u32 m0, s39, 20480
  s_movk_i32 s30, 512
  buffer_load_dwordx4 v69, s[8:11], s30 offen sc1 lds
  buffer_load_dwordx4 v75, s[8:11], s30 offen offset:1024 sc1 lds
  s_add_u32 m0, s39, 28672
  s_movk_i32 s30, 640
  buffer_load_dwordx4 v70, s[8:11], s30 offen sc1 lds
  buffer_load_dwordx4 v76, s[8:11], s30 offen offset:1024 sc1 lds
  s_add_u32 m0, s39, 57344
  s_movk_i32 s30, 768
  buffer_load_dwordx4 v70, s[8:11], s30 offen sc1 lds
  buffer_load_dwordx4 v76, s[8:11], s30 offen offset:1024 sc1 lds
  s_add_u32 m0, s39, 65536
  s_movk_i32 s30, 896
  buffer_load_dwordx4 v71, s[8:11], s30 offen sc1 lds
  buffer_load_dwordx4 v77, s[8:11], s30 offen offset:1024 sc1 lds
  s_waitcnt vmcnt(12)
  s_barrier
  v_mov_b32 v28, 162904
  v_mov_b32 v29, 1
  s_mov_b64 exec, 1
  ds_add_rtn_u32 v30, v28, v29
  s_mov_b64 exec, -1
  s_lshl_b32 s30, s24, 3
  s_add_u32 s30, s30, 0x1b60000
  s_waitcnt lgkmcnt(0)
  v_readfirstlane_b32 s31, v30
  v_mov_b32 v28, s30
  v_mov_b32 v30, s26
  v_mov_b32 v31, s27
  s_cmp_lg_u32 s31, 3
  s_cbranch_scc1 .sg_91
  s_mov_b64 exec, 1
  s_mov_b32 s30, 49152
  buffer_store_dwordx2 v[30:31], v28, s[4:7], s30 offen sc1
  s_mov_b64 exec, -1
.sg_91:
  s_waitcnt vmcnt(8)
  s_barrier
  s_lshl_b32 s36, s22, 4
  s_sub_u32 s35, s22, 1
  s_add_u32 s35, s35, s65
  s_cmp_gt_u32 s35, 15
  s_cselect_b32 s35, s22, s35
  s_lshl_b32 s35, s35, 4
  v_and_b32 v52, 15, v1
  v_lshlrev_b32 v52, 3, v52
  s_lshl_b32 s30, s36, 3
  s_add_u32 s30, s30, 0x1b70000
  v_mov_b32 v53, s30
  s_lshl_b32 s30, s35, 3
  s_add_u32 s30, s30, 0x1b64000
  v_cmp_le_u32 vcc, 16, v1
  v_mov_b32 v54, s30
  s_nop 0
  v_cndmask_b32 v53, v53, v54, vcc
  v_add_u32 v52, v52, v53
  s_waitcnt vmcnt(4)
  s_barrier
  buffer_load_dwordx2 v[56:57], v52, s[4:7], 0 offen sc1
  s_add_u32 m0, s71, 73728
  s_nop 0
  buffer_load_dwordx4 v66, s[4:7], s69 offen sc1 lds
  buffer_load_dwordx4 v66, s[4:7], s69 offen offset:1024 sc1 lds
  buffer_load_dwordx4 v66, s[4:7], s69 offen offset:2048 sc1 lds
  buffer_load_dwordx4 v66, s[4:7], s69 offen offset:3072 sc1 lds
  s_add_u32 m0, s71, 77824
  s_add_u32 s38, s69, 4096
  buffer_load_dwordx4 v66, s[4:7], s38 offen sc1 lds
  s_add_u32 s69, s69, 20480
  s_add_u32 m0, s39, 94208
  s_movk_i32 s30, 1024
  buffer_load_dwordx4 v72, s[8:11], s30 offen sc1 lds
  buffer_load_dwordx4 v78, s[8:11], s30 offen offset:1024 sc1 lds
  s_add_u32 m0, s39, 102400
  s_movk_i32 s30, 1152
  buffer_load_dwordx4 v72, s[8:11], s30 offen sc1 lds
  buffer_load_dwordx4 v78, s[8:11], s30 offen offset:1024 sc1 lds
  s_waitcnt vmcnt(10)
  s_barrier
  s_waitcnt vmcnt(9)
  v_cmp_ne_u64 vcc, s[26:27], v[56:57]
  s_cmp_eq_u64 vcc, 0
  s_cselect_b32 s37, 1, 0
  s_cbranch_scc0 .ns_92
  s_mov_b32 s16, s62
  s_mov_b32 s17, s63
  s_mov_b32 s18, 0x780000
  s_mov_b32 s19, 0x20000
  s_mul_i32 s34, s21, 9216
  s_add_u32 s34, s34, 110592
  s_add_u32 m0, s34, 0
  s_nop 0
  buffer_load_dwordx4 v79, s[16:19], 0 offen sc1 lds
  s_add_u32 m0, s34, 1024
  s_nop 0
  buffer_load_dwordx4 v80, s[16:19], 0 offen sc1 lds
  s_add_u32 m0, s34, 2048
  s_nop 0
  buffer_load_dwordx4 v81, s[16:19], 0 offen sc1 lds
  s_add_u32 m0, s34, 3072
  s_nop 0
  buffer_load_dwordx4 v82, s[16:19], 0 offen sc1 lds
  s_add_u32 m0, s34, 4096
  s_nop 0
  buffer_load_dwordx4 v83, s[16:19], 0 offen sc1 lds
  s_add_u32 m0, s34, 5120
  s_nop 0
  buffer_load_dwordx4 v84, s[16:19], 0 offen sc1 lds
  s_add_u32 m0, s34, 6144
  s_nop 0
  buffer_load_dwordx4 v85, s[16:19], 0 offen sc1 lds
  s_add_u32 m0, s34, 7168
  s_nop 0
  buffer_load_dwordx4 v86, s[16:19], 0 offen sc1 lds
  s_add_u32 m0, s34, 8192
  s_nop 0
  buffer_load_dwordx4 v87, s[16:19], 0 offen sc1 lds
.ns_92:
  s_cmp_eq_u32 s37, 0
  s_cbranch_scc1 .w0_93
  s_waitcnt vmcnt(9)
  s_branch .w1_94
.w0_93:
  s_waitcnt vmcnt(0)
.w1_94:
  s_barrier
  s_barrier
  s_add_u32 s8, s62, 0xb00000
  s_addc_u32 s9, s63, 0
  s_mov_b32 s10, 0x280000
  s_mov_b32 s11, 0x20000
  s_mov_b32 s68, 0
  s_mul_i32 s71, s21, 3072
  s_min_u32 s30, s21, 2
  s_lshl_b32 s30, s30, 10
  s_add_u32 s71, s71, s30
  s_mul_i32 s69, s23, 143360
  s_add_u32 s69, s69, s71
  s_add_u32 s69, s69, 0x2300000
  s_cmp_lg_u32 s37, 0
  s_cbranch_scc1 .st_95
  s_mov_b32 s72, 0x40000
.pl_96:
  buffer_load_dwordx2 v[56:57], v52, s[4:7], 0 offen sc1
  s_waitcnt vmcnt(0)
  v_cmp_ne_u64 vcc, s[26:27], v[56:57]
  s_cbranch_vccz .pd_97
  s_sleep 2
  s_sub_u32 s72, s72, 1
  s_cmp_lg_u32 s72, 0
  s_cbranch_scc1 .pl_96
.pd_97:
  s_mov_b32 s16, s62
  s_mov_b32 s17, s63
  s_mov_b32 s18, 0x780000
  s_mov_b32 s19, 0x20000
  s_mul_i32 s34, s21, 9216
  s_add_u32 s34, s34, 110592
  s_add_u32 m0, s34, 0
  s_nop 0
  buffer_load_dwordx4 v79, s[16:19], 0 offen sc1 lds
  s_add_u32 m0, s34, 1024
  s_nop 0
  buffer_load_dwordx4 v80, s[16:19], 0 offen sc1 lds
  s_add_u32 m0, s34, 2048
  s_nop 0
  buffer_load_dwordx4 v81, s[16:19], 0 offen sc1 lds
  s_add_u32 m0, s34, 3072
  s_nop 0
  buffer_load_dwordx4 v82, s[16:19], 0 offen sc1 lds
  s_add_u32 m0, s34, 4096
  s_nop 0
  buffer_load_dwordx4 v83, s[16:19], 0 offen sc1 lds
  s_add_u32 m0, s34, 5120
  s_nop 0
  buffer_load_dwordx4 v84, s[16:19], 0 offen sc1 lds
  s_add_u32 m0, s34, 6144
  s_nop 0
  buffer_load_dwordx4 v85, s[16:19], 0 offen sc1 lds
  s_add_u32 m0, s34, 7168
  s_nop 0
  buffer_load_dwordx4 v86, s[16:19], 0 offen sc1 lds
  s_add_u32 m0, s34, 8192
  s_nop 0
  buffer_load_dwordx4 v87, s[16:19], 0 offen sc1 lds
.st_95:
  s_add_u32 m0, s71, 0
  s_nop 0
  buffer_load_dwordx4 v66, s[4:7], s69 offen sc1 lds
  buffer_load_dwordx4 v66, s[4:7], s69 offen offset:1024 sc1 lds
  buffer_load_dwordx4 v66, s[4:7], s69 offen offset:2048 sc1 lds
  s_cmp_lt_u32 s21, 2
  s_cselect_b64 exec, -1, 0
  buffer_load_dwordx4 v66, s[4:7], s69 offen offset:3072 sc1 lds
  s_mov_b64 exec, -1
  s_add_u32 s69, s69, 14336
  s_add_u32 m0, s71, 30720
  s_nop 0
  buffer_load_dwordx4 v66, s[4:7], s69 offen sc1 lds
  buffer_load_dwordx4 v66, s[4:7], s69 offen offset:1024 sc1 lds
  buffer_load_dwordx4 v66, s[4:7], s69 offen offset:2048 sc1 lds
  s_cmp_lt_u32 s21, 2
  s_cselect_b64 exec, -1, 0
  buffer_load_dwordx4 v66, s[4:7], s69 offen offset:3072 sc1 lds
  s_mov_b64 exec, -1
  s_add_u32 s69, s69, 14336
  s_add_u32 m0, s71, 61440
  s_nop 0
  buffer_load_dwordx4 v66, s[4:7], s69 offen sc1 lds
  buffer_load_dwordx4 v66, s[4:7], s69 offen offset:1024 sc1 lds
  buffer_load_dwordx4 v66, s[4:7], s69 offen offset:2048 sc1 lds
  s_cmp_lt_u32 s21, 2
  s_cselect_b64 exec, -1, 0
  buffer_load_dwordx4 v66, s[4:7], s69 offen offset:3072 sc1 lds
  s_mov_b64 exec, -1
  s_add_u32 s69, s69, 14336
  s_add_u32 m0, s71, 92160
  s_nop 0
  buffer_load_dwordx4 v66, s[4:7], s69 offen sc1 lds
  buffer_load_dwordx4 v66, s[4:7], s69 offen offset:1024 sc1 lds
  buffer_load_dwordx4 v66, s[4:7], s69 offen offset:2048 sc1 lds
  s_cmp_lt_u32 s21, 2
  s_cselect_b64 exec, -1, 0
  buffer_load_dwordx4 v66, s[4:7], s69 offen offset:3072 sc1 lds
  s_mov_b64 exec, -1
  s_add_u32 s69, s69, 14336
  s_waitcnt vmcnt(16)
  s_barrier
  s_lshl_b32 s35, s22, 4
  v_and_b32 v52, 15, v1
  v_lshlrev_b32 v52, 3, v52
  s_lshl_b32 s30, s35, 3
  s_add_u32 s30, s30, 0x1b66000
  v_mov_b32 v53, s30
  v_add_u32 v52, v52, v53
  s_lshl_b32 s30, s20, 3
  v_lshrrev_b32 v29, 3, v1
  v_add_u32 v29, s30, v29
  v_bfe_u32 v30, v1, 1, 2
  v_mul_u32_u24 v30, 40, v30
  v_mul_u32_u24 v28, 160, v29
  v_add_u32 v28, v28, v30
  v_add_u32 v28, 110592, v28
  v_and_b32 v32, 1, v1
  v_mul_u32_u24 v33, 1280, v32
  v_sub_u32 v33, v28, v33
  v_add_u32 v31, s67, v29
  ds_read_b64 v[92:93], v28 offset:0
  ds_read_b64 v[94:95], v28 offset:8
  ds_read_b64 v[96:97], v28 offset:16
  ds_read_b64 v[98:99], v28 offset:24
  ds_read_b64 v[100:101], v28 offset:32
  ds_read_b64 v[104:105], v33 offset:12480
  ds_read_b64 v[106:107], v33 offset:12488
  ds_read_b64 v[108:109], v33 offset:12496
  ds_read_b64 v[110:111], v33 offset:12504
  ds_read_b64 v[112:113], v33 offset:12512
  ds_read_b64 v[114:115], v33 offset:12160
  ds_read_b64 v[116:117], v33 offset:12168
  ds_read_b64 v[118:119], v33 offset:12176
  ds_read_b64 v[120:121], v33 offset:12184
  ds_read_b64 v[122:123], v33 offset:12192
  ds_read_b64 v[124:125], v33 offset:11840
  ds_read_b64 v[126:127], v33 offset:11848
  ds_read_b64 v[128:129], v33 offset:11856
  ds_read_b64 v[130:131], v33 offset:11864
  ds_read_b64 v[132:133], v33 offset:11872
  ds_read_b64 v[134:135], v33 offset:11520
  ds_read_b64 v[136:137], v33 offset:11528
  ds_read_b64 v[138:139], v33 offset:11536
  ds_read_b64 v[140:141], v33 offset:11544
  ds_read_b64 v[142:143], v33 offset:11552
  v_mov_b32 v36, 0
  v_mov_b32 v37, 0
  v_mov_b32 v38, 0
  v_mov_b32 v39, 0
  s_waitcnt lgkmcnt(0)
  v_dot2c_f32_bf16 v36, v92, v104
  v_dot2c_f32_bf16 v37, v92, v114
  v_dot2c_f32_bf16 v38, v92, v124
  v_dot2c_f32_bf16 v39, v92, v134
  v_dot2c_f32_bf16 v36, v93, v105
  v_dot2c_f32_bf16 v37, v93, v115
  v_dot2c_f32_bf16 v38, v93, v125
  v_dot2c_f32_bf16 v39, v93, v135
  v_dot2c_f32_bf16 v36, v94, v106
  v_dot2c_f32_bf16 v37, v94, v116
  v_dot2c_f32_bf16 v38, v94, v126
  v_dot2c_f32_bf16 v39, v94, v136
  v_dot2c_f32_bf16 v36, v95, v107
  v_dot2c_f32_bf16 v37, v95, v117
  v_dot2c_f32_bf16 v38, v95, v127
  v_dot2c_f32_bf16 v39, v95, v137
  v_dot2c_f32_bf16 v36, v96, v108
  v_dot2c_f32_bf16 v37, v96, v118
  v_dot2c_f32_bf16 v38, v96, v128
  v_dot2c_f32_bf16 v39, v96, v138
  v_dot2c_f32_bf16 v36, v97, v109
  v_dot2c_f32_bf16 v37, v97, v119
  v_dot2c_f32_bf16 v38, v97, v129
  v_dot2c_f32_bf16 v39, v97, v139
  v_dot2c_f32_bf16 v36, v98, v110
  v_dot2c_f32_bf16 v37, v98, v120
  v_dot2c_f32_bf16 v38, v98, v130
  v_dot2c_f32_bf16 v39, v98, v140
  v_dot2c_f32_bf16 v36, v99, v111
  v_dot2c_f32_bf16 v37, v99, v121
  v_dot2c_f32_bf16 v38, v99, v131
  v_dot2c_f32_bf16 v39, v99, v141
  v_dot2c_f32_bf16 v36, v100, v112
  v_dot2c_f32_bf16 v37, v100, v122
  v_dot2c_f32_bf16 v38, v100, v132
  v_dot2c_f32_bf16 v39, v100, v142
  v_dot2c_f32_bf16 v36, v101, v113
  v_dot2c_f32_bf16 v37, v101, v123
  v_dot2c_f32_bf16 v38, v101, v133
  v_dot2c_f32_bf16 v39, v101, v143
  s_nop 2
  ds_read_b64 v[104:105], v33 offset:24960
  ds_read_b64 v[106:107], v33 offset:24968
  ds_read_b64 v[108:109], v33 offset:24976
  ds_read_b64 v[110:111], v33 offset:24984
  ds_read_b64 v[112:113], v33 offset:24992
  ds_read_b64 v[114:115], v33 offset:24640
  ds_read_b64 v[116:117], v33 offset:24648
  ds_read_b64 v[118:119], v33 offset:24656
  ds_read_b64 v[120:121], v33 offset:24664
  ds_read_b64 v[122:123], v33 offset:24672
  ds_read_b64 v[124:125], v33 offset:24320
  ds_read_b64 v[126:127], v33 offset:24328
  ds_read_b64 v[128:129], v33 offset:24336
  ds_read_b64 v[130:131], v33 offset:24344
  ds_read_b64 v[132:133], v33 offset:24352
  ds_read_b64 v[134:135], v33 offset:24000
  ds_read_b64 v[136:137], v33 offset:24008
  ds_read_b64 v[138:139], v33 offset:24016
  ds_read_b64 v[140:141], v33 offset:24024
  ds_read_b64 v[142:143], v33 offset:24032
  buffer_load_dwordx2 v[56:57], v52, s[4:7], 0 offen sc1
  v_cvt_pk_bf16_f32 v34, v36, v37
  v_lshlrev_b32 v36, 16, v34
  v_and_b32 v37, 0xffff0000, v34
  v_cvt_pk_bf16_f32 v34, v38, v39
  v_lshlrev_b32 v38, 16, v34
  v_and_b32 v39, 0xffff0000, v34
  v_mul_f32 v36, 0x3e64f92e, v36
  v_mul_f32 v37, 0x3e64f92e, v37
  v_mul_f32 v38, 0x3e64f92e, v38
  v_mul_f32 v39, 0x3e64f92e, v39
  v_cvt_pk_bf16_f32 v34, v36, v37
  v_lshlrev_b32 v36, 16, v34
  v_and_b32 v37, 0xffff0000, v34
  v_cvt_pk_bf16_f32 v34, v38, v39
  v_lshlrev_b32 v38, 16, v34
  v_and_b32 v39, 0xffff0000, v34
  s_add_u32 s30, s30, s67
  s_cmp_ge_u32 s30, 16
  s_cbranch_scc1 .nm_98
  v_mov_b32 v34, 0xce6e6b28
  v_lshlrev_b32 v35, 3, v32
  v_sub_u32 v35, v31, v35
  v_cmp_gt_i32 vcc, 0, v35
  s_nop 1
  v_cndmask_b32 v36, v36, v34, vcc
  v_cmp_gt_i32 vcc, 2, v35
  s_nop 1
  v_cndmask_b32 v37, v37, v34, vcc
  v_cmp_gt_i32 vcc, 4, v35
  s_nop 1
  v_cndmask_b32 v38, v38, v34, vcc
  v_cmp_gt_i32 vcc, 6, v35
  s_nop 1
  v_cndmask_b32 v39, v39, v34, vcc
.nm_98:
  v_max3_f32 v40, v36, v37, v38
  v_max_f32 v40, v40, v39
  s_nop 1
  v_max_f32_dpp v40, v40, v40 quad_perm:[1,0,3,2] row_mask:0xf bank_mask:0xf
  v_sub_f32 v36, v36, v40
  v_sub_f32 v37, v37, v40
  v_sub_f32 v38, v38, v40
  v_sub_f32 v39, v39, v40
  v_mul_f32 v36, 0x3fb8aa3b, v36
  v_mul_f32 v37, 0x3fb8aa3b, v37
  v_mul_f32 v38, 0x3fb8aa3b, v38
  v_mul_f32 v39, 0x3fb8aa3b, v39
  v_exp_f32 v36, v36
  v_exp_f32 v37, v37
  v_exp_f32 v38, v38
  v_exp_f32 v39, v39
  s_nop 0
  v_add_f32 v40, v36, v37
  v_add_f32 v41, v38, v39
  v_add_f32 v40, v40, v41
  s_nop 1
  v_add_f32_dpp v40, v40, v40 quad_perm:[1,0,3,2] row_mask:0xf bank_mask:0xf
  v_rcp_f32 v40, v40
  s_nop 0
  v_mul_f32 v36, v36, v40
  v_mul_f32 v37, v37, v40
  v_mul_f32 v38, v38, v40
  v_mul_f32 v39, v39, v40
  v_cvt_pk_bf16_f32 v42, v36, v37
  v_cvt_pk_bf16_f32 v43, v38, v39
  v_mov_b32 v144, 0
  v_mov_b32 v145, 0
  v_mov_b32 v146, 0
  v_mov_b32 v147, 0
  v_mov_b32 v148, 0
  v_mov_b32 v149, 0
  v_mov_b32 v150, 0
  v_mov_b32 v151, 0
  v_mov_b32 v152, 0
  v_mov_b32 v153, 0
  v_mov_b32 v154, 0
  v_mov_b32 v155, 0
  v_mov_b32 v156, 0
  v_mov_b32 v157, 0
  v_mov_b32 v158, 0
  v_mov_b32 v159, 0
  v_mov_b32 v160, 0
  v_mov_b32 v161, 0
  v_mov_b32 v162, 0
  v_mov_b32 v163, 0
  s_mov_b32 s30, 0x05040100
  s_mov_b32 s31, 0x07060302
  s_waitcnt lgkmcnt(0)
  v_perm_b32 v164, v114, v104, s30
  v_perm_b32 v165, v114, v104, s31
  v_perm_b32 v166, v115, v105, s30
  v_perm_b32 v167, v115, v105, s31
  v_perm_b32 v168, v116, v106, s30
  v_perm_b32 v169, v116, v106, s31
  v_perm_b32 v170, v117, v107, s30
  v_perm_b32 v171, v117, v107, s31
  v_perm_b32 v172, v118, v108, s30
  v_perm_b32 v173, v118, v108, s31
  v_perm_b32 v174, v119, v109, s30
  v_perm_b32 v175, v119, v109, s31
  v_perm_b32 v176, v120, v110, s30
  v_perm_b32 v177, v120, v110, s31
  v_perm_b32 v178, v121, v111, s30
  v_perm_b32 v179, v121, v111, s31
  v_perm_b32 v180, v122, v112, s30
  v_perm_b32 v181, v122, v112, s31
  v_perm_b32 v182, v123, v113, s30
  v_perm_b32 v183, v123, v113, s31
  v_dot2c_f32_bf16 v144, v164, v42
  v_dot2c_f32_bf16 v145, v165, v42
  v_dot2c_f32_bf16 v146, v166, v42
  v_dot2c_f32_bf16 v147, v167, v42
  v_dot2c_f32_bf16 v148, v168, v42
  v_dot2c_f32_bf16 v149, v169, v42
  v_dot2c_f32_bf16 v150, v170, v42
  v_dot2c_f32_bf16 v151, v171, v42
  v_dot2c_f32_bf16 v152, v172, v42
  v_dot2c_f32_bf16 v153, v173, v42
  v_dot2c_f32_bf16 v154, v174, v42
  v_dot2c_f32_bf16 v155, v175, v42
  v_dot2c_f32_bf16 v156, v176, v42
  v_dot2c_f32_bf16 v157, v177, v42
  v_dot2c_f32_bf16 v158, v178, v42
  v_dot2c_f32_bf16 v159, v179, v42
  v_dot2c_f32_bf16 v160, v180, v42
  v_dot2c_f32_bf16 v161, v181, v42
  v_dot2c_f32_bf16 v162, v182, v42
  v_dot2c_f32_bf16 v163, v183, v42
  v_perm_b32 v164, v134, v124, s30
  v_perm_b32 v165, v134, v124, s31
  v_perm_b32 v166, v135, v125, s30
  v_perm_b32 v167, v135, v125, s31
  v_perm_b32 v168, v136, v126, s30
  v_perm_b32 v169, v136, v126, s31
  v_perm_b32 v170, v137, v127, s30
  v_perm_b32 v171, v137, v127, s31
  v_perm_b32 v172, v138, v128, s30
  v_perm_b32 v173, v138, v128, s31
  v_perm_b32 v174, v139, v129, s30
  v_perm_b32 v175, v139, v129, s31
  v_perm_b32 v176, v140, v130, s30
  v_perm_b32 v177, v140, v130, s31
  v_perm_b32 v178, v141, v131, s30
  v_perm_b32 v179, v141, v131, s31
  v_perm_b32 v180, v142, v132, s30
  v_perm_b32 v181, v142, v132, s31
  v_perm_b32 v182, v143, v133, s30
  v_perm_b32 v183, v143, v133, s31
  v_dot2c_f32_bf16 v144, v164, v43
  v_dot2c_f32_bf16 v145, v165, v43
  v_dot2c_f32_bf16 v146, v166, v43
  v_dot2c_f32_bf16 v147, v167, v43
  v_dot2c_f32_bf16 v148, v168, v43
  v_dot2c_f32_bf16 v149, v169, v43
  v_dot2c_f32_bf16 v150, v170, v43
  v_dot2c_f32_bf16 v151, v171, v43
  v_dot2c_f32_bf16 v152, v172, v43
  v_dot2c_f32_bf16 v153, v173, v43
  v_dot2c_f32_bf16 v154, v174, v43
  v_dot2c_f32_bf16 v155, v175, v43
  v_dot2c_f32_bf16 v156, v176, v43
  v_dot2c_f32_bf16 v157, v177, v43
  v_dot2c_f32_bf16 v158, v178, v43
  v_dot2c_f32_bf16 v159, v179, v43
  v_dot2c_f32_bf16 v160, v180, v43
  v_dot2c_f32_bf16 v161, v181, v43
  v_dot2c_f32_bf16 v162, v182, v43
  v_dot2c_f32_bf16 v163, v183, v43
  s_nop 2
  s_waitcnt vmcnt(0)
  v_cmp_ne_u64 vcc, s[26:27], v[56:57]
  s_cmp_eq_u64 vcc, 0
  s_cselect_b32 s37, 1, 0
  s_cbranch_scc0 .na_99
  s_add_u32 m0, s70, 14336
  s_nop 0
  buffer_load_dwordx4 v4, s[8:11], s68 offen sc1 lds
  buffer_load_dwordx4 v5, s[8:11], s68 offen offset:1024 sc1 lds
  buffer_load_dwordx4 v6, s[8:11], s68 offen offset:2048 sc1 lds
  buffer_load_dwordx4 v7, s[8:11], s68 offen offset:3072 sc1 lds
  s_add_u32 s68, s68, 128
  s_add_u32 m0, s70, 45056
  s_nop 0
  buffer_load_dwordx4 v4, s[8:11], s68 offen sc1 lds
  buffer_load_dwordx4 v5, s[8:11], s68 offen offset:1024 sc1 lds
  buffer_load_dwordx4 v6, s[8:11], s68 offen offset:2048 sc1 lds
  buffer_load_dwordx4 v7, s[8:11], s68 offen offset:3072 sc1 lds
  s_add_u32 s68, s68, 128
  s_add_u32 m0, s70, 75776
  s_nop 0
  buffer_load_dwordx4 v4, s[8:11], s68 offen sc1 lds
  buffer_load_dwordx4 v5, s[8:11], s68 offen offset:1024 sc1 lds
  buffer_load_dwordx4 v6, s[8:11], s68 offen offset:2048 sc1 lds
  buffer_load_dwordx4 v7, s[8:11], s68 offen offset:3072 sc1 lds
  s_add_u32 s68, s68, 128
.na_99:
  v_add_f32_dpp v144, v144, v144 quad_perm:[1,0,3,2] row_mask:0xf bank_mask:0xf
  v_add_f32_dpp v145, v145, v145 quad_perm:[1,0,3,2] row_mask:0xf bank_mask:0xf
  v_add_f32_dpp v146, v146, v146 quad_perm:[1,0,3,2] row_mask:0xf bank_mask:0xf
  v_add_f32_dpp v147, v147, v147 quad_perm:[1,0,3,2] row_mask:0xf bank_mask:0xf
  v_add_f32_dpp v148, v148, v148 quad_perm:[1,0,3,2] row_mask:0xf bank_mask:0xf
  v_add_f32_dpp v149, v149, v149 quad_perm:[1,0,3,2] row_mask:0xf bank_mask:0xf
  v_add_f32_dpp v150, v150, v150 quad_perm:[1,0,3,2] row_mask:0xf bank_mask:0xf
  v_add_f32_dpp v151, v151, v151 quad_perm:[1,0,3,2] row_mask:0xf bank_mask:0xf
  v_add_f32_dpp v152, v152, v152 quad_perm:[1,0,3,2] row_mask:0xf bank_mask:0xf
  v_add_f32_dpp v153, v153, v153 quad_perm:[1,0,3,2] row_mask:0xf bank_mask:0xf
  v_add_f32_dpp v154, v154, v154 quad_perm:[1,0,3,2] row_mask:0xf bank_mask:0xf
  v_add_f32_dpp v155, v155, v155 quad_perm:[1,0,3,2] row_mask:0xf bank_mask:0xf
  v_add_f32_dpp v156, v156, v156 quad_perm:[1,0,3,2] row_mask:0xf bank_mask:0xf
  v_add_f32_dpp v157, v157, v157 quad_perm:[1,0,3,2] row_mask:0xf bank_mask:0xf
  v_add_f32_dpp v158, v158, v158 quad_perm:[1,0,3,2] row_mask:0xf bank_mask:0xf
  v_add_f32_dpp v159, v159, v159 quad_perm:[1,0,3,2] row_mask:0xf bank_mask:0xf
  v_add_f32_dpp v160, v160, v160 quad_perm:[1,0,3,2] row_mask:0xf bank_mask:0xf
  v_add_f32_dpp v161, v161, v161 quad_perm:[1,0,3,2] row_mask:0xf bank_mask:0xf
  v_add_f32_dpp v162, v162, v162 quad_perm:[1,0,3,2] row_mask:0xf bank_mask:0xf
  v_add_f32_dpp v163, v163, v163 quad_perm:[1,0,3,2] row_mask:0xf bank_mask:0xf
  v_cvt_pk_bf16_f32 v92, v144, v145
  v_cvt_pk_bf16_f32 v93, v146, v147
  v_cvt_pk_bf16_f32 v94, v148, v149
  v_cvt_pk_bf16_f32 v95, v150, v151
  v_cvt_pk_bf16_f32 v96, v152, v153
  v_cvt_pk_bf16_f32 v97, v154, v155
  v_cvt_pk_bf16_f32 v98, v156, v157
  v_cvt_pk_bf16_f32 v99, v158, v159
  v_cvt_pk_bf16_f32 v100, v160, v161
  v_cvt_pk_bf16_f32 v101, v162, v163
  v_mul_u32_u24 v28, 1280, v31
  v_add_u32 v28, v28, v30
  v_lshl_or_b32 v28, v32, 31, v28
  s_mul_i32 s30, s66, 160
  s_add_u32 s30, s30, 0xe00000
  s_cmp_lg_u32 s25, 0
  s_cbranch_scc1 .dp_100
  buffer_store_dwordx4 v[92:95], v28, s[4:7], s30 offen sc1
  buffer_store_dwordx4 v[96:99], v28, s[4:7], s30 offen offset:16 sc1
  buffer_store_dwordx2 v[100:101], v28, s[4:7], s30 offen offset:32 sc1
  s_branch .de_101
.dp_100:
  buffer_store_dwordx4 v[92:95], v28, s[4:7], s30 offen
  buffer_store_dwordx4 v[96:99], v28, s[4:7], s30 offen offset:16
  buffer_store_dwordx2 v[100:101], v28, s[4:7], s30 offen offset:32
.de_101:
  s_barrier
  s_cmp_lg_u32 s37, 0
  s_cbranch_scc1 .ga_102
  s_mov_b32 s72, 0x40000
.pl_103:
  buffer_load_dwordx2 v[56:57], v52, s[4:7], 0 offen sc1
  s_waitcnt vmcnt(0)
  v_cmp_ne_u64 vcc, s[26:27], v[56:57]
  s_cbranch_vccz .pd_104
  s_sleep 2
  s_sub_u32 s72, s72, 1
  s_cmp_lg_u32 s72, 0
  s_cbranch_scc1 .pl_103
.pd_104:
  s_add_u32 m0, s70, 14336
  s_nop 0
  buffer_load_dwordx4 v4, s[8:11], s68 offen sc1 lds
  buffer_load_dwordx4 v5, s[8:11], s68 offen offset:1024 sc1 lds
  buffer_load_dwordx4 v6, s[8:11], s68 offen offset:2048 sc1 lds
  buffer_load_dwordx4 v7, s[8:11], s68 offen offset:3072 sc1 lds
  s_add_u32 s68, s68, 128
  s_add_u32 m0, s70, 45056
  s_nop 0
  buffer_load_dwordx4 v4, s[8:11], s68 offen sc1 lds
  buffer_load_dwordx4 v5, s[8:11], s68 offen offset:1024 sc1 lds
  buffer_load_dwordx4 v6, s[8:11], s68 offen offset:2048 sc1 lds
  buffer_load_dwordx4 v7, s[8:11], s68 offen offset:3072 sc1 lds
  s_add_u32 s68, s68, 128
  s_add_u32 m0, s70, 75776
  s_nop 0
  buffer_load_dwordx4 v4, s[8:11], s68 offen sc1 lds
  buffer_load_dwordx4 v5, s[8:11], s68 offen offset:1024 sc1 lds
  buffer_load_dwordx4 v6, s[8:11], s68 offen offset:2048 sc1 lds
  buffer_load_dwordx4 v7, s[8:11], s68 offen offset:3072 sc1 lds
  s_add_u32 s68, s68, 128
.ga_102:
  s_add_u32 m0, s70, 106496
  s_nop 0
  buffer_load_dwordx4 v4, s[8:11], s68 offen sc1 lds
  buffer_load_dwordx4 v5, s[8:11], s68 offen offset:1024 sc1 lds
  buffer_load_dwordx4 v6, s[8:11], s68 offen offset:2048 sc1 lds
  buffer_load_dwordx4 v7, s[8:11], s68 offen offset:3072 sc1 lds
  s_add_u32 s68, s68, 128
  s_waitcnt vmcnt(12)
  s_barrier
  s_waitcnt vmcnt(8)
  s_barrier
  s_add_u32 m0, s71, 0
  s_nop 0
  buffer_load_dwordx4 v66, s[4:7], s69 offen sc1 lds
  buffer_load_dwordx4 v66, s[4:7], s69 offen offset:1024 sc1 lds
  buffer_load_dwordx4 v66, s[4:7], s69 offen offset:2048 sc1 lds
  s_cmp_lt_u32 s21, 2
  s_cselect_b64 exec, -1, 0
  buffer_load_dwordx4 v66, s[4:7], s69 offen offset:3072 sc1 lds
  s_mov_b64 exec, -1
  s_add_u32 s69, s69, 14336
  s_add_u32 m0, s70, 14336
  s_nop 0
  buffer_load_dwordx4 v4, s[8:11], s68 offen sc1 lds
  buffer_load_dwordx4 v5, s[8:11], s68 offen offset:1024 sc1 lds
  buffer_load_dwordx4 v6, s[8:11], s68 offen offset:2048 sc1 lds
  buffer_load_dwordx4 v7, s[8:11], s68 offen offset:3072 sc1 lds
  s_add_u32 s68, s68, 128
  s_waitcnt vmcnt(12)
  s_barrier
  s_lshl_b32 s30, s21, 9
  s_add_u32 s30, s30, 0x1b6c000
  v_lshl_add_u32 v52, v1, 3, s30
  buffer_load_dwordx2 v[56:57], v52, s[4:7], 0 offen sc1
  s_add_u32 m0, s71, 30720
  s_nop 0
  buffer_load_dwordx4 v66, s[4:7], s69 offen sc1 lds
  buffer_load_dwordx4 v66, s[4:7], s69 offen offset:1024 sc1 lds
  buffer_load_dwordx4 v66, s[4:7], s69 offen offset:2048 sc1 lds
  s_cmp_lt_u32 s21, 2
  s_cselect_b64 exec, -1, 0
  buffer_load_dwordx4 v66, s[4:7], s69 offen offset:3072 sc1 lds
  s_mov_b64 exec, -1
  s_add_u32 s69, s69, 14336
  s_add_u32 m0, s70, 45056
  s_nop 0
  buffer_load_dwordx4 v4, s[8:11], s68 offen sc1 lds
  buffer_load_dwordx4 v5, s[8:11], s68 offen offset:1024 sc1 lds
  buffer_load_dwordx4 v6, s[8:11], s68 offen offset:2048 sc1 lds
  buffer_load_dwordx4 v7, s[8:11], s68 offen offset:3072 sc1 lds
  s_add_u32 s68, s68, 128
  s_waitcnt vmcnt(16)
  s_barrier
  v_mov_b32 v28, 162900
  v_mov_b32 v29, 1
  s_mov_b64 exec, 1
  ds_add_rtn_u32 v30, v28, v29
  s_mov_b64 exec, -1
  s_lshl_b32 s30, s24, 3
  s_add_u32 s30, s30, 0x1b60000
  s_waitcnt lgkmcnt(0)
  v_readfirstlane_b32 s31, v30
  v_mov_b32 v28, s30
  v_mov_b32 v30, s26
  v_mov_b32 v31, s27
  s_cmp_lg_u32 s31, 7
  s_cbranch_scc1 .sg_105
  s_mov_b64 exec, 1
  s_mov_b32 s30, 40960
  s_cmp_lg_u32 s25, 0
  s_cbranch_scc1 .dp_106
  buffer_store_dwordx2 v[30:31], v28, s[4:7], s30 offen sc1
  s_branch .de_107
.dp_106:
  buffer_store_dwordx2 v[30:31], v28, s[4:7], s30 offen
.de_107:
  s_mov_b64 exec, -1
.sg_105:
  s_add_u32 m0, s71, 61440
  s_nop 0
  buffer_load_dwordx4 v66, s[4:7], s69 offen sc1 lds
  buffer_load_dwordx4 v66, s[4:7], s69 offen offset:1024 sc1 lds
  buffer_load_dwordx4 v66, s[4:7], s69 offen offset:2048 sc1 lds
  s_cmp_lt_u32 s21, 2
  s_cselect_b64 exec, -1, 0
  buffer_load_dwordx4 v66, s[4:7], s69 offen offset:3072 sc1 lds
  s_mov_b64 exec, -1
  s_add_u32 s69, s69, 14336
  s_add_u32 m0, s70, 75776
  s_nop 0
  buffer_load_dwordx4 v4, s[8:11], s68 offen sc1 lds
  buffer_load_dwordx4 v5, s[8:11], s68 offen offset:1024 sc1 lds
  buffer_load_dwordx4 v6, s[8:11], s68 offen offset:2048 sc1 lds
  buffer_load_dwordx4 v7, s[8:11], s68 offen offset:3072 sc1 lds
  s_add_u32 s68, s68, 128
  s_waitcnt vmcnt(16)
  s_barrier
  s_add_u32 m0, s71, 92160
  s_nop 0
  buffer_load_dwordx4 v66, s[4:7], s69 offen sc1 lds
  buffer_load_dwordx4 v66, s[4:7], s69 offen offset:1024 sc1 lds
  buffer_load_dwordx4 v66, s[4:7], s69 offen offset:2048 sc1 lds
  s_cmp_lt_u32 s21, 2
  s_cselect_b64 exec, -1, 0
  buffer_load_dwordx4 v66, s[4:7], s69 offen offset:3072 sc1 lds
  s_mov_b64 exec, -1
  s_add_u32 s69, s69, 14336
  s_add_u32 m0, s70, 106496
  s_nop 0
  buffer_load_dwordx4 v4, s[8:11], s68 offen sc1 lds
  buffer_load_dwordx4 v5, s[8:11], s68 offen offset:1024 sc1 lds
  buffer_load_dwordx4 v6, s[8:11], s68 offen offset:2048 sc1 lds
  buffer_load_dwordx4 v7, s[8:11], s68 offen offset:3072 sc1 lds
  s_add_u32 s68, s68, 128
  s_waitcnt vmcnt(16)
  v_cmp_ne_u64 vcc, s[26:27], v[56:57]
  s_cbranch_vccz .pok_108
  s_mov_b32 s72, 0x40000
.pl_109:
  buffer_load_dwordx2 v[56:57], v52, s[4:7], 0 offen sc1
  s_waitcnt vmcnt(0)
  v_cmp_ne_u64 vcc, s[26:27], v[56:57]
  s_cbranch_vccz .pd_110
  s_sleep 2
  s_sub_u32 s72, s72, 1
  s_cmp_lg_u32 s72, 0
  s_cbranch_scc1 .pl_109
.pd_110:
.pok_108:
  s_barrier
  s_add_u32 m0, s71, 0
  s_nop 0
  buffer_load_dwordx4 v66, s[4:7], s69 offen sc1 lds
  buffer_load_dwordx4 v66, s[4:7], s69 offen offset:1024 sc1 lds
  buffer_load_dwordx4 v66, s[4:7], s69 offen offset:2048 sc1 lds
  s_cmp_lt_u32 s21, 2
  s_cselect_b64 exec, -1, 0
  buffer_load_dwordx4 v66, s[4:7], s69 offen offset:3072 sc1 lds
  s_mov_b64 exec, -1
  s_add_u32 s69, s69, 14336
  s_add_u32 m0, s70, 14336
  s_nop 0
  buffer_load_dwordx4 v4, s[8:11], s68 offen sc1 lds
  buffer_load_dwordx4 v5, s[8:11], s68 offen offset:1024 sc1 lds
  buffer_load_dwordx4 v6, s[8:11], s68 offen offset:2048 sc1 lds
  buffer_load_dwordx4 v7, s[8:11], s68 offen offset:3072 sc1 lds
  s_add_u32 s68, s68, 128
  s_waitcnt vmcnt(16)
  s_barrier
  s_add_u32 m0, s71, 30720
  s_nop 0
  buffer_load_dwordx4 v66, s[4:7], s69 offen sc1 lds
  buffer_load_dwordx4 v66, s[4:7], s69 offen offset:1024 sc1 lds
  buffer_load_dwordx4 v66, s[4:7], s69 offen offset:2048 sc1 lds
  s_cmp_lt_u32 s21, 2
  s_cselect_b64 exec, -1, 0
  buffer_load_dwordx4 v66, s[4:7], s69 offen offset:3072 sc1 lds
  s_mov_b64 exec, -1
  s_add_u32 s69, s69, 14336
  s_add_u32 m0, s70, 45056
  s_nop 0
  buffer_load_dwordx4 v4, s[8:11], s68 offen sc1 lds
  buffer_load_dwordx4 v5, s[8:11], s68 offen offset:1024 sc1 lds
  buffer_load_dwordx4 v6, s[8:11], s68 offen offset:2048 sc1 lds
  buffer_load_dwordx4 v7, s[8:11], s68 offen offset:3072 sc1 lds
  s_add_u32 s68, s68, 128
  s_waitcnt vmcnt(16)
  s_barrier
  s_lshl_b32 s35, s22, 4
  v_mov_b32 v58, 162960
  s_cmp_lg_u32 s21, 0
  s_cbranch_scc1 .lw_111
  v_and_b32 v52, 15, v1
  v_lshlrev_b32 v52, 3, v52
  s_lshl_b32 s30, s35, 3
  s_add_u32 s30, s30, 0x1b6a000
  v_mov_b32 v53, s30
  v_add_u32 v52, v52, v53
  s_mov_b32 s72, 0x40000
.pl_114:
  buffer_load_dwordx2 v[56:57], v52, s[4:7], 0 offen sc1
  s_waitcnt vmcnt(0)
  v_cmp_ne_u64 vcc, s[26:27], v[56:57]
  s_cbranch_vccz .pd_115
  s_sleep 2
  s_sub_u32 s72, s72, 1
  s_cmp_lg_u32 s72, 0
  s_cbranch_scc1 .pl_114
.pd_115:
  v_mov_b32 v59, 1
  ds_write_b32 v58, v59
  s_branch .lwd_112
.lw_111:
  s_mov_b32 s72, 0x1000000
.lwl_113:
  ds_read_b32 v56, v58
  s_waitcnt lgkmcnt(0)
  v_readfirstlane_b32 s30, v56
  s_nop 3
  s_cmp_lg_u32 s30, 0
  s_cbranch_scc1 .lwd_112
  s_sleep 1
  s_sub_u32 s72, s72, 1
  s_cmp_lg_u32 s72, 0
  s_cbranch_scc1 .lwl_113
.lwd_112:
  s_cmp_ge_u32 s21, 2
  s_cbranch_scc1 .s1_116
  s_lshl_b32 s30, s22, 7
  s_lshl_b32 s31, s21, 6
  s_add_u32 s30, s30, s31
  v_add_u32 v28, s30, v1
  v_lshlrev_b32 v28, 6, v28
  v_add_u32 v28, 0x1b10000, v28
  buffer_load_dwordx4 v[92:95], v28, s[4:7], 0 offen offset:0 sc1
  buffer_load_dwordx4 v[96:99], v28, s[4:7], 0 offen offset:16 sc1
  buffer_load_dwordx4 v[100:103], v28, s[4:7], 0 offen offset:32 sc1
  buffer_load_dwordx4 v[104:107], v28, s[4:7], 0 offen offset:48 sc1
  s_branch .s2_117
.s1_116:
  s_mul_i32 s30, s23, 448
  s_add_u32 s30, s30, 0x1b40a00
  buffer_load_dwordx4 v[92:95], v66, s[4:7], s30 offen sc1
  s_add_u32 s30, s30, 9728
  buffer_load_dwordx4 v[96:99], v66, s[4:7], s30 offen sc1
  s_add_u32 s30, s30, 9728
  buffer_load_dwordx4 v[100:103], v66, s[4:7], s30 offen sc1
  s_add_u32 s30, s30, 9728
  buffer_load_dwordx4 v[104:107], v66, s[4:7], s30 offen sc1
  s_add_u32 s30, s30, 9728
.s2_117:
  s_waitcnt vmcnt(0)
  s_barrier
  s_cmp_ge_u32 s21, 2
  s_cbranch_scc1 .s1_118
  v_add_f32 v36, v92, v94
  v_add_f32 v37, v93, v95
  v_add_f32 v36, v36, v96
  v_add_f32 v37, v37, v97
  v_add_f32 v36, v36, v98
  v_add_f32 v37, v37, v99
  v_add_f32 v36, v36, v100
  v_add_f32 v37, v37, v101
  v_add_f32 v36, v36, v102
  v_add_f32 v37, v37, v103
  v_add_f32 v36, v36, v104
  v_add_f32 v37, v37, v105
  v_add_f32 v36, v36, v106
  v_add_f32 v37, v37, v107
  v_mul_f32 v36, 0x3acccccd, v36
  v_mov_b32 v38, 0
  v_mul_f32 v39, 0x3c4ccccd, v92
  v_sub_f32 v39, v39, v36
  v_fmac_f32 v38, v39, v39
  v_mul_f32 v39, 0x3c4ccccd, v94
  v_sub_f32 v39, v39, v36
  v_fmac_f32 v38, v39, v39
  v_mul_f32 v39, 0x3c4ccccd, v96
  v_sub_f32 v39, v39, v36
  v_fmac_f32 v38, v39, v39
  v_mul_f32 v39, 0x3c4ccccd, v98
  v_sub_f32 v39, v39, v36
  v_fmac_f32 v38, v39, v39
  v_mul_f32 v39, 0x3c4ccccd, v100
  v_sub_f32 v39, v39, v36
  v_fmac_f32 v38, v39, v39
  v_mul_f32 v39, 0x3c4ccccd, v102
  v_sub_f32 v39, v39, v36
  v_fmac_f32 v38, v39, v39
  v_mul_f32 v39, 0x3c4ccccd, v104
  v_sub_f32 v39, v39, v36
  v_fmac_f32 v38, v39, v39
  v_mul_f32 v39, 0x3c4ccccd, v106
  v_sub_f32 v39, v39, v36
  v_fmac_f32 v38, v39, v39
  v_mul_f32 v38, 0x42a00000, v38
  v_add_f32 v37, v37, v38
  v_mul_f32 v37, 0x3acccccd, v37
  v_cvt_pk_bf16_f32 v40, v36, v37
  v_lshlrev_b32 v36, 16, v40
  v_and_b32 v37, 0xffff0000, v40
  v_add_f32 v37, 0x3727c5ac, v37
  v_cvt_pk_bf16_f32 v40, v37, v37
  v_lshlrev_b32 v37, 16, v40
  v_sqrt_f32 v37, v37
  s_nop 0
  v_cvt_pk_bf16_f32 v40, v37, v37
  v_lshlrev_b32 v37, 16, v40
  v_rcp_f32 v37, v37
  v_xor_b32 v36, 0x80000000, v36
  s_lshl_b32 s30, s21, 9
  s_add_u32 s30, s30, 159744
  v_lshl_add_u32 v28, v1, 3, s30
  ds_write_b64 v28, v[36:37]
  s_branch .s2_119
.s1_118:
  v_pk_add_f32 v[92:93], v[92:93], v[96:97]
  v_pk_add_f32 v[100:101], v[100:101], v[104:105]
  v_pk_add_f32 v[92:93], v[92:93], v[100:101]
  v_pk_add_f32 v[94:95], v[94:95], v[98:99]
  v_pk_add_f32 v[102:103], v[102:103], v[106:107]
  v_pk_add_f32 v[94:95], v[94:95], v[102:103]
  v_add_u32 v28, 161792, v66
  ds_write_b128 v28, v[92:95]
.s2_119:
  s_barrier
  s_waitcnt lgkmcnt(0)
  s_barrier
  s_mul_i32 s71, s21, 5120
  s_mul_i32 s69, s66, 389120
  s_add_u32 s69, s69, s71
  s_add_u32 s69, s69, 0x1d00000
  s_add_u32 m0, s71, 0
  s_nop 0
  buffer_load_dwordx4 v66, s[4:7], s69 offen sc1 lds
  buffer_load_dwordx4 v66, s[4:7], s69 offen offset:1024 sc1 lds
  buffer_load_dwordx4 v66, s[4:7], s69 offen offset:2048 sc1 lds
  buffer_load_dwordx4 v66, s[4:7], s69 offen offset:3072 sc1 lds
  s_add_u32 m0, s71, 4096
  s_add_u32 s38, s69, 4096
  buffer_load_dwordx4 v66, s[4:7], s38 offen sc1 lds
  s_add_u32 s69, s69, 20480
  s_add_u32 m0, s39, 20480
  s_movk_i32 s30, 0
  buffer_load_dwordx4 v90, s[4:7], s30 offen sc1 lds
  buffer_load_dwordx4 v91, s[4:7], s30 offen offset:1024 sc1 lds
  s_add_u32 m0, s39, 28672
  s_movk_i32 s30, 128
  buffer_load_dwordx4 v90, s[4:7], s30 offen sc1 lds
  buffer_load_dwordx4 v91, s[4:7], s30 offen offset:1024 sc1 lds
  s_add_u32 m0, s71, 36864
  s_nop 0
  buffer_load_dwordx4 v66, s[4:7], s69 offen sc1 lds
  buffer_load_dwordx4 v66, s[4:7], s69 offen offset:1024 sc1 lds
  buffer_load_dwordx4 v66, s[4:7], s69 offen offset:2048 sc1 lds
  buffer_load_dwordx4 v66, s[4:7], s69 offen offset:3072 sc1 lds
  s_add_u32 m0, s71, 40960
  s_add_u32 s38, s69, 4096
  buffer_load_dwordx4 v66, s[4:7], s38 offen sc1 lds
  s_add_u32 s69, s69, 20480
  s_add_u32 m0, s39, 57344
  s_movk_i32 s30, 256
  buffer_load_dwordx4 v90, s[4:7], s30 offen sc1 lds
  buffer_load_dwordx4 v91, s[4:7], s30 offen offset:1024 sc1 lds
  s_add_u32 m0, s39, 65536
  s_movk_i32 s30, 384
  buffer_load_dwordx4 v90, s[4:7], s30 offen sc1 lds
  buffer_load_dwordx4 v91, s[4:7], s30 offen offset:1024 sc1 lds
  s_add_u32 m0, s71, 73728
  s_nop 0
  buffer_load_dwordx4 v66, s[4:7], s69 offen sc1 lds
  buffer_load_dwordx4 v66, s[4:7], s69 offen offset:1024 sc1 lds
  buffer_load_dwordx4 v66, s[4:7], s69 offen offset:2048 sc1 lds
  buffer_load_dwordx4 v66, s[4:7], s69 offen offset:3072 sc1 lds
  s_add_u32 m0, s71, 77824
  s_add_u32 s38, s69, 4096
  buffer_load_dwordx4 v66, s[4:7], s38 offen sc1 lds
  s_add_u32 s69, s69, 20480
  s_add_u32 m0, s39, 94208
  s_movk_i32 s30, 512
  buffer_load_dwordx4 v90, s[4:7], s30 offen sc1 lds
  buffer_load_dwordx4 v91, s[4:7], s30 offen offset:1024 sc1 lds
  s_add_u32 m0, s39, 102400
  s_movk_i32 s30, 640
  buffer_load_dwordx4 v90, s[4:7], s30 offen sc1 lds
  buffer_load_dwordx4 v91, s[4:7], s30 offen offset:1024 sc1 lds
  s_add_u32 m0, s71, 110592
  s_nop 0
  buffer_load_dwordx4 v66, s[4:7], s69 offen sc1 lds
  buffer_load_dwordx4 v66, s[4:7], s69 offen offset:1024 sc1 lds
  buffer_load_dwordx4 v66, s[4:7], s69 offen offset:2048 sc1 lds
  buffer_load_dwordx4 v66, s[4:7], s69 offen offset:3072 sc1 lds
  s_add_u32 m0, s71, 114688
  s_add_u32 s38, s69, 4096
  buffer_load_dwordx4 v66, s[4:7], s38 offen sc1 lds
  s_add_u32 s69, s69, 20480
  s_add_u32 m0, s39, 131072
  s_movk_i32 s30, 768
  buffer_load_dwordx4 v90, s[4:7], s30 offen sc1 lds
  buffer_load_dwordx4 v91, s[4:7], s30 offen offset:1024 sc1 lds
  s_add_u32 m0, s39, 139264
  s_movk_i32 s30, 896
  buffer_load_dwordx4 v90, s[4:7], s30 offen sc1 lds
  buffer_load_dwordx4 v91, s[4:7], s30 offen offset:1024 sc1 lds
  s_waitcnt vmcnt(27)
  s_barrier
  s_waitcnt vmcnt(18)
  s_barrier
  s_waitcnt vmcnt(9)
  s_barrier
  s_add_u32 m0, s71, 0
  s_nop 0
  buffer_load_dwordx4 v66, s[4:7], s69 offen sc1 lds
  buffer_load_dwordx4 v66, s[4:7], s69 offen offset:1024 sc1 lds
  buffer_load_dwordx4 v66, s[4:7], s69 offen offset:2048 sc1 lds
  buffer_load_dwordx4 v66, s[4:7], s69 offen offset:3072 sc1 lds
  s_add_u32 m0, s71, 4096
  s_add_u32 s38, s69, 4096
  buffer_load_dwordx4 v66, s[4:7], s38 offen sc1 lds
  s_add_u32 s69, s69, 20480
  s_add_u32 m0, s39, 20480
  s_movk_i32 s30, 1024
  buffer_load_dwordx4 v90, s[4:7], s30 offen sc1 lds
  buffer_load_dwordx4 v91, s[4:7], s30 offen offset:1024 sc1 lds
  s_add_u32 m0, s39, 28672
  s_movk_i32 s30, 1152
  buffer_load_dwordx4 v90, s[4:7], s30 offen sc1 lds
  buffer_load_dwordx4 v91, s[4:7], s30 offen offset:1024 sc1 lds
  s_waitcnt vmcnt(9)
  s_barrier
  s_add_u32 m0, s71, 36864
  s_nop 0
  buffer_load_dwordx4 v66, s[4:7], s69 offen sc1 lds
  buffer_load_dwordx4 v66, s[4:7], s69 offen offset:1024 sc1 lds
  buffer_load_dwordx4 v66, s[4:7], s69 offen offset:2048 sc1 lds
  buffer_load_dwordx4 v66, s[4:7], s69 offen offset:3072 sc1 lds
  s_add_u32 m0, s71, 40960
  s_add_u32 s38, s69, 4096
  buffer_load_dwordx4 v66, s[4:7], s38 offen sc1 lds
  s_add_u32 s69, s69, 20480
  s_lshl_b32 s35, s22, 4
  v_mov_b32 v58, 162956
  s_cmp_lg_u32 s21, 0
  s_cbranch_scc1 .lw_120
  v_and_b32 v52, 15, v1
  v_lshlrev_b32 v52, 3, v52
  s_lshl_b32 s30, s35, 3
  s_add_u32 s30, s30, 0x1b68000
  v_mov_b32 v53, s30
  v_add_u32 v52, v52, v53
  s_mov_b32 s72, 0x40000
.pl_123:
  buffer_load_dwordx2 v[56:57], v52, s[4:7], 0 offen sc1
  s_waitcnt vmcnt(0)
  v_cmp_ne_u64 vcc, s[26:27], v[56:57]
  s_cbranch_vccz .pd_124
  s_sleep 2
  s_sub_u32 s72, s72, 1
  s_cmp_lg_u32 s72, 0
  s_cbranch_scc1 .pl_123
.pd_124:
  v_mov_b32 v59, 1
  ds_write_b32 v58, v59
  s_branch .lwd_121
.lw_120:
  s_mov_b32 s72, 0x1000000
.lwl_122:
  ds_read_b32 v56, v58
  s_waitcnt lgkmcnt(0)
  v_readfirstlane_b32 s30, v56
  s_nop 3
  s_cmp_lg_u32 s30, 0
  s_cbranch_scc1 .lwd_121
  s_sleep 1
  s_sub_u32 s72, s72, 1
  s_cmp_lg_u32 s72, 0
  s_cbranch_scc1 .lwl_122
.lwd_121:
  s_add_u32 m0, s39, 57344
  s_movk_i32 s30, 0
  buffer_load_dwordx4 v88, s[4:7], s30 offen sc1 lds
  buffer_load_dwordx4 v89, s[4:7], s30 offen offset:1024 sc1 lds
  s_add_u32 m0, s39, 65536
  s_movk_i32 s30, 128
  buffer_load_dwordx4 v88, s[4:7], s30 offen sc1 lds
  buffer_load_dwordx4 v89, s[4:7], s30 offen offset:1024 sc1 lds
  s_waitcnt vmcnt(9)
  s_barrier
  s_add_u32 m0, s71, 73728
  s_nop 0
  buffer_load_dwordx4 v66, s[4:7], s69 offen sc1 lds
  buffer_load_dwordx4 v66, s[4:7], s69 offen offset:1024 sc1 lds
  buffer_load_dwordx4 v66, s[4:7], s69 offen offset:2048 sc1 lds
  buffer_load_dwordx4 v66, s[4:7], s69 offen offset:3072 sc1 lds
  s_add_u32 m0, s71, 77824
  s_add_u32 s38, s69, 4096
  buffer_load_dwordx4 v66, s[4:7], s38 offen sc1 lds
  s_add_u32 s69, s69, 20480
  s_add_u32 m0, s39, 94208
  s_movk_i32 s30, 256
  buffer_load_dwordx4 v88, s[4:7], s30 offen sc1 lds
  buffer_load_dwordx4 v89, s[4:7], s30 offen offset:1024 sc1 lds
  s_add_u32 m0, s39, 102400
  s_movk_i32 s30, 384
  buffer_load_dwordx4 v88, s[4:7], s30 offen sc1 lds
  buffer_load_dwordx4 v89, s[4:7], s30 offen offset:1024 sc1 lds
  s_waitcnt vmcnt(9)
  s_barrier
  s_add_u32 m0, s71, 110592
  s_nop 0
  buffer_load_dwordx4 v66, s[4:7], s69 offen sc1 lds
  buffer_load_dwordx4 v66, s[4:7], s69 offen offset:1024 sc1 lds
  buffer_load_dwordx4 v66, s[4:7], s69 offen offset:2048 sc1 lds
  buffer_load_dwordx4 v66, s[4:7], s69 offen offset:3072 sc1 lds
  s_add_u32 m0, s71, 114688
  s_add_u32 s38, s69, 4096
  buffer_load_dwordx4 v66, s[4:7], s38 offen sc1 lds
  s_add_u32 s69, s69, 20480
  s_add_u32 m0, s39, 131072
  s_movk_i32 s30, 512
  buffer_load_dwordx4 v88, s[4:7], s30 offen sc1 lds
  buffer_load_dwordx4 v89, s[4:7], s30 offen offset:1024 sc1 lds
  s_add_u32 m0, s39, 139264
  s_movk_i32 s30, 640
  buffer_load_dwordx4 v88, s[4:7], s30 offen sc1 lds
  buffer_load_dwordx4 v89, s[4:7], s30 offen offset:1024 sc1 lds
  s_waitcnt vmcnt(9)
  s_barrier
  s_add_u32 m0, s71, 0
  s_nop 0
  buffer_load_dwordx4 v66, s[4:7], s69 offen sc1 lds
  buffer_load_dwordx4 v66, s[4:7], s69 offen offset:1024 sc1 lds
  buffer_load_dwordx4 v66, s[4:7], s69 offen offset:2048 sc1 lds
  buffer_load_dwordx4 v66, s[4:7], s69 offen offset:3072 sc1 lds
  s_add_u32 m0, s71, 4096
  s_add_u32 s38, s69, 4096
  buffer_load_dwordx4 v66, s[4:7], s38 offen sc1 lds
  s_add_u32 s69, s69, 20480
  s_add_u32 m0, s39, 20480
  s_movk_i32 s30, 768
  buffer_load_dwordx4 v88, s[4:7], s30 offen sc1 lds
  buffer_load_dwordx4 v89, s[4:7], s30 offen offset:1024 sc1 lds
  s_add_u32 m0, s39, 28672
  s_movk_i32 s30, 896
  buffer_load_dwordx4 v88, s[4:7], s30 offen sc1 lds
  buffer_load_dwordx4 v89, s[4:7], s30 offen offset:1024 sc1 lds
  s_waitcnt vmcnt(9)
  s_barrier
  s_add_u32 m0, s71, 36864
  s_nop 0
  buffer_load_dwordx4 v66, s[4:7], s69 offen sc1 lds
  buffer_load_dwordx4 v66, s[4:7], s69 offen offset:1024 sc1 lds
  buffer_load_dwordx4 v66, s[4:7], s69 offen offset:2048 sc1 lds
  buffer_load_dwordx4 v66, s[4:7], s69 offen offset:3072 sc1 lds
  s_add_u32 m0, s71, 40960
  s_add_u32 s38, s69, 4096
  buffer_load_dwordx4 v66, s[4:7], s38 offen sc1 lds
  s_add_u32 s69, s69, 20480
  s_add_u32 m0, s39, 57344
  s_movk_i32 s30, 1024
  buffer_load_dwordx4 v88, s[4:7], s30 offen sc1 lds
  buffer_load_dwordx4 v89, s[4:7], s30 offen offset:1024 sc1 lds
  s_add_u32 m0, s39, 65536
  s_movk_i32 s30, 1152
  buffer_load_dwordx4 v88, s[4:7], s30 offen sc1 lds
  buffer_load_dwordx4 v89, s[4:7], s30 offen offset:1024 sc1 lds
  s_waitcnt vmcnt(9)
  s_barrier
  s_add_u32 m0, s71, 73728
  s_nop 0
  buffer_load_dwordx4 v66, s[4:7], s69 offen sc1 lds
  buffer_load_dwordx4 v66, s[4:7], s69 offen offset:1024 sc1 lds
  buffer_load_dwordx4 v66, s[4:7], s69 offen offset:2048 sc1 lds
  buffer_load_dwordx4 v66, s[4:7], s69 offen offset:3072 sc1 lds
  s_add_u32 m0, s71, 77824
  s_add_u32 s38, s69, 4096
  buffer_load_dwordx4 v66, s[4:7], s38 offen sc1 lds
  s_add_u32 s69, s69, 20480
  s_add_u32 m0, s39, 94208
  s_movk_i32 s30, 1280
  buffer_load_dwordx4 v88, s[4:7], s30 offen sc1 lds
  buffer_load_dwordx4 v89, s[4:7], s30 offen offset:1024 sc1 lds
  s_add_u32 m0, s39, 102400
  s_movk_i32 s30, 1408
  buffer_load_dwordx4 v88, s[4:7], s30 offen sc1 lds
  buffer_load_dwordx4 v89, s[4:7], s30 offen offset:1024 sc1 lds
  s_waitcnt vmcnt(9)
  s_barrier
  s_add_u32 m0, s71, 110592
  s_nop 0
  buffer_load_dwordx4 v66, s[4:7], s69 offen sc1 lds
  buffer_load_dwordx4 v66, s[4:7], s69 offen offset:1024 sc1 lds
  buffer_load_dwordx4 v66, s[4:7], s69 offen offset:2048 sc1 lds
  buffer_load_dwordx4 v66, s[4:7], s69 offen offset:3072 sc1 lds
  s_add_u32 m0, s71, 114688
  s_add_u32 s38, s69, 4096
  buffer_load_dwordx4 v66, s[4:7], s38 offen sc1 lds
  s_add_u32 s69, s69, 20480
  s_add_u32 m0, s39, 131072
  s_movk_i32 s30, 1536
  buffer_load_dwordx4 v88, s[4:7], s30 offen sc1 lds
  buffer_load_dwordx4 v89, s[4:7], s30 offen offset:1024 sc1 lds
  s_add_u32 m0, s39, 139264
  s_movk_i32 s30, 1664
  buffer_load_dwordx4 v88, s[4:7], s30 offen sc1 lds
  buffer_load_dwordx4 v89, s[4:7], s30 offen offset:1024 sc1 lds
  s_waitcnt vmcnt(9)
  s_barrier
  s_add_u32 m0, s71, 0
  s_nop 0
  buffer_load_dwordx4 v66, s[4:7], s69 offen sc1 lds
  buffer_load_dwordx4 v66, s[4:7], s69 offen offset:1024 sc1 lds
  buffer_load_dwordx4 v66, s[4:7], s69 offen offset:2048 sc1 lds
  buffer_load_dwordx4 v66, s[4:7], s69 offen offset:3072 sc1 lds
  s_add_u32 m0, s71, 4096
  s_add_u32 s38, s69, 4096
  buffer_load_dwordx4 v66, s[4:7], s38 offen sc1 lds
  s_add_u32 s69, s69, 20480
  s_add_u32 m0, s39, 20480
  s_movk_i32 s30, 1792
  buffer_load_dwordx4 v88, s[4:7], s30 offen sc1 lds
  buffer_load_dwordx4 v89, s[4:7], s30 offen offset:1024 sc1 lds
  s_add_u32 m0, s39, 28672
  s_movk_i32 s30, 1920
  buffer_load_dwordx4 v88, s[4:7], s30 offen sc1 lds
  buffer_load_dwordx4 v89, s[4:7], s30 offen offset:1024 sc1 lds
  s_waitcnt vmcnt(9)
  s_barrier
  s_add_u32 m0, s71, 36864
  s_nop 0
  buffer_load_dwordx4 v66, s[4:7], s69 offen sc1 lds
  buffer_load_dwordx4 v66, s[4:7], s69 offen offset:1024 sc1 lds
  buffer_load_dwordx4 v66, s[4:7], s69 offen offset:2048 sc1 lds
  buffer_load_dwordx4 v66, s[4:7], s69 offen offset:3072 sc1 lds
  s_add_u32 m0, s71, 40960
  s_add_u32 s38, s69, 4096
  buffer_load_dwordx4 v66, s[4:7], s38 offen sc1 lds
  s_add_u32 s69, s69, 20480
  s_add_u32 m0, s39, 57344
  s_movk_i32 s30, 2048
  buffer_load_dwordx4 v88, s[4:7], s30 offen sc1 lds
  buffer_load_dwordx4 v89, s[4:7], s30 offen offset:1024 sc1 lds
  s_add_u32 m0, s39, 65536
  s_movk_i32 s30, 2176
  buffer_load_dwordx4 v88, s[4:7], s30 offen sc1 lds
  buffer_load_dwordx4 v89, s[4:7], s30 offen offset:1024 sc1 lds
  s_waitcnt vmcnt(9)
  s_barrier
  s_add_u32 m0, s71, 73728
  s_nop 0
  buffer_load_dwordx4 v66, s[4:7], s69 offen sc1 lds
  buffer_load_dwordx4 v66, s[4:7], s69 offen offset:1024 sc1 lds
  buffer_load_dwordx4 v66, s[4:7], s69 offen offset:2048 sc1 lds
  buffer_load_dwordx4 v66, s[4:7], s69 offen offset:3072 sc1 lds
  s_add_u32 m0, s71, 77824
  s_add_u32 s38, s69, 4096
  buffer_load_dwordx4 v66, s[4:7], s38 offen sc1 lds
  s_add_u32 s69, s69, 20480
  s_add_u32 m0, s39, 94208
  s_movk_i32 s30, 2304
  buffer_load_dwordx4 v88, s[4:7], s30 offen sc1 lds
  buffer_load_dwordx4 v89, s[4:7], s30 offen offset:1024 sc1 lds
  s_add_u32 m0, s39, 102400
  s_movk_i32 s30, 2432
  buffer_load_dwordx4 v88, s[4:7], s30 offen sc1 lds
  buffer_load_dwordx4 v89, s[4:7], s30 offen offset:1024 sc1 lds
  s_waitcnt vmcnt(9)
  s_barrier
  s_add_u32 m0, s71, 110592
  s_nop 0
  buffer_load_dwordx4 v66, s[4:7], s69 offen sc1 lds
  buffer_load_dwordx4 v66, s[4:7], s69 offen offset:1024 sc1 lds
  buffer_load_dwordx4 v66, s[4:7], s69 offen offset:2048 sc1 lds
  buffer_load_dwordx4 v66, s[4:7], s69 offen offset:3072 sc1 lds
  s_add_u32 m0, s71, 114688
  s_add_u32 s38, s69, 4096
  buffer_load_dwordx4 v66, s[4:7], s38 offen sc1 lds
  s_add_u32 s69, s69, 20480
  s_add_u32 m0, s39, 131072
  s_movk_i32 s30, 2560
  buffer_load_dwordx4 v88, s[4:7], s30 offen sc1 lds
  buffer_load_dwordx4 v89, s[4:7], s30 offen offset:1024 sc1 lds
  s_add_u32 m0, s39, 139264
  s_movk_i32 s30, 2688
  buffer_load_dwordx4 v88, s[4:7], s30 offen sc1 lds
  buffer_load_dwordx4 v89, s[4:7], s30 offen offset:1024 sc1 lds
  s_waitcnt vmcnt(9)
  s_barrier
  s_add_u32 m0, s71, 0
  s_nop 0
  buffer_load_dwordx4 v66, s[4:7], s69 offen sc1 lds
  buffer_load_dwordx4 v66, s[4:7], s69 offen offset:1024 sc1 lds
  buffer_load_dwordx4 v66, s[4:7], s69 offen offset:2048 sc1 lds
  buffer_load_dwordx4 v66, s[4:7], s69 offen offset:3072 sc1 lds
  s_add_u32 m0, s71, 4096
  s_add_u32 s38, s69, 4096
  buffer_load_dwordx4 v66, s[4:7], s38 offen sc1 lds
  s_add_u32 s69, s69, 20480
  s_add_u32 m0, s39, 20480
  s_movk_i32 s30, 2816
  buffer_load_dwordx4 v88, s[4:7], s30 offen sc1 lds
  buffer_load_dwordx4 v89, s[4:7], s30 offen offset:1024 sc1 lds
  s_add_u32 m0, s39, 28672
  s_movk_i32 s30, 2944
  buffer_load_dwordx4 v88, s[4:7], s30 offen sc1 lds
  buffer_load_dwordx4 v89, s[4:7], s30 offen offset:1024 sc1 lds
  s_waitcnt vmcnt(9)
  s_barrier
  s_add_u32 m0, s71, 36864
  s_nop 0
  buffer_load_dwordx4 v66, s[4:7], s69 offen sc1 lds
  buffer_load_dwordx4 v66, s[4:7], s69 offen offset:1024 sc1 lds
  buffer_load_dwordx4 v66, s[4:7], s69 offen offset:2048 sc1 lds
  buffer_load_dwordx4 v66, s[4:7], s69 offen offset:3072 sc1 lds
  s_add_u32 m0, s71, 40960
  s_add_u32 s38, s69, 4096
  buffer_load_dwordx4 v66, s[4:7], s38 offen sc1 lds
  s_add_u32 s69, s69, 20480
  s_add_u32 m0, s39, 57344
  s_movk_i32 s30, 3072
  buffer_load_dwordx4 v88, s[4:7], s30 offen sc1 lds
  buffer_load_dwordx4 v89, s[4:7], s30 offen offset:1024 sc1 lds
  s_add_u32 m0, s39, 65536
  s_movk_i32 s30, 3200
  buffer_load_dwordx4 v88, s[4:7], s30 offen sc1 lds
  buffer_load_dwordx4 v89, s[4:7], s30 offen offset:1024 sc1 lds
  s_waitcnt vmcnt(9)
  s_barrier
  s_add_u32 m0, s71, 73728
  s_nop 0
  buffer_load_dwordx4 v66, s[4:7], s69 offen sc1 lds
  buffer_load_dwordx4 v66, s[4:7], s69 offen offset:1024 sc1 lds
  buffer_load_dwordx4 v66, s[4:7], s69 offen offset:2048 sc1 lds
  buffer_load_dwordx4 v66, s[4:7], s69 offen offset:3072 sc1 lds
  s_add_u32 m0, s71, 77824
  s_add_u32 s38, s69, 4096
  buffer_load_dwordx4 v66, s[4:7], s38 offen sc1 lds
  s_add_u32 s69, s69, 20480
  s_add_u32 m0, s39, 94208
  s_movk_i32 s30, 3328
  buffer_load_dwordx4 v88, s[4:7], s30 offen sc1 lds
  buffer_load_dwordx4 v89, s[4:7], s30 offen offset:1024 sc1 lds
  s_add_u32 m0, s39, 102400
  s_movk_i32 s30, 3456
  buffer_load_dwordx4 v88, s[4:7], s30 offen sc1 lds
  buffer_load_dwordx4 v89, s[4:7], s30 offen offset:1024 sc1 lds
  s_waitcnt vmcnt(9)
  s_barrier
  s_waitcnt vmcnt(0)
  s_barrier
  s_endpgm
.Lexit:
  s_endpgm
.section .rodata,"a"
.p2align 6
.amdhsa_kernel gated_mix__sliding_local_dilated__mixer_s_mlp__prompt_kernel
  .amdhsa_next_free_vgpr 256
  .amdhsa_next_free_sgpr 102
  .amdhsa_accum_offset 256
  .amdhsa_group_segment_fixed_size 0
  .amdhsa_kernarg_size 96
  .amdhsa_user_sgpr_count 2
  .amdhsa_user_sgpr_kernarg_segment_ptr 1
  .amdhsa_system_sgpr_workgroup_id_x 1
.end_amdhsa_kernel
```
